```python
import torch

def _softmax(x, axis=-1):
    return torch.softmax(x, dim=axis)
def _gelu(x):
    return torch.nn.functional.gelu(x, approximate="tanh")
def _silu(x):
    return torch.nn.functional.silu(x)
def _sigmoid(x):
    return torch.sigmoid(x)
def _layernorm(x, axis=-1, eps=1e-5):
    m = x.mean(dim=axis, keepdim=True)
    v = x.var(dim=axis, keepdim=True, unbiased=False)
    return (x - m) / torch.sqrt(v + eps)
def _scatter_add(tgt, idx, src, axis=0):
    return tgt.clone().index_add_(axis, idx, src)
def _segment_sum(src, seg, n):
    out = torch.zeros((n,) + src.shape[1:], dtype=src.dtype)
    return out.index_add_(0, seg, src)
def _pad(x, pw):
    flat = tuple(v for pair in reversed(pw) for v in pair)
    return torch.nn.functional.pad(x, flat)

kernel_name = 'interleave_layers__softmax_full_mha__mixer_s_mlp__prompt'

def setup_inputs():

    _w = (lambda a: (lambda t: t.to(torch.bfloat16) if t.is_floating_point() else t)(torch.as_tensor(a)))
    def _A_setup():
        B, S, D = 1, 2048, 512
        return {
            "x": _w((lambda *s: torch.randn(*s, dtype=torch.bfloat16) * 0.05)(B, S, D)),
            "wqkv": _w((lambda *s: torch.randn(*s, dtype=torch.bfloat16) * 0.05)(D, 3 * D)),
            "wo": _w((lambda *s: torch.randn(*s, dtype=torch.bfloat16) * 0.05)(D, D)),
        }
    _A_in = _A_setup()

    def _B_setup():
        B, S, D, F = 1, 2048, 512, 1792
        return {
            "x":  _w((lambda *s: torch.randn(*s, dtype=torch.bfloat16) * 0.05)(B, S, D)),
            "w1": _w((lambda *s: torch.randn(*s, dtype=torch.bfloat16) * 0.8)(D, D) * (D ** -0.5)),
            "w2": _w((lambda *s: torch.randn(*s, dtype=torch.bfloat16) * 0.8)(D, D) * (D ** -0.5)),
            "w3": _w((lambda *s: torch.randn(*s, dtype=torch.bfloat16) * 0.8)(D, F) * (D ** -0.5)),
            "w4": _w((lambda *s: torch.randn(*s, dtype=torch.bfloat16) * 0.8)(F, D) * (F ** -0.5)),
        }
    _B_in = _B_setup()

    return {
        "A_x": _A_in["x"],
        "A_wqkv": _A_in["wqkv"],
        "A_wo": _A_in["wo"],
        "B_x": _B_in["x"],
        "B_w1": _B_in["w1"],
        "B_w2": _B_in["w2"],
        "B_w3": _B_in["w3"],
        "B_w4": _B_in["w4"],
    }

def reference(A_x, A_wqkv, A_wo, B_x, B_w1, B_w2, B_w3, B_w4):
    def _A_ref(x, wqkv, wo):
        B, S, D = x.shape
        H = 32; Dh = D // H
        qkv = (lambda x, *d: x.permute(*d))((x @ wqkv).reshape(B, S, 3, H, Dh), 2, 0, 3, 1, 4)
        q, k, v = qkv[0], qkv[1], qkv[2]
        scale = Dh ** -0.5
        scores = torch.einsum("bhqd,bhkd->bhqk", q, k) * scale
        p = _softmax(scores, axis=-1)
        o = torch.einsum("bhqk,bhkd->bhqd", p, v)
        return (lambda x, *d: x.permute(*d))(o, 0, 2, 1, 3).reshape(B, S, D) @ wo

    def _B_ref(x, w1, w2, w3, w4):
        B, S, D = x.shape
        h = _gelu(_layernorm(x, axis=-1) @ w1)
        c = D // 4
        g0 = _pad(h[:, :, 0*c:1*c], ((0, 0), (1, 0), (0, 0)))[:, :S, :]
        g1 = _pad(h[:, :, 1*c:2*c], ((0, 0), (0, 1), (0, 0)))[:, 1:, :]
        g2 = _pad(h[:, :, 2*c:3*c], ((0, 0), (2, 0), (0, 0)))[:, :S, :]
        g3 = _pad(h[:, :, 3*c:   ], ((0, 0), (0, 2), (0, 0)))[:, 2:, :]
        hs = torch.concatenate([g0, g1, g2, g3], axis=-1) @ w2
        x1 = x + hs
        h2 = _gelu(_layernorm(x1, axis=-1) @ w3) @ w4
        return x1 + h2

    x = A_x
    x = x + _A_ref(_layernorm(x, axis=-1), A_wqkv, A_wo)
    x = x + _B_ref(_layernorm(x, axis=-1), B_w1, B_w2, B_w3, B_w4)
    x = x + _A_ref(_layernorm(x, axis=-1), A_wqkv, A_wo)
    x = x + _B_ref(_layernorm(x, axis=-1), B_w1, B_w2, B_w3, B_w4)
    return x
```

```asm
; @launch kernel=k0_kernel grid=(256,1,1) block=(512,1,1) lds=151552
; @launch kernel=attn0_kernel grid=(256,1,1) block=(1024,1,1) lds=147520
; @launch kernel=chain0_kernel grid=(256,1,1) block=(512,1,1) lds=157696
; @launch kernel=attn1_kernel grid=(256,1,1) block=(1024,1,1) lds=147520
; @launch kernel=chain1_kernel grid=(256,1,1) block=(512,1,1) lds=157696
.amdgcn_target "amdgcn-amd-amdhsa--gfx950"
.text
L_code_start:
.text
.globl k0_kernel
.p2align 8
.type k0_kernel,@function
k0_kernel:
    s_cmp_ge_u32 s2, 256
    s_cbranch_scc1 L_k0_kernel_end
    s_load_dwordx2 s[6:7], s[0:1], 80
    s_load_dwordx4 s[32:35], s[0:1], 0
    v_lshrrev_b32 v1, 6, v0
    v_mov_b32 v2, v0
    v_and_b32 v0, 63, v0
    s_and_b32 s30, s2, 7
    s_lshr_b32 s31, s2, 3
    v_readfirstlane_b32 s22, v1
    s_mov_b32 s42, s31
    s_and_b32 s21, s31, 7
    s_lshr_b32 s31, s31, 3
    s_lshl_b32 s20, s30, 2
    s_add_u32 s20, s20, s31
    s_and_b32 s23, s22, 1
    s_bfe_u32 s24, s22, 0x10001
    s_and_b32 s25, s22, 3
    s_lshl_b32 s28, s20, 1
    s_add_u32 s28, s28, s23
    s_waitcnt lgkmcnt(0)
    s_mov_b32 s12, s6
    s_mov_b32 s13, s7
    s_mov_b32 s14, 0x2800000
    s_mov_b32 s15, 0x00020000
    s_mov_b32 s8, s32
    s_mov_b32 s9, s33
    s_mov_b32 s10, 0x200000
    s_mov_b32 s11, 0x00020000
    s_mov_b32 s16, s34
    s_mov_b32 s17, s35
    s_mov_b32 s18, 0x180000
    s_mov_b32 s19, 0x00020000
    s_cmp_gt_u32 s2, 1
    s_cbranch_scc1 L_k0_kernel_nz
    v_mov_b32 v4, 0
    v_mov_b32 v5, 0
    v_mov_b32 v6, 0
    v_mov_b32 v7, 0
    s_cmp_eq_u32 s2, 1
    s_cbranch_scc1 L_k0_kernel_z1
    v_lshlrev_b32 v3, 8, v2
    v_add_u32 v3, 1048576, v3
    buffer_store_dword v4, v3, s[12:15], 0 offen
    s_branch L_k0_kernel_nz
L_k0_kernel_z1:
    v_lshlrev_b32 v3, 4, v2
    v_add_u32 v3, 32768, v3
    buffer_store_dwordx4 v[4:7], v3, s[12:15], 0 offen
    v_add_u32 v3, 8192, v3
    buffer_store_dwordx4 v[4:7], v3, s[12:15], 0 offen
    v_add_u32 v3, 8192, v3
    buffer_store_dwordx4 v[4:7], v3, s[12:15], 0 offen
L_k0_kernel_nz:
    s_sub_u32 s30, s2, 2
    s_cmp_ge_u32 s30, 16
    s_cbranch_scc1 L_k0_kernel_nh
    s_lshl_b32 s30, s30, 13
    s_add_u32 s30, s30, 20971520
    v_mov_b32 v4, -1
    v_mov_b32 v5, -1
    v_mov_b32 v6, -1
    v_mov_b32 v7, -1
    v_lshlrev_b32 v3, 4, v2
    buffer_store_dwordx4 v[4:7], v3, s[12:15], s30 offen
L_k0_kernel_nh:
    s_cmp_ge_u32 s22, 4
    s_cbranch_scc1 L_k0_kernel_ld
    s_getpc_b64 s[32:33]
L_pc_k0_kernel:
    s_sub_u32 s32, s32, (L_pc_k0_kernel - L_code_start)
    s_subb_u32 s33, s33, 0
    s_lshl_b32 s34, s42, 13
    v_lshlrev_b32 v224, 7, v0
    v_add_u32 v224, s34, v224
    v_min_u32 v224, (L_code_end - L_code_start - 4), v224
    global_load_dword v225, v224, s[32:33]
    v_and_b32 v2, 31, v0
    v_lshrrev_b32 v3, 5, v0
    v_lshrrev_b32 v4, 3, v2
    s_lshl_b32 s30, s23, 2
    v_add_u32 v4, s30, v4
    v_lshlrev_b32 v4, 10, v4
    v_and_b32 v5, 7, v2
    v_lshl_add_u32 v4, v5, 7, v4
    v_bfe_u32 v5, v2, 1, 3
    v_xor_b32 v5, v5, v3
    v_xor_b32 v6, 0, v5
    v_lshl_add_u32 v8, v6, 4, v4
    v_xor_b32 v6, 2, v5
    v_lshl_add_u32 v9, v6, 4, v4
    v_xor_b32 v6, 4, v5
    v_lshl_add_u32 v10, v6, 4, v4
    v_xor_b32 v6, 6, v5
    v_lshl_add_u32 v11, v6, 4, v4
    v_and_b32 v4, 15, v0
    v_lshrrev_b32 v5, 2, v4
    v_lshlrev_b32 v6, 10, v3
    v_lshl_add_u32 v6, v5, 7, v6
    v_lshrrev_b32 v5, 1, v5
    v_xor_b32 v5, s24, v5
    v_lshl_add_u32 v6, v5, 6, v6
    v_bfe_u32 v5, v0, 4, 1
    v_lshl_add_u32 v6, v5, 5, v6
    v_and_b32 v4, 3, v4
    v_lshl_add_u32 v6, v4, 3, v6
    v_add_u32 v12, 8192, v6
    v_mov_b32 v20, 0x3f803f80
    v_mov_b32 v21, 0x3f803f80
    v_mov_b32 v22, 0x3f803f80
    v_mov_b32 v23, 0x3f803f80
    v_mov_b32 v32, 0
    v_mov_b32 v33, 0
    v_mov_b32 v34, 0
    v_mov_b32 v35, 0
    v_mov_b32 v36, 0
    v_mov_b32 v37, 0
    v_mov_b32 v38, 0
    v_mov_b32 v39, 0
    v_mov_b32 v40, 0
    v_mov_b32 v41, 0
    v_mov_b32 v42, 0
    v_mov_b32 v43, 0
    v_mov_b32 v44, 0
    v_mov_b32 v45, 0
    v_mov_b32 v46, 0
    v_mov_b32 v47, 0
    v_mov_b32 v48, 0
    v_mov_b32 v49, 0
    v_mov_b32 v50, 0
    v_mov_b32 v51, 0
    v_mov_b32 v52, 0
    v_mov_b32 v53, 0
    v_mov_b32 v54, 0
    v_mov_b32 v55, 0
    v_mov_b32 v56, 0
    v_mov_b32 v57, 0
    v_mov_b32 v58, 0
    v_mov_b32 v59, 0
    v_mov_b32 v60, 0
    v_mov_b32 v61, 0
    v_mov_b32 v62, 0
    v_mov_b32 v63, 0
    v_mov_b32 v64, 0
    v_mov_b32 v65, 0
    s_lshl_b32 s44, s21, 1
    s_add_u32 s44, s44, s24
    v_mov_b32 v68, 0
    v_mov_b32 v69, 0
    v_mov_b32 v70, 0
    v_mov_b32 v71, 0
    v_mov_b32 v72, 0
    v_mov_b32 v73, 0
    v_mov_b32 v74, 0
    v_mov_b32 v75, 0
    v_mov_b32 v76, 0
    v_mov_b32 v77, 0
    v_mov_b32 v78, 0
    v_mov_b32 v79, 0
    v_mov_b32 v80, 0
    v_mov_b32 v81, 0
    v_mov_b32 v82, 0
    v_mov_b32 v83, 0
    v_mov_b32 v84, 0
    v_mov_b32 v85, 0
    v_mov_b32 v86, 0
    v_mov_b32 v87, 0
    v_mov_b32 v88, 0
    v_mov_b32 v89, 0
    v_mov_b32 v90, 0
    v_mov_b32 v91, 0
    v_mov_b32 v92, 0
    v_mov_b32 v93, 0
    v_mov_b32 v94, 0
    v_mov_b32 v95, 0
    v_mov_b32 v96, 0
    v_mov_b32 v97, 0
    v_mov_b32 v98, 0
    v_mov_b32 v99, 0
    v_mov_b32 v100, 0
    v_mov_b32 v101, 0
    v_mov_b32 v102, 0
    v_mov_b32 v103, 0
    v_mov_b32 v104, 0
    v_mov_b32 v105, 0
    v_mov_b32 v106, 0
    v_mov_b32 v107, 0
    v_mov_b32 v108, 0
    v_mov_b32 v109, 0
    v_mov_b32 v110, 0
    v_mov_b32 v111, 0
    v_mov_b32 v112, 0
    v_mov_b32 v113, 0
    v_mov_b32 v114, 0
    v_mov_b32 v115, 0
    v_mov_b32 v13, v8
    v_mov_b32 v14, v9
    v_mov_b32 v18, v12
    s_mov_b32 s36, 0
    s_mov_b32 s38, 8
    s_barrier
    ds_read_b128 v[116:119], v13
    ds_read_b64_tr_b16 v[120:121], v18 offset:0
    ds_read_b64_tr_b16 v[122:123], v18 offset:512
    ds_read_b64_tr_b16 v[124:125], v18 offset:8192
    ds_read_b64_tr_b16 v[126:127], v18 offset:8704
    ds_read_b64_tr_b16 v[128:129], v18 offset:16384
    ds_read_b64_tr_b16 v[130:131], v18 offset:16896
    ds_read_b128 v[132:135], v14
    ds_read_b64_tr_b16 v[136:137], v18 offset:2048
    ds_read_b64_tr_b16 v[138:139], v18 offset:2560
    ds_read_b64_tr_b16 v[140:141], v18 offset:10240
    ds_read_b64_tr_b16 v[142:143], v18 offset:10752
    ds_read_b64_tr_b16 v[144:145], v18 offset:18432
    ds_read_b64_tr_b16 v[146:147], v18 offset:18944
    s_cmp_eq_u32 s22, 1
    s_cbranch_scc1 L_k0_kernel_loop1
    s_cmp_eq_u32 s22, 2
    s_cbranch_scc1 L_k0_kernel_loop2
    s_cmp_eq_u32 s22, 3
    s_cbranch_scc1 L_k0_kernel_loop3
L_k0_kernel_loop0:
    s_barrier
    s_add_u32 s37, s36, 32768
    s_and_b32 s37, s37, 131071
    v_add_u32 v15, s36, v10
    v_add_u32 v16, s36, v11
    v_add_u32 v17, s36, v12
    s_waitcnt lgkmcnt(7)
    ds_read_b128 v[148:151], v15
    ds_read_b64_tr_b16 v[152:153], v17 offset:4096
    ds_read_b64_tr_b16 v[154:155], v17 offset:4608
    ds_read_b64_tr_b16 v[156:157], v17 offset:12288
    ds_read_b64_tr_b16 v[158:159], v17 offset:12800
    ds_read_b64_tr_b16 v[160:161], v17 offset:20480
    ds_read_b64_tr_b16 v[162:163], v17 offset:20992
    v_mfma_f32_32x32x16_bf16 v[68:83], v[120:123], v[116:119], v[68:83]
    v_lshlrev_b32 v66, 16, v116
    v_and_b32 v67, 0xffff0000, v116
    v_add_f32 v64, v64, v66
    v_fmac_f32 v65, v66, v66
    v_add_f32 v64, v64, v67
    v_fmac_f32 v65, v67, v67
    v_mfma_f32_32x32x16_bf16 v[84:99], v[124:127], v[116:119], v[84:99]
    v_lshlrev_b32 v66, 16, v117
    v_and_b32 v67, 0xffff0000, v117
    v_add_f32 v64, v64, v66
    v_fmac_f32 v65, v66, v66
    v_add_f32 v64, v64, v67
    v_fmac_f32 v65, v67, v67
    v_mfma_f32_32x32x16_bf16 v[100:115], v[116:119], v[128:131], v[100:115]
    v_lshlrev_b32 v66, 16, v118
    v_and_b32 v67, 0xffff0000, v118
    v_add_f32 v64, v64, v66
    v_fmac_f32 v65, v66, v66
    v_add_f32 v64, v64, v67
    v_fmac_f32 v65, v67, v67
    v_mfma_f32_32x32x16_bf16 v[32:47], v[120:123], v[20:23], v[32:47]
    v_lshlrev_b32 v66, 16, v119
    v_and_b32 v67, 0xffff0000, v119
    v_add_f32 v64, v64, v66
    v_fmac_f32 v65, v66, v66
    v_add_f32 v64, v64, v67
    v_fmac_f32 v65, v67, v67
    v_mfma_f32_32x32x16_bf16 v[48:63], v[128:131], v[20:23], v[48:63]
    s_waitcnt lgkmcnt(7)
    ds_read_b128 v[164:167], v16
    ds_read_b64_tr_b16 v[168:169], v17 offset:6144
    ds_read_b64_tr_b16 v[170:171], v17 offset:6656
    ds_read_b64_tr_b16 v[172:173], v17 offset:14336
    ds_read_b64_tr_b16 v[174:175], v17 offset:14848
    ds_read_b64_tr_b16 v[176:177], v17 offset:22528
    ds_read_b64_tr_b16 v[178:179], v17 offset:23040
    v_mfma_f32_32x32x16_bf16 v[68:83], v[136:139], v[132:135], v[68:83]
    v_mfma_f32_32x32x16_bf16 v[84:99], v[140:143], v[132:135], v[84:99]
    v_mfma_f32_32x32x16_bf16 v[100:115], v[132:135], v[144:147], v[100:115]
    v_mfma_f32_32x32x16_bf16 v[32:47], v[136:139], v[20:23], v[32:47]
    s_waitcnt lgkmcnt(7)
    v_add_u32 v13, s37, v8
    v_add_u32 v14, s37, v9
    v_add_u32 v18, s37, v12
    ds_read_b128 v[116:119], v13
    ds_read_b64_tr_b16 v[120:121], v18 offset:0
    ds_read_b64_tr_b16 v[122:123], v18 offset:512
    ds_read_b64_tr_b16 v[124:125], v18 offset:8192
    ds_read_b64_tr_b16 v[126:127], v18 offset:8704
    ds_read_b64_tr_b16 v[128:129], v18 offset:16384
    ds_read_b64_tr_b16 v[130:131], v18 offset:16896
    v_mfma_f32_32x32x16_bf16 v[68:83], v[152:155], v[148:151], v[68:83]
    v_lshlrev_b32 v66, 16, v148
    v_and_b32 v67, 0xffff0000, v148
    v_add_f32 v64, v64, v66
    v_fmac_f32 v65, v66, v66
    v_add_f32 v64, v64, v67
    v_fmac_f32 v65, v67, v67
    v_mfma_f32_32x32x16_bf16 v[84:99], v[156:159], v[148:151], v[84:99]
    v_lshlrev_b32 v66, 16, v149
    v_and_b32 v67, 0xffff0000, v149
    v_add_f32 v64, v64, v66
    v_fmac_f32 v65, v66, v66
    v_add_f32 v64, v64, v67
    v_fmac_f32 v65, v67, v67
    v_mfma_f32_32x32x16_bf16 v[100:115], v[148:151], v[160:163], v[100:115]
    v_lshlrev_b32 v66, 16, v150
    v_and_b32 v67, 0xffff0000, v150
    v_add_f32 v64, v64, v66
    v_fmac_f32 v65, v66, v66
    v_add_f32 v64, v64, v67
    v_fmac_f32 v65, v67, v67
    v_mfma_f32_32x32x16_bf16 v[32:47], v[152:155], v[20:23], v[32:47]
    v_lshlrev_b32 v66, 16, v151
    v_and_b32 v67, 0xffff0000, v151
    v_add_f32 v64, v64, v66
    v_fmac_f32 v65, v66, v66
    v_add_f32 v64, v64, v67
    v_fmac_f32 v65, v67, v67
    v_mfma_f32_32x32x16_bf16 v[48:63], v[160:163], v[20:23], v[48:63]
    s_waitcnt lgkmcnt(7)
    ds_read_b128 v[132:135], v14
    ds_read_b64_tr_b16 v[136:137], v18 offset:2048
    ds_read_b64_tr_b16 v[138:139], v18 offset:2560
    ds_read_b64_tr_b16 v[140:141], v18 offset:10240
    ds_read_b64_tr_b16 v[142:143], v18 offset:10752
    ds_read_b64_tr_b16 v[144:145], v18 offset:18432
    ds_read_b64_tr_b16 v[146:147], v18 offset:18944
    v_mfma_f32_32x32x16_bf16 v[68:83], v[168:171], v[164:167], v[68:83]
    v_mfma_f32_32x32x16_bf16 v[84:99], v[172:175], v[164:167], v[84:99]
    v_mfma_f32_32x32x16_bf16 v[100:115], v[164:167], v[176:179], v[100:115]
    v_mfma_f32_32x32x16_bf16 v[32:47], v[168:171], v[20:23], v[32:47]
    s_mov_b32 s36, s37
    s_sub_u32 s38, s38, 1
    s_cmp_lg_u32 s38, 0
    s_cbranch_scc1 L_k0_kernel_loop0
    s_branch L_k0_kernel_loopend
L_k0_kernel_loop1:
    s_barrier
    s_add_u32 s37, s36, 32768
    s_and_b32 s37, s37, 131071
    v_add_u32 v15, s36, v10
    v_add_u32 v16, s36, v11
    v_add_u32 v17, s36, v12
    s_waitcnt lgkmcnt(7)
    ds_read_b128 v[148:151], v15
    ds_read_b64_tr_b16 v[152:153], v17 offset:4096
    ds_read_b64_tr_b16 v[154:155], v17 offset:4608
    ds_read_b64_tr_b16 v[156:157], v17 offset:12288
    ds_read_b64_tr_b16 v[158:159], v17 offset:12800
    ds_read_b64_tr_b16 v[160:161], v17 offset:20480
    ds_read_b64_tr_b16 v[162:163], v17 offset:20992
    v_mfma_f32_32x32x16_bf16 v[68:83], v[120:123], v[116:119], v[68:83]
    v_lshlrev_b32 v66, 16, v116
    v_and_b32 v67, 0xffff0000, v116
    v_add_f32 v64, v64, v66
    v_fmac_f32 v65, v66, v66
    v_add_f32 v64, v64, v67
    v_fmac_f32 v65, v67, v67
    v_mfma_f32_32x32x16_bf16 v[84:99], v[124:127], v[116:119], v[84:99]
    v_lshlrev_b32 v66, 16, v117
    v_and_b32 v67, 0xffff0000, v117
    v_add_f32 v64, v64, v66
    v_fmac_f32 v65, v66, v66
    v_add_f32 v64, v64, v67
    v_fmac_f32 v65, v67, v67
    v_mfma_f32_32x32x16_bf16 v[100:115], v[116:119], v[128:131], v[100:115]
    v_lshlrev_b32 v66, 16, v118
    v_and_b32 v67, 0xffff0000, v118
    v_add_f32 v64, v64, v66
    v_fmac_f32 v65, v66, v66
    v_add_f32 v64, v64, v67
    v_fmac_f32 v65, v67, v67
    v_mfma_f32_32x32x16_bf16 v[32:47], v[124:127], v[20:23], v[32:47]
    v_lshlrev_b32 v66, 16, v119
    v_and_b32 v67, 0xffff0000, v119
    v_add_f32 v64, v64, v66
    v_fmac_f32 v65, v66, v66
    v_add_f32 v64, v64, v67
    v_fmac_f32 v65, v67, v67
    s_waitcnt lgkmcnt(7)
    ds_read_b128 v[164:167], v16
    ds_read_b64_tr_b16 v[168:169], v17 offset:6144
    ds_read_b64_tr_b16 v[170:171], v17 offset:6656
    ds_read_b64_tr_b16 v[172:173], v17 offset:14336
    ds_read_b64_tr_b16 v[174:175], v17 offset:14848
    ds_read_b64_tr_b16 v[176:177], v17 offset:22528
    ds_read_b64_tr_b16 v[178:179], v17 offset:23040
    v_mfma_f32_32x32x16_bf16 v[68:83], v[136:139], v[132:135], v[68:83]
    v_mfma_f32_32x32x16_bf16 v[84:99], v[140:143], v[132:135], v[84:99]
    v_mfma_f32_32x32x16_bf16 v[100:115], v[132:135], v[144:147], v[100:115]
    v_mfma_f32_32x32x16_bf16 v[32:47], v[140:143], v[20:23], v[32:47]
    v_mfma_f32_32x32x16_bf16 v[48:63], v[144:147], v[20:23], v[48:63]
    s_waitcnt lgkmcnt(7)
    v_add_u32 v13, s37, v8
    v_add_u32 v14, s37, v9
    v_add_u32 v18, s37, v12
    ds_read_b128 v[116:119], v13
    ds_read_b64_tr_b16 v[120:121], v18 offset:0
    ds_read_b64_tr_b16 v[122:123], v18 offset:512
    ds_read_b64_tr_b16 v[124:125], v18 offset:8192
    ds_read_b64_tr_b16 v[126:127], v18 offset:8704
    ds_read_b64_tr_b16 v[128:129], v18 offset:16384
    ds_read_b64_tr_b16 v[130:131], v18 offset:16896
    v_mfma_f32_32x32x16_bf16 v[68:83], v[152:155], v[148:151], v[68:83]
    v_lshlrev_b32 v66, 16, v148
    v_and_b32 v67, 0xffff0000, v148
    v_add_f32 v64, v64, v66
    v_fmac_f32 v65, v66, v66
    v_add_f32 v64, v64, v67
    v_fmac_f32 v65, v67, v67
    v_mfma_f32_32x32x16_bf16 v[84:99], v[156:159], v[148:151], v[84:99]
    v_lshlrev_b32 v66, 16, v149
    v_and_b32 v67, 0xffff0000, v149
    v_add_f32 v64, v64, v66
    v_fmac_f32 v65, v66, v66
    v_add_f32 v64, v64, v67
    v_fmac_f32 v65, v67, v67
    v_mfma_f32_32x32x16_bf16 v[100:115], v[148:151], v[160:163], v[100:115]
    v_lshlrev_b32 v66, 16, v150
    v_and_b32 v67, 0xffff0000, v150
    v_add_f32 v64, v64, v66
    v_fmac_f32 v65, v66, v66
    v_add_f32 v64, v64, v67
    v_fmac_f32 v65, v67, v67
    v_mfma_f32_32x32x16_bf16 v[32:47], v[156:159], v[20:23], v[32:47]
    v_lshlrev_b32 v66, 16, v151
    v_and_b32 v67, 0xffff0000, v151
    v_add_f32 v64, v64, v66
    v_fmac_f32 v65, v66, v66
    v_add_f32 v64, v64, v67
    v_fmac_f32 v65, v67, v67
    s_waitcnt lgkmcnt(7)
    ds_read_b128 v[132:135], v14
    ds_read_b64_tr_b16 v[136:137], v18 offset:2048
    ds_read_b64_tr_b16 v[138:139], v18 offset:2560
    ds_read_b64_tr_b16 v[140:141], v18 offset:10240
    ds_read_b64_tr_b16 v[142:143], v18 offset:10752
    ds_read_b64_tr_b16 v[144:145], v18 offset:18432
    ds_read_b64_tr_b16 v[146:147], v18 offset:18944
    v_mfma_f32_32x32x16_bf16 v[68:83], v[168:171], v[164:167], v[68:83]
    v_mfma_f32_32x32x16_bf16 v[84:99], v[172:175], v[164:167], v[84:99]
    v_mfma_f32_32x32x16_bf16 v[100:115], v[164:167], v[176:179], v[100:115]
    v_mfma_f32_32x32x16_bf16 v[32:47], v[172:175], v[20:23], v[32:47]
    v_mfma_f32_32x32x16_bf16 v[48:63], v[176:179], v[20:23], v[48:63]
    s_mov_b32 s36, s37
    s_sub_u32 s38, s38, 1
    s_cmp_lg_u32 s38, 0
    s_cbranch_scc1 L_k0_kernel_loop1
    s_branch L_k0_kernel_loopend
L_k0_kernel_loop2:
    s_barrier
    s_add_u32 s37, s36, 32768
    s_and_b32 s37, s37, 131071
    v_add_u32 v15, s36, v10
    v_add_u32 v16, s36, v11
    v_add_u32 v17, s36, v12
    s_waitcnt lgkmcnt(7)
    ds_read_b128 v[148:151], v15
    ds_read_b64_tr_b16 v[152:153], v17 offset:4096
    ds_read_b64_tr_b16 v[154:155], v17 offset:4608
    ds_read_b64_tr_b16 v[156:157], v17 offset:12288
    ds_read_b64_tr_b16 v[158:159], v17 offset:12800
    ds_read_b64_tr_b16 v[160:161], v17 offset:20480
    ds_read_b64_tr_b16 v[162:163], v17 offset:20992
    v_mfma_f32_32x32x16_bf16 v[68:83], v[120:123], v[116:119], v[68:83]
    v_mfma_f32_32x32x16_bf16 v[84:99], v[124:127], v[116:119], v[84:99]
    v_mfma_f32_32x32x16_bf16 v[100:115], v[116:119], v[128:131], v[100:115]
    v_mfma_f32_32x32x16_bf16 v[32:47], v[120:123], v[20:23], v[32:47]
    v_mfma_f32_32x32x16_bf16 v[48:63], v[128:131], v[20:23], v[48:63]
    s_waitcnt lgkmcnt(7)
    ds_read_b128 v[164:167], v16
    ds_read_b64_tr_b16 v[168:169], v17 offset:6144
    ds_read_b64_tr_b16 v[170:171], v17 offset:6656
    ds_read_b64_tr_b16 v[172:173], v17 offset:14336
    ds_read_b64_tr_b16 v[174:175], v17 offset:14848
    ds_read_b64_tr_b16 v[176:177], v17 offset:22528
    ds_read_b64_tr_b16 v[178:179], v17 offset:23040
    v_mfma_f32_32x32x16_bf16 v[68:83], v[136:139], v[132:135], v[68:83]
    v_lshlrev_b32 v66, 16, v132
    v_and_b32 v67, 0xffff0000, v132
    v_add_f32 v64, v64, v66
    v_fmac_f32 v65, v66, v66
    v_add_f32 v64, v64, v67
    v_fmac_f32 v65, v67, v67
    v_mfma_f32_32x32x16_bf16 v[84:99], v[140:143], v[132:135], v[84:99]
    v_lshlrev_b32 v66, 16, v133
    v_and_b32 v67, 0xffff0000, v133
    v_add_f32 v64, v64, v66
    v_fmac_f32 v65, v66, v66
    v_add_f32 v64, v64, v67
    v_fmac_f32 v65, v67, v67
    v_mfma_f32_32x32x16_bf16 v[100:115], v[132:135], v[144:147], v[100:115]
    v_lshlrev_b32 v66, 16, v134
    v_and_b32 v67, 0xffff0000, v134
    v_add_f32 v64, v64, v66
    v_fmac_f32 v65, v66, v66
    v_add_f32 v64, v64, v67
    v_fmac_f32 v65, v67, v67
    v_mfma_f32_32x32x16_bf16 v[32:47], v[136:139], v[20:23], v[32:47]
    v_lshlrev_b32 v66, 16, v135
    v_and_b32 v67, 0xffff0000, v135
    v_add_f32 v64, v64, v66
    v_fmac_f32 v65, v66, v66
    v_add_f32 v64, v64, v67
    v_fmac_f32 v65, v67, v67
    s_waitcnt lgkmcnt(7)
    v_add_u32 v13, s37, v8
    v_add_u32 v14, s37, v9
    v_add_u32 v18, s37, v12
    ds_read_b128 v[116:119], v13
    ds_read_b64_tr_b16 v[120:121], v18 offset:0
    ds_read_b64_tr_b16 v[122:123], v18 offset:512
    ds_read_b64_tr_b16 v[124:125], v18 offset:8192
    ds_read_b64_tr_b16 v[126:127], v18 offset:8704
    ds_read_b64_tr_b16 v[128:129], v18 offset:16384
    ds_read_b64_tr_b16 v[130:131], v18 offset:16896
    v_mfma_f32_32x32x16_bf16 v[68:83], v[152:155], v[148:151], v[68:83]
    v_mfma_f32_32x32x16_bf16 v[84:99], v[156:159], v[148:151], v[84:99]
    v_mfma_f32_32x32x16_bf16 v[100:115], v[148:151], v[160:163], v[100:115]
    v_mfma_f32_32x32x16_bf16 v[32:47], v[152:155], v[20:23], v[32:47]
    v_mfma_f32_32x32x16_bf16 v[48:63], v[160:163], v[20:23], v[48:63]
    s_waitcnt lgkmcnt(7)
    ds_read_b128 v[132:135], v14
    ds_read_b64_tr_b16 v[136:137], v18 offset:2048
    ds_read_b64_tr_b16 v[138:139], v18 offset:2560
    ds_read_b64_tr_b16 v[140:141], v18 offset:10240
    ds_read_b64_tr_b16 v[142:143], v18 offset:10752
    ds_read_b64_tr_b16 v[144:145], v18 offset:18432
    ds_read_b64_tr_b16 v[146:147], v18 offset:18944
    v_mfma_f32_32x32x16_bf16 v[68:83], v[168:171], v[164:167], v[68:83]
    v_lshlrev_b32 v66, 16, v164
    v_and_b32 v67, 0xffff0000, v164
    v_add_f32 v64, v64, v66
    v_fmac_f32 v65, v66, v66
    v_add_f32 v64, v64, v67
    v_fmac_f32 v65, v67, v67
    v_mfma_f32_32x32x16_bf16 v[84:99], v[172:175], v[164:167], v[84:99]
    v_lshlrev_b32 v66, 16, v165
    v_and_b32 v67, 0xffff0000, v165
    v_add_f32 v64, v64, v66
    v_fmac_f32 v65, v66, v66
    v_add_f32 v64, v64, v67
    v_fmac_f32 v65, v67, v67
    v_mfma_f32_32x32x16_bf16 v[100:115], v[164:167], v[176:179], v[100:115]
    v_lshlrev_b32 v66, 16, v166
    v_and_b32 v67, 0xffff0000, v166
    v_add_f32 v64, v64, v66
    v_fmac_f32 v65, v66, v66
    v_add_f32 v64, v64, v67
    v_fmac_f32 v65, v67, v67
    v_mfma_f32_32x32x16_bf16 v[32:47], v[168:171], v[20:23], v[32:47]
    v_lshlrev_b32 v66, 16, v167
    v_and_b32 v67, 0xffff0000, v167
    v_add_f32 v64, v64, v66
    v_fmac_f32 v65, v66, v66
    v_add_f32 v64, v64, v67
    v_fmac_f32 v65, v67, v67
    s_mov_b32 s36, s37
    s_sub_u32 s38, s38, 1
    s_cmp_lg_u32 s38, 0
    s_cbranch_scc1 L_k0_kernel_loop2
    s_branch L_k0_kernel_loopend
L_k0_kernel_loop3:
    s_barrier
    s_add_u32 s37, s36, 32768
    s_and_b32 s37, s37, 131071
    v_add_u32 v15, s36, v10
    v_add_u32 v16, s36, v11
    v_add_u32 v17, s36, v12
    s_waitcnt lgkmcnt(7)
    ds_read_b128 v[148:151], v15
    ds_read_b64_tr_b16 v[152:153], v17 offset:4096
    ds_read_b64_tr_b16 v[154:155], v17 offset:4608
    ds_read_b64_tr_b16 v[156:157], v17 offset:12288
    ds_read_b64_tr_b16 v[158:159], v17 offset:12800
    ds_read_b64_tr_b16 v[160:161], v17 offset:20480
    ds_read_b64_tr_b16 v[162:163], v17 offset:20992
    v_mfma_f32_32x32x16_bf16 v[68:83], v[120:123], v[116:119], v[68:83]
    v_mfma_f32_32x32x16_bf16 v[84:99], v[124:127], v[116:119], v[84:99]
    v_mfma_f32_32x32x16_bf16 v[100:115], v[116:119], v[128:131], v[100:115]
    v_mfma_f32_32x32x16_bf16 v[32:47], v[124:127], v[20:23], v[32:47]
    s_waitcnt lgkmcnt(7)
    ds_read_b128 v[164:167], v16
    ds_read_b64_tr_b16 v[168:169], v17 offset:6144
    ds_read_b64_tr_b16 v[170:171], v17 offset:6656
    ds_read_b64_tr_b16 v[172:173], v17 offset:14336
    ds_read_b64_tr_b16 v[174:175], v17 offset:14848
    ds_read_b64_tr_b16 v[176:177], v17 offset:22528
    ds_read_b64_tr_b16 v[178:179], v17 offset:23040
    v_mfma_f32_32x32x16_bf16 v[68:83], v[136:139], v[132:135], v[68:83]
    v_lshlrev_b32 v66, 16, v132
    v_and_b32 v67, 0xffff0000, v132
    v_add_f32 v64, v64, v66
    v_fmac_f32 v65, v66, v66
    v_add_f32 v64, v64, v67
    v_fmac_f32 v65, v67, v67
    v_mfma_f32_32x32x16_bf16 v[84:99], v[140:143], v[132:135], v[84:99]
    v_lshlrev_b32 v66, 16, v133
    v_and_b32 v67, 0xffff0000, v133
    v_add_f32 v64, v64, v66
    v_fmac_f32 v65, v66, v66
    v_add_f32 v64, v64, v67
    v_fmac_f32 v65, v67, v67
    v_mfma_f32_32x32x16_bf16 v[100:115], v[132:135], v[144:147], v[100:115]
    v_lshlrev_b32 v66, 16, v134
    v_and_b32 v67, 0xffff0000, v134
    v_add_f32 v64, v64, v66
    v_fmac_f32 v65, v66, v66
    v_add_f32 v64, v64, v67
    v_fmac_f32 v65, v67, v67
    v_mfma_f32_32x32x16_bf16 v[32:47], v[140:143], v[20:23], v[32:47]
    v_lshlrev_b32 v66, 16, v135
    v_and_b32 v67, 0xffff0000, v135
    v_add_f32 v64, v64, v66
    v_fmac_f32 v65, v66, v66
    v_add_f32 v64, v64, v67
    v_fmac_f32 v65, v67, v67
    v_mfma_f32_32x32x16_bf16 v[48:63], v[144:147], v[20:23], v[48:63]
    s_waitcnt lgkmcnt(7)
    v_add_u32 v13, s37, v8
    v_add_u32 v14, s37, v9
    v_add_u32 v18, s37, v12
    ds_read_b128 v[116:119], v13
    ds_read_b64_tr_b16 v[120:121], v18 offset:0
    ds_read_b64_tr_b16 v[122:123], v18 offset:512
    ds_read_b64_tr_b16 v[124:125], v18 offset:8192
    ds_read_b64_tr_b16 v[126:127], v18 offset:8704
    ds_read_b64_tr_b16 v[128:129], v18 offset:16384
    ds_read_b64_tr_b16 v[130:131], v18 offset:16896
    v_mfma_f32_32x32x16_bf16 v[68:83], v[152:155], v[148:151], v[68:83]
    v_mfma_f32_32x32x16_bf16 v[84:99], v[156:159], v[148:151], v[84:99]
    v_mfma_f32_32x32x16_bf16 v[100:115], v[148:151], v[160:163], v[100:115]
    v_mfma_f32_32x32x16_bf16 v[32:47], v[156:159], v[20:23], v[32:47]
    s_waitcnt lgkmcnt(7)
    ds_read_b128 v[132:135], v14
    ds_read_b64_tr_b16 v[136:137], v18 offset:2048
    ds_read_b64_tr_b16 v[138:139], v18 offset:2560
    ds_read_b64_tr_b16 v[140:141], v18 offset:10240
    ds_read_b64_tr_b16 v[142:143], v18 offset:10752
    ds_read_b64_tr_b16 v[144:145], v18 offset:18432
    ds_read_b64_tr_b16 v[146:147], v18 offset:18944
    v_mfma_f32_32x32x16_bf16 v[68:83], v[168:171], v[164:167], v[68:83]
    v_lshlrev_b32 v66, 16, v164
    v_and_b32 v67, 0xffff0000, v164
    v_add_f32 v64, v64, v66
    v_fmac_f32 v65, v66, v66
    v_add_f32 v64, v64, v67
    v_fmac_f32 v65, v67, v67
    v_mfma_f32_32x32x16_bf16 v[84:99], v[172:175], v[164:167], v[84:99]
    v_lshlrev_b32 v66, 16, v165
    v_and_b32 v67, 0xffff0000, v165
    v_add_f32 v64, v64, v66
    v_fmac_f32 v65, v66, v66
    v_add_f32 v64, v64, v67
    v_fmac_f32 v65, v67, v67
    v_mfma_f32_32x32x16_bf16 v[100:115], v[164:167], v[176:179], v[100:115]
    v_lshlrev_b32 v66, 16, v166
    v_and_b32 v67, 0xffff0000, v166
    v_add_f32 v64, v64, v66
    v_fmac_f32 v65, v66, v66
    v_add_f32 v64, v64, v67
    v_fmac_f32 v65, v67, v67
    v_mfma_f32_32x32x16_bf16 v[32:47], v[172:175], v[20:23], v[32:47]
    v_lshlrev_b32 v66, 16, v167
    v_and_b32 v67, 0xffff0000, v167
    v_add_f32 v64, v64, v66
    v_fmac_f32 v65, v66, v66
    v_add_f32 v64, v64, v67
    v_fmac_f32 v65, v67, v67
    v_mfma_f32_32x32x16_bf16 v[48:63], v[176:179], v[20:23], v[48:63]
    s_mov_b32 s36, s37
    s_sub_u32 s38, s38, 1
    s_cmp_lg_u32 s38, 0
    s_cbranch_scc1 L_k0_kernel_loop3
L_k0_kernel_loopend:
    s_waitcnt lgkmcnt(0)
    s_lshl_b32 s30, s22, 8
    s_add_u32 s30, s30, 150528
    v_lshrrev_b32 v2, 5, v0
    v_lshlrev_b32 v2, 4, v2
    v_add_u32 v3, s30, v2
    s_nop 15
    s_mov_b64 s[40:41], exec
    s_mov_b32 exec_lo, 1
    s_mov_b32 exec_hi, 1
    ds_write_b128 v3, v[32:35] offset:0
    ds_write_b128 v3, v[36:39] offset:32
    ds_write_b128 v3, v[40:43] offset:64
    ds_write_b128 v3, v[44:47] offset:96
    ds_write_b128 v3, v[48:51] offset:128
    ds_write_b128 v3, v[52:55] offset:160
    ds_write_b128 v3, v[56:59] offset:192
    ds_write_b128 v3, v[60:63] offset:224
    s_mov_b64 exec, s[40:41]
    v_mov_b32 v4, v64
    v_mov_b32 v5, v65
    s_nop 1
    v_permlane32_swap_b32 v64, v4
    v_permlane32_swap_b32 v65, v5
    s_nop 1
    v_add_f32 v64, v64, v4
    v_add_f32 v65, v65, v5
    v_and_b32 v4, 31, v0
    s_lshl_b32 s30, s23, 5
    v_add_u32 v4, s30, v4
    v_lshlrev_b32 v4, 3, v4
    s_lshl_b32 s30, s24, 9
    s_add_u32 s30, s30, 149504
    v_add_u32 v4, s30, v4
    ds_write_b64 v4, v[64:65]
    s_waitcnt lgkmcnt(0)
    s_barrier
    s_lshl_b32 s30, s24, 9
    s_add_u32 s30, s30, 150528
    v_add_u32 v3, s30, v2
    v_and_b32 v4, 31, v0
    v_lshlrev_b32 v5, 2, v4
    v_add_u32 v5, s30, v5
    s_lshl_b32 s30, s23, 5
    v_add_u32 v4, s30, v4
    v_lshlrev_b32 v4, 3, v4
    v_add_u32 v4, 149504, v4
    ds_read_b64 v[28:29], v4
    ds_read_b64 v[30:31], v4 offset:512
    ds_read_b32 v220, v5 offset:128
    ds_read_b32 v221, v5 offset:384
    ds_read_b128 v[180:183], v3 offset:0
    ds_read_b128 v[196:199], v3 offset:256
    ds_read_b128 v[184:187], v3 offset:32
    ds_read_b128 v[200:203], v3 offset:288
    ds_read_b128 v[188:191], v3 offset:64
    ds_read_b128 v[204:207], v3 offset:320
    ds_read_b128 v[192:195], v3 offset:96
    ds_read_b128 v[208:211], v3 offset:352
    s_waitcnt lgkmcnt(0)
    v_add_f32 v220, v220, v221
    v_add_f32 v28, v28, v30
    v_add_f32 v29, v29, v31
    v_mul_f32 v28, 0x3b000000, v28
    v_mul_f32 v29, 0x3b000000, v29
    v_fma_f32 v29, -v28, v28, v29
    v_max_f32 v29, 0, v29
    v_add_f32 v24, 0x3727c5ac, v29
    v_rsq_f32 v24, v24
    s_nop 0
    v_mul_f32_e64 v25, -v28, v24
    v_mul_f32 v26, 0x3eb8aa3b, v24
    v_mul_f32 v27, 0x3eb8aa3b, v25
    s_lshl_b32 s30, s22, 8
    s_add_u32 s30, s30, 147456
    v_and_b32 v2, 31, v0
    v_lshlrev_b32 v2, 2, v2
    v_add_u32 v2, s30, v2
    ds_write_b32 v2, v24
    ds_write_b32 v2, v25 offset:128
    v_lshrrev_b32 v3, 5, v0
    v_lshlrev_b32 v3, 4, v3
    v_add_u32 v3, s30, v3
    s_waitcnt lgkmcnt(0)
    ds_read_b128 v[116:119], v3 offset:0
    ds_read_b128 v[132:135], v3 offset:128
    ds_read_b128 v[120:123], v3 offset:32
    ds_read_b128 v[136:139], v3 offset:160
    ds_read_b128 v[124:127], v3 offset:64
    ds_read_b128 v[140:143], v3 offset:192
    ds_read_b128 v[128:131], v3 offset:96
    ds_read_b128 v[144:147], v3 offset:224
    s_lshl_b32 s30, s44, 17
    s_lshl_b32 s31, s28, 10
    s_add_u32 s32, s30, s31
    v_lshlrev_b32 v19, 4, v0
    v_pk_mul_f32 v[180:181], v[180:181], v[26:27] op_sel:[0,1] op_sel_hi:[1,1]
    v_pk_mul_f32 v[182:183], v[182:183], v[26:27] op_sel:[0,1] op_sel_hi:[1,1]
    v_pk_mul_f32 v[184:185], v[184:185], v[26:27] op_sel:[0,1] op_sel_hi:[1,1]
    v_pk_mul_f32 v[186:187], v[186:187], v[26:27] op_sel:[0,1] op_sel_hi:[1,1]
    v_pk_mul_f32 v[188:189], v[188:189], v[26:27] op_sel:[0,1] op_sel_hi:[1,1]
    v_pk_mul_f32 v[190:191], v[190:191], v[26:27] op_sel:[0,1] op_sel_hi:[1,1]
    v_pk_mul_f32 v[192:193], v[192:193], v[26:27] op_sel:[0,1] op_sel_hi:[1,1]
    v_pk_mul_f32 v[194:195], v[194:195], v[26:27] op_sel:[0,1] op_sel_hi:[1,1]
    v_pk_fma_f32 v[68:69], v[68:69], v[26:27], v[180:181] op_sel:[0,0,0] op_sel_hi:[1,0,1]
    v_pk_fma_f32 v[70:71], v[70:71], v[26:27], v[182:183] op_sel:[0,0,0] op_sel_hi:[1,0,1]
    v_pk_fma_f32 v[72:73], v[72:73], v[26:27], v[184:185] op_sel:[0,0,0] op_sel_hi:[1,0,1]
    v_pk_fma_f32 v[74:75], v[74:75], v[26:27], v[186:187] op_sel:[0,0,0] op_sel_hi:[1,0,1]
    v_pk_fma_f32 v[76:77], v[76:77], v[26:27], v[188:189] op_sel:[0,0,0] op_sel_hi:[1,0,1]
    v_pk_fma_f32 v[78:79], v[78:79], v[26:27], v[190:191] op_sel:[0,0,0] op_sel_hi:[1,0,1]
    v_pk_fma_f32 v[80:81], v[80:81], v[26:27], v[192:193] op_sel:[0,0,0] op_sel_hi:[1,0,1]
    v_pk_fma_f32 v[82:83], v[82:83], v[26:27], v[194:195] op_sel:[0,0,0] op_sel_hi:[1,0,1]
    v_cvt_pk_bf16_f32 v212, v68, v69
    v_cvt_pk_bf16_f32 v213, v70, v71
    v_cvt_pk_bf16_f32 v214, v72, v73
    v_cvt_pk_bf16_f32 v215, v74, v75
    v_cvt_pk_bf16_f32 v216, v76, v77
    v_cvt_pk_bf16_f32 v217, v78, v79
    v_cvt_pk_bf16_f32 v218, v80, v81
    v_cvt_pk_bf16_f32 v219, v82, v83
    s_add_u32 s34, s32, 6291456
    s_add_u32 s35, s32, 6356992
    buffer_store_dwordx4 v[212:215], v19, s[12:15], s34 offen sc1
    buffer_store_dwordx4 v[216:219], v19, s[12:15], s35 offen sc1
    s_nop 1
    v_pk_mul_f32 v[196:197], v[196:197], v[24:25] op_sel:[0,1] op_sel_hi:[1,1]
    v_pk_mul_f32 v[198:199], v[198:199], v[24:25] op_sel:[0,1] op_sel_hi:[1,1]
    v_pk_mul_f32 v[200:201], v[200:201], v[24:25] op_sel:[0,1] op_sel_hi:[1,1]
    v_pk_mul_f32 v[202:203], v[202:203], v[24:25] op_sel:[0,1] op_sel_hi:[1,1]
    v_pk_mul_f32 v[204:205], v[204:205], v[24:25] op_sel:[0,1] op_sel_hi:[1,1]
    v_pk_mul_f32 v[206:207], v[206:207], v[24:25] op_sel:[0,1] op_sel_hi:[1,1]
    v_pk_mul_f32 v[208:209], v[208:209], v[24:25] op_sel:[0,1] op_sel_hi:[1,1]
    v_pk_mul_f32 v[210:211], v[210:211], v[24:25] op_sel:[0,1] op_sel_hi:[1,1]
    v_pk_fma_f32 v[84:85], v[84:85], v[24:25], v[196:197] op_sel:[0,0,0] op_sel_hi:[1,0,1]
    v_pk_fma_f32 v[86:87], v[86:87], v[24:25], v[198:199] op_sel:[0,0,0] op_sel_hi:[1,0,1]
    v_pk_fma_f32 v[88:89], v[88:89], v[24:25], v[200:201] op_sel:[0,0,0] op_sel_hi:[1,0,1]
    v_pk_fma_f32 v[90:91], v[90:91], v[24:25], v[202:203] op_sel:[0,0,0] op_sel_hi:[1,0,1]
    v_pk_fma_f32 v[92:93], v[92:93], v[24:25], v[204:205] op_sel:[0,0,0] op_sel_hi:[1,0,1]
    v_pk_fma_f32 v[94:95], v[94:95], v[24:25], v[206:207] op_sel:[0,0,0] op_sel_hi:[1,0,1]
    v_pk_fma_f32 v[96:97], v[96:97], v[24:25], v[208:209] op_sel:[0,0,0] op_sel_hi:[1,0,1]
    v_pk_fma_f32 v[98:99], v[98:99], v[24:25], v[210:211] op_sel:[0,0,0] op_sel_hi:[1,0,1]
    v_cvt_pk_bf16_f32 v212, v84, v85
    v_cvt_pk_bf16_f32 v213, v86, v87
    v_cvt_pk_bf16_f32 v214, v88, v89
    v_cvt_pk_bf16_f32 v215, v90, v91
    v_cvt_pk_bf16_f32 v216, v92, v93
    v_cvt_pk_bf16_f32 v217, v94, v95
    v_cvt_pk_bf16_f32 v218, v96, v97
    v_cvt_pk_bf16_f32 v219, v98, v99
    s_add_u32 s34, s32, 8388608
    s_add_u32 s35, s32, 8454144
    buffer_store_dwordx4 v[212:215], v19, s[12:15], s34 offen sc1
    buffer_store_dwordx4 v[216:219], v19, s[12:15], s35 offen sc1
    s_nop 1
    v_pk_mul_f32 v[2:3], v[84:85], v[84:85]
    v_pk_mul_f32 v[4:5], v[92:93], v[92:93]
    v_pk_fma_f32 v[2:3], v[86:87], v[86:87], v[2:3]
    v_pk_fma_f32 v[4:5], v[94:95], v[94:95], v[4:5]
    v_pk_fma_f32 v[2:3], v[88:89], v[88:89], v[2:3]
    v_pk_fma_f32 v[4:5], v[96:97], v[96:97], v[4:5]
    v_pk_fma_f32 v[2:3], v[90:91], v[90:91], v[2:3]
    v_pk_fma_f32 v[4:5], v[98:99], v[98:99], v[4:5]
    v_add_f32 v2, v2, v3
    v_add_f32 v3, v4, v5
    s_nop 1
    v_permlane32_swap_b32 v2, v3
    s_nop 1
    v_add_f32 v2, v2, v3
    s_nop 1
    v_max_f32_dpp v2, v2, v2 row_ror:8 row_mask:0xf bank_mask:0xf
    s_nop 1
    v_max_f32_dpp v2, v2, v2 row_ror:4 row_mask:0xf bank_mask:0xf
    s_nop 1
    v_max_f32_dpp v2, v2, v2 row_ror:2 row_mask:0xf bank_mask:0xf
    s_nop 1
    v_max_f32_dpp v2, v2, v2 row_ror:1 row_mask:0xf bank_mask:0xf
    v_mov_b32 v3, v2
    s_nop 1
    v_permlane16_swap_b32 v2, v3
    s_nop 1
    v_max_f32 v2, v2, v3
    s_lshl_b32 s30, s44, 9
    s_lshl_b32 s31, s28, 2
    s_add_u32 s30, s30, s31
    s_add_u32 s30, s30, 0
    v_lshrrev_b32 v3, 5, v0
    v_lshlrev_b32 v3, 8, v3
    s_mov_b64 s[40:41], exec
    s_mov_b32 exec_lo, 1
    s_mov_b32 exec_hi, 1
    buffer_store_dword v2, v3, s[12:15], s30 offen
    s_mov_b64 exec, s[40:41]
    s_waitcnt lgkmcnt(0)
    v_pk_mul_f32 v[132:133], v[132:133], v[220:221] op_sel:[0,0] op_sel_hi:[1,0]
    v_pk_mul_f32 v[134:135], v[134:135], v[220:221] op_sel:[0,0] op_sel_hi:[1,0]
    v_pk_mul_f32 v[136:137], v[136:137], v[220:221] op_sel:[0,0] op_sel_hi:[1,0]
    v_pk_mul_f32 v[138:139], v[138:139], v[220:221] op_sel:[0,0] op_sel_hi:[1,0]
    v_pk_mul_f32 v[140:141], v[140:141], v[220:221] op_sel:[0,0] op_sel_hi:[1,0]
    v_pk_mul_f32 v[142:143], v[142:143], v[220:221] op_sel:[0,0] op_sel_hi:[1,0]
    v_pk_mul_f32 v[144:145], v[144:145], v[220:221] op_sel:[0,0] op_sel_hi:[1,0]
    v_pk_mul_f32 v[146:147], v[146:147], v[220:221] op_sel:[0,0] op_sel_hi:[1,0]
    v_pk_fma_f32 v[100:101], v[100:101], v[116:117], v[132:133]
    v_pk_fma_f32 v[102:103], v[102:103], v[118:119], v[134:135]
    v_pk_fma_f32 v[104:105], v[104:105], v[120:121], v[136:137]
    v_pk_fma_f32 v[106:107], v[106:107], v[122:123], v[138:139]
    v_pk_fma_f32 v[108:109], v[108:109], v[124:125], v[140:141]
    v_pk_fma_f32 v[110:111], v[110:111], v[126:127], v[142:143]
    v_pk_fma_f32 v[112:113], v[112:113], v[128:129], v[144:145]
    v_pk_fma_f32 v[114:115], v[114:115], v[130:131], v[146:147]
    v_cvt_pk_bf16_f32 v212, v100, v101
    v_cvt_pk_bf16_f32 v213, v102, v103
    v_cvt_pk_bf16_f32 v214, v104, v105
    v_cvt_pk_bf16_f32 v215, v106, v107
    v_cvt_pk_bf16_f32 v216, v108, v109
    v_cvt_pk_bf16_f32 v217, v110, v111
    v_cvt_pk_bf16_f32 v218, v112, v113
    v_cvt_pk_bf16_f32 v219, v114, v115
    s_nop 1
    v_permlane32_swap_b32 v212, v214
    v_permlane32_swap_b32 v213, v215
    v_permlane32_swap_b32 v216, v218
    v_permlane32_swap_b32 v217, v219
    v_bfe_u32 v2, v0, 4, 1
    v_lshlrev_b32 v2, 16, v2
    v_lshrrev_b32 v3, 5, v0
    v_lshl_add_u32 v2, v3, 8, v2
    v_and_b32 v3, 15, v0
    v_lshl_add_u32 v2, v3, 4, v2
    s_add_u32 s30, s32, 10485760
    buffer_store_dwordx4 v[212:215], v2, s[12:15], s30 offen sc1
    buffer_store_dwordx4 v[216:219], v2, s[12:15], s30 offen offset:512 sc1
    s_endpgm
L_k0_kernel_ld:
    s_mov_b32 s43, s20
    v_lshrrev_b32 v8, 3, v0
    v_and_b32 v9, 7, v0
    v_lshrrev_b32 v10, 1, v8
    s_lshl_b32 s30, s20, 6
    s_lshl_b32 s31, s25, 4
    s_add_u32 s30, s30, s31
    v_add_u32 v11, s30, v8
    v_lshlrev_b32 v11, 10, v11
    v_xor_b32 v12, v9, v10
    v_lshl_add_u32 v2, v12, 4, v11
    v_xor_b32 v12, 4, v12
    v_lshl_add_u32 v3, v12, 4, v11
    v_add_u32 v3, 8192, v3
    s_lshl_b32 s31, s25, 4
    v_add_u32 v11, s31, v8
    v_mul_u32_u24 v11, 3072, v11
    v_and_b32 v10, 1, v10
    v_lshlrev_b32 v10, 2, v10
    v_xor_b32 v12, v9, v10
    v_lshl_add_u32 v4, v12, 4, v11
    s_lshl_b32 s30, s21, 7
    v_add_u32 v4, s30, v4
    v_add_u32 v5, 24576, v4
    s_lshl_b32 s27, s25, 11
    s_add_u32 s30, s43, 0
    s_and_b32 s30, s30, 7
    s_lshl_b32 s31, s30, 7
    s_mul_i32 s32, s30, 196608
    s_add_u32 m0, s27, 0
    s_nop 0
    buffer_load_dwordx4 v2, s[8:11], s31 offen lds
    s_add_u32 m0, s27, 1024
    s_nop 0
    buffer_load_dwordx4 v3, s[8:11], s31 offen lds
    s_add_u32 s26, s32, 0
    s_add_u32 m0, s27, 8192
    s_nop 0
    buffer_load_dwordx4 v4, s[16:19], s26 offen lds
    s_add_u32 m0, s27, 9216
    s_nop 0
    buffer_load_dwordx4 v5, s[16:19], s26 offen lds
    s_add_u32 s26, s32, 1024
    s_add_u32 m0, s27, 16384
    s_nop 0
    buffer_load_dwordx4 v4, s[16:19], s26 offen lds
    s_add_u32 m0, s27, 17408
    s_nop 0
    buffer_load_dwordx4 v5, s[16:19], s26 offen lds
    s_add_u32 s26, s32, 2048
    s_add_u32 m0, s27, 24576
    s_nop 0
    buffer_load_dwordx4 v4, s[16:19], s26 offen lds
    s_add_u32 m0, s27, 25600
    s_nop 0
    buffer_load_dwordx4 v5, s[16:19], s26 offen lds
    s_add_u32 s30, s43, 1
    s_and_b32 s30, s30, 7
    s_lshl_b32 s31, s30, 7
    s_mul_i32 s32, s30, 196608
    s_add_u32 m0, s27, 32768
    s_nop 0
    buffer_load_dwordx4 v2, s[8:11], s31 offen lds
    s_add_u32 m0, s27, 33792
    s_nop 0
    buffer_load_dwordx4 v3, s[8:11], s31 offen lds
    s_add_u32 s26, s32, 0
    s_add_u32 m0, s27, 40960
    s_nop 0
    buffer_load_dwordx4 v4, s[16:19], s26 offen lds
    s_add_u32 m0, s27, 41984
    s_nop 0
    buffer_load_dwordx4 v5, s[16:19], s26 offen lds
    s_add_u32 s26, s32, 1024
    s_add_u32 m0, s27, 49152
    s_nop 0
    buffer_load_dwordx4 v4, s[16:19], s26 offen lds
    s_add_u32 m0, s27, 50176
    s_nop 0
    buffer_load_dwordx4 v5, s[16:19], s26 offen lds
    s_add_u32 s26, s32, 2048
    s_add_u32 m0, s27, 57344
    s_nop 0
    buffer_load_dwordx4 v4, s[16:19], s26 offen lds
    s_add_u32 m0, s27, 58368
    s_nop 0
    buffer_load_dwordx4 v5, s[16:19], s26 offen lds
    s_add_u32 s30, s43, 2
    s_and_b32 s30, s30, 7
    s_lshl_b32 s31, s30, 7
    s_mul_i32 s32, s30, 196608
    s_add_u32 m0, s27, 65536
    s_nop 0
    buffer_load_dwordx4 v2, s[8:11], s31 offen lds
    s_add_u32 m0, s27, 66560
    s_nop 0
    buffer_load_dwordx4 v3, s[8:11], s31 offen lds
    s_add_u32 s26, s32, 0
    s_add_u32 m0, s27, 73728
    s_nop 0
    buffer_load_dwordx4 v4, s[16:19], s26 offen lds
    s_add_u32 m0, s27, 74752
    s_nop 0
    buffer_load_dwordx4 v5, s[16:19], s26 offen lds
    s_add_u32 s26, s32, 1024
    s_add_u32 m0, s27, 81920
    s_nop 0
    buffer_load_dwordx4 v4, s[16:19], s26 offen lds
    s_add_u32 m0, s27, 82944
    s_nop 0
    buffer_load_dwordx4 v5, s[16:19], s26 offen lds
    s_add_u32 s26, s32, 2048
    s_add_u32 m0, s27, 90112
    s_nop 0
    buffer_load_dwordx4 v4, s[16:19], s26 offen lds
    s_add_u32 m0, s27, 91136
    s_nop 0
    buffer_load_dwordx4 v5, s[16:19], s26 offen lds
    s_waitcnt vmcnt(16)
    s_barrier
    s_add_u32 s30, s43, 3
    s_and_b32 s30, s30, 7
    s_lshl_b32 s31, s30, 7
    s_mul_i32 s32, s30, 196608
    s_add_u32 m0, s27, 98304
    s_nop 0
    buffer_load_dwordx4 v2, s[8:11], s31 offen lds
    s_add_u32 m0, s27, 99328
    s_nop 0
    buffer_load_dwordx4 v3, s[8:11], s31 offen lds
    s_add_u32 s26, s32, 0
    s_add_u32 m0, s27, 106496
    s_nop 0
    buffer_load_dwordx4 v4, s[16:19], s26 offen lds
    s_add_u32 m0, s27, 107520
    s_nop 0
    buffer_load_dwordx4 v5, s[16:19], s26 offen lds
    s_add_u32 s26, s32, 1024
    s_add_u32 m0, s27, 114688
    s_nop 0
    buffer_load_dwordx4 v4, s[16:19], s26 offen lds
    s_add_u32 m0, s27, 115712
    s_nop 0
    buffer_load_dwordx4 v5, s[16:19], s26 offen lds
    s_add_u32 s26, s32, 2048
    s_add_u32 m0, s27, 122880
    s_nop 0
    buffer_load_dwordx4 v4, s[16:19], s26 offen lds
    s_add_u32 m0, s27, 123904
    s_nop 0
    buffer_load_dwordx4 v5, s[16:19], s26 offen lds
    s_waitcnt vmcnt(16)
    s_barrier
    s_waitcnt vmcnt(8)
    s_barrier
    s_add_u32 s30, s43, 4
    s_and_b32 s30, s30, 7
    s_lshl_b32 s31, s30, 7
    s_mul_i32 s32, s30, 196608
    s_add_u32 m0, s27, 0
    s_nop 0
    buffer_load_dwordx4 v2, s[8:11], s31 offen lds
    s_add_u32 m0, s27, 1024
    s_nop 0
    buffer_load_dwordx4 v3, s[8:11], s31 offen lds
    s_add_u32 s26, s32, 0
    s_add_u32 m0, s27, 8192
    s_nop 0
    buffer_load_dwordx4 v4, s[16:19], s26 offen lds
    s_add_u32 m0, s27, 9216
    s_nop 0
    buffer_load_dwordx4 v5, s[16:19], s26 offen lds
    s_add_u32 s26, s32, 1024
    s_add_u32 m0, s27, 16384
    s_nop 0
    buffer_load_dwordx4 v4, s[16:19], s26 offen lds
    s_add_u32 m0, s27, 17408
    s_nop 0
    buffer_load_dwordx4 v5, s[16:19], s26 offen lds
    s_add_u32 s26, s32, 2048
    s_add_u32 m0, s27, 24576
    s_nop 0
    buffer_load_dwordx4 v4, s[16:19], s26 offen lds
    s_add_u32 m0, s27, 25600
    s_nop 0
    buffer_load_dwordx4 v5, s[16:19], s26 offen lds
    s_waitcnt vmcnt(8)
    s_barrier
    s_add_u32 s30, s43, 5
    s_and_b32 s30, s30, 7
    s_lshl_b32 s31, s30, 7
    s_mul_i32 s32, s30, 196608
    s_add_u32 m0, s27, 32768
    s_nop 0
    buffer_load_dwordx4 v2, s[8:11], s31 offen lds
    s_add_u32 m0, s27, 33792
    s_nop 0
    buffer_load_dwordx4 v3, s[8:11], s31 offen lds
    s_add_u32 s26, s32, 0
    s_add_u32 m0, s27, 40960
    s_nop 0
    buffer_load_dwordx4 v4, s[16:19], s26 offen lds
    s_add_u32 m0, s27, 41984
    s_nop 0
    buffer_load_dwordx4 v5, s[16:19], s26 offen lds
    s_add_u32 s26, s32, 1024
    s_add_u32 m0, s27, 49152
    s_nop 0
    buffer_load_dwordx4 v4, s[16:19], s26 offen lds
    s_add_u32 m0, s27, 50176
    s_nop 0
    buffer_load_dwordx4 v5, s[16:19], s26 offen lds
    s_add_u32 s26, s32, 2048
    s_add_u32 m0, s27, 57344
    s_nop 0
    buffer_load_dwordx4 v4, s[16:19], s26 offen lds
    s_add_u32 m0, s27, 58368
    s_nop 0
    buffer_load_dwordx4 v5, s[16:19], s26 offen lds
    s_waitcnt vmcnt(8)
    s_barrier
    s_add_u32 s30, s43, 6
    s_and_b32 s30, s30, 7
    s_lshl_b32 s31, s30, 7
    s_mul_i32 s32, s30, 196608
    s_add_u32 m0, s27, 65536
    s_nop 0
    buffer_load_dwordx4 v2, s[8:11], s31 offen lds
    s_add_u32 m0, s27, 66560
    s_nop 0
    buffer_load_dwordx4 v3, s[8:11], s31 offen lds
    s_add_u32 s26, s32, 0
    s_add_u32 m0, s27, 73728
    s_nop 0
    buffer_load_dwordx4 v4, s[16:19], s26 offen lds
    s_add_u32 m0, s27, 74752
    s_nop 0
    buffer_load_dwordx4 v5, s[16:19], s26 offen lds
    s_add_u32 s26, s32, 1024
    s_add_u32 m0, s27, 81920
    s_nop 0
    buffer_load_dwordx4 v4, s[16:19], s26 offen lds
    s_add_u32 m0, s27, 82944
    s_nop 0
    buffer_load_dwordx4 v5, s[16:19], s26 offen lds
    s_add_u32 s26, s32, 2048
    s_add_u32 m0, s27, 90112
    s_nop 0
    buffer_load_dwordx4 v4, s[16:19], s26 offen lds
    s_add_u32 m0, s27, 91136
    s_nop 0
    buffer_load_dwordx4 v5, s[16:19], s26 offen lds
    s_waitcnt vmcnt(8)
    s_barrier
    s_add_u32 s30, s43, 7
    s_and_b32 s30, s30, 7
    s_lshl_b32 s31, s30, 7
    s_mul_i32 s32, s30, 196608
    s_add_u32 m0, s27, 98304
    s_nop 0
    buffer_load_dwordx4 v2, s[8:11], s31 offen lds
    s_add_u32 m0, s27, 99328
    s_nop 0
    buffer_load_dwordx4 v3, s[8:11], s31 offen lds
    s_add_u32 s26, s32, 0
    s_add_u32 m0, s27, 106496
    s_nop 0
    buffer_load_dwordx4 v4, s[16:19], s26 offen lds
    s_add_u32 m0, s27, 107520
    s_nop 0
    buffer_load_dwordx4 v5, s[16:19], s26 offen lds
    s_add_u32 s26, s32, 1024
    s_add_u32 m0, s27, 114688
    s_nop 0
    buffer_load_dwordx4 v4, s[16:19], s26 offen lds
    s_add_u32 m0, s27, 115712
    s_nop 0
    buffer_load_dwordx4 v5, s[16:19], s26 offen lds
    s_add_u32 s26, s32, 2048
    s_add_u32 m0, s27, 122880
    s_nop 0
    buffer_load_dwordx4 v4, s[16:19], s26 offen lds
    s_add_u32 m0, s27, 123904
    s_nop 0
    buffer_load_dwordx4 v5, s[16:19], s26 offen lds
    s_waitcnt vmcnt(8)
    s_barrier
    s_waitcnt vmcnt(0)
    s_barrier
    s_barrier
    s_barrier
    s_endpgm
L_k0_kernel_end:
    s_endpgm
.section .rodata,"a"
.p2align 6
.amdhsa_kernel k0_kernel
  .amdhsa_next_free_vgpr 226
  .amdhsa_next_free_sgpr 64
  .amdhsa_accum_offset 228
  .amdhsa_group_segment_fixed_size 0
  .amdhsa_kernarg_size 88
  .amdhsa_user_sgpr_count 2
  .amdhsa_user_sgpr_kernarg_segment_ptr 1
  .amdhsa_system_sgpr_workgroup_id_x 1
  .amdhsa_float_denorm_mode_32 3
.end_amdhsa_kernel
.text
.text
.globl attn1_kernel
.p2align 8
.type attn1_kernel,@function
attn1_kernel:
    s_mov_b32 s50, 4194304
    s_mov_b32 s51, 8192
    s_mov_b32 s52, 1
    s_branch L_attn_body
.text
.globl attn0_kernel
.p2align 8
.type attn0_kernel,@function
attn0_kernel:
    s_mov_b32 s50, 2097152
    s_mov_b32 s51, 0
    s_mov_b32 s52, 0
L_attn_body:
    s_cmp_ge_u32 s2, 256
    s_cbranch_scc1 L_attn_end
    s_load_dwordx2 s[6:7], s[0:1], 80
    v_lshrrev_b32 v1, 6, v0
    v_and_b32 v0, 63, v0
    s_and_b32 s30, s2, 7
    s_lshr_b32 s31, s2, 3
    v_readfirstlane_b32 s22, v1
    s_and_b32 s21, s31, 7
    s_lshr_b32 s31, s31, 3
    s_lshl_b32 s20, s30, 2
    s_add_u32 s20, s20, s31
    s_and_b32 s23, s22, 7
    s_lshr_b32 s24, s22, 3
    s_lshl_b32 s30, s21, 3
    s_add_u32 s23, s23, s30
    v_lshlrev_b32 v2, 4, v0
    s_and_b32 s30, s22, 3
    s_lshl_b32 s31, s24, 5
    s_add_u32 s30, s30, s31
    s_lshl_b32 s30, s30, 10
    s_bfe_u32 s31, s22, 0x10002
    s_lshl_b32 s32, s31, 16
    s_add_u32 s43, s30, s32
    s_mul_i32 s32, s31, 2097152
    s_add_u32 s30, s30, s32
    s_lshl_b32 s32, s20, 16
    s_add_u32 s30, s30, s32
    s_add_u32 s42, s30, 8388608
    s_waitcnt lgkmcnt(0)
    s_mov_b32 s12, s6
    s_mov_b32 s13, s7
    s_mov_b32 s14, 0x2800000
    s_mov_b32 s15, 0x00020000
    s_add_u32 m0, s43, 0
    s_add_u32 s34, s42, 0
    buffer_load_dwordx4 v2, s[12:15], s34 offen lds
    s_lshl_b32 s33, s20, 16
    s_lshl_b32 s34, s23, 10
    s_add_u32 s33, s33, s34
    s_add_u32 s33, s33, 6291456
    buffer_load_dwordx4 v[4:7], v2, s[12:15], s33 offen
    s_lshl_b32 s33, s20, 8
    s_add_u32 s33, s33, s51
    v_lshlrev_b32 v99, 2, v0
    buffer_load_dword v100, v99, s[12:15], s33 offen
    s_add_u32 m0, s43, 4096
    s_add_u32 s34, s42, 4096
    buffer_load_dwordx4 v2, s[12:15], s34 offen lds
    s_lshl_b32 s30, s24, 15
    v_add_u32 v96, s30, v2
    v_lshrrev_b32 v101, 5, v0
    v_lshlrev_b32 v101, 8, v101
    v_and_b32 v102, 15, v0
    v_lshl_add_u32 v101, v102, 4, v101
    s_add_u32 s30, s30, 65536
    v_add_u32 v97, s30, v101
    s_mov_b32 s40, 0x0000ffff
    s_mov_b32 s41, 0x0000ffff
    v_and_b32 v103, 0x1b, v0
    v_mov_b32 v104, 0x3f803f80
    v_cmp_eq_u32 vcc, 16, v103
    s_nop 1
    v_cndmask_b32 v16, 0, v104, vcc
    v_mov_b32 v17, v16
    v_mov_b32 v18, v16
    v_mov_b32 v19, v16
    v_mov_b32 v20, v16
    v_mov_b32 v21, v16
    v_mov_b32 v22, v16
    v_mov_b32 v23, v16
    v_mov_b32 v64, 0
    v_mov_b32 v65, 0
    v_mov_b32 v66, 0
    v_mov_b32 v67, 0
    v_mov_b32 v68, 0
    v_mov_b32 v69, 0
    v_mov_b32 v70, 0
    v_mov_b32 v71, 0
    v_mov_b32 v72, 0
    v_mov_b32 v73, 0
    v_mov_b32 v74, 0
    v_mov_b32 v75, 0
    v_mov_b32 v76, 0
    v_mov_b32 v77, 0
    v_mov_b32 v78, 0
    v_mov_b32 v79, 0
    v_mov_b32 v107, 0xdddddddd
    s_mov_b32 s58, 0
    s_cmp_lg_u32 s52, 0
    s_cbranch_scc1 L_attn_rp1
    s_cmp_lg_u32 s52, 0
    s_cbranch_scc1 L_attn_rp1
    s_lshl_b32 s33, s2, 4
    s_add_u32 s33, s33, s22
    s_lshl_b32 s33, s33, 1
    s_cmp_ge_u32 s33, 6656
    s_cbranch_scc1 L_attn_rp1
    s_lshl_b32 s54, s33, 10
    s_add_u32 s54, s54, 25165824
    s_cmp_ge_u32 s33, 1536
    s_cbranch_scc1 L_attn_rm1
    s_load_dwordx2 s[16:17], s[0:1], 8
    s_sub_u32 s34, s33, 0
    s_lshr_b32 s35, s34, 5
    s_and_b32 s34, s34, 31
    s_mov_b32 s56, 3072
    s_mov_b32 s18, 0x180000
    s_lshl_b32 s55, s35, 7
    s_add_u32 s55, s55, 32768
    s_branch L_attn_rgo
L_attn_rm1:
    s_cmp_ge_u32 s33, 2048
    s_cbranch_scc1 L_attn_rm2
    s_load_dwordx2 s[16:17], s[0:1], 16
    s_sub_u32 s34, s33, 1536
    s_lshr_b32 s35, s34, 5
    s_and_b32 s34, s34, 31
    s_mov_b32 s56, 1024
    s_mov_b32 s18, 0x80000
    s_mov_b32 s55, 0
    s_branch L_attn_rgo
L_attn_rm2:
    s_cmp_ge_u32 s33, 2560
    s_cbranch_scc1 L_attn_rm3
    s_load_dwordx2 s[16:17], s[0:1], 32
    s_sub_u32 s34, s33, 2048
    s_lshr_b32 s35, s34, 5
    s_and_b32 s34, s34, 31
    s_mov_b32 s56, 1024
    s_mov_b32 s18, 0x80000
    s_lshl_b32 s55, s35, 7
    s_add_u32 s55, s55, 40960
    s_branch L_attn_rgo
L_attn_rm3:
    s_cmp_ge_u32 s33, 3072
    s_cbranch_scc1 L_attn_rm4
    s_load_dwordx2 s[16:17], s[0:1], 40
    s_sub_u32 s34, s33, 2560
    s_lshr_b32 s35, s34, 5
    s_and_b32 s34, s34, 31
    s_mov_b32 s56, 1024
    s_mov_b32 s18, 0x80000
    s_mov_b32 s55, 0
    s_branch L_attn_rgo
L_attn_rm4:
    s_cmp_ge_u32 s33, 4864
    s_cbranch_scc1 L_attn_rm5
    s_load_dwordx2 s[16:17], s[0:1], 48
    s_sub_u32 s34, s33, 3072
    s_lshr_b32 s35, s34, 5
    s_and_b32 s34, s34, 31
    s_mov_b32 s56, 3584
    s_mov_b32 s18, 0x1c0000
    s_lshl_b32 s55, s35, 7
    s_add_u32 s55, s55, 45056
    s_branch L_attn_rgo
L_attn_rm5:
    s_load_dwordx2 s[16:17], s[0:1], 56
    s_sub_u32 s34, s33, 4864
    s_mul_i32 s35, s34, 2341
    s_lshr_b32 s35, s35, 18
    s_mul_i32 s38, s35, 112
    s_sub_u32 s34, s34, s38
    s_mov_b32 s56, 1024
    s_mov_b32 s18, 0x1c0000
    s_mov_b32 s55, 0
L_attn_rgo:
    s_mov_b32 s19, 0x00020000
    s_lshl_b32 s34, s34, 4
    s_mul_i32 s53, s34, s56
    s_lshl_b32 s35, s35, 6
    s_add_u32 s53, s53, s35
    v_lshrrev_b32 v80, 2, v0
    v_mul_lo_u32 v80, v80, s56
    v_and_b32 v81, 3, v0
    v_lshl_add_u32 v80, v81, 4, v80
    s_lshl_b32 s57, s22, 10
    s_add_u32 s57, s57, 131072
    v_lshrrev_b32 v81, 5, v0
    v_lshlrev_b32 v81, 8, v81
    v_and_b32 v82, 15, v0
    v_lshrrev_b32 v83, 2, v82
    v_lshl_add_u32 v81, v83, 6, v81
    v_and_b32 v82, 3, v82
    v_lshl_add_u32 v81, v82, 3, v81
    v_bfe_u32 v82, v0, 4, 1
    v_lshl_add_u32 v81, v82, 5, v81
    v_add_u32 v81, s57, v81
    v_mov_b32 v82, 0
    v_mov_b32 v83, 0
    s_mov_b32 s58, 1
L_attn_rp1:
    s_waitcnt vmcnt(1)
    v_lshlrev_b32 v98, 16, v4
    v_and_b32 v99, 0xffff0000, v4
    v_mul_f32 v102, v98, v98
    v_fmac_f32 v102, v99, v99
    v_lshlrev_b32 v98, 16, v5
    v_and_b32 v99, 0xffff0000, v5
    v_fmac_f32 v102, v98, v98
    v_fmac_f32 v102, v99, v99
    v_lshlrev_b32 v98, 16, v6
    v_and_b32 v99, 0xffff0000, v6
    v_fmac_f32 v102, v98, v98
    v_fmac_f32 v102, v99, v99
    v_lshlrev_b32 v98, 16, v7
    v_and_b32 v99, 0xffff0000, v7
    v_fmac_f32 v102, v98, v98
    v_fmac_f32 v102, v99, v99
    v_mov_b32 v103, v102
    s_nop 1
    v_permlane32_swap_b32 v102, v103
    s_nop 1
    v_add_f32 v102, v102, v103
    v_mov_b32 v106, 0
    s_cmp_lg_u32 s22, 0
    s_cbranch_scc1 L_attn_nokn
    s_nop 1
    v_max_f32_dpp v100, v100, v100 row_ror:8 row_mask:0xf bank_mask:0xf
    s_nop 1
    v_max_f32_dpp v100, v100, v100 row_ror:4 row_mask:0xf bank_mask:0xf
    s_nop 1
    v_max_f32_dpp v100, v100, v100 row_ror:2 row_mask:0xf bank_mask:0xf
    s_nop 1
    v_max_f32_dpp v100, v100, v100 row_ror:1 row_mask:0xf bank_mask:0xf
    v_mov_b32 v101, v100
    s_nop 1
    v_permlane16_swap_b32 v100, v101
    s_nop 1
    v_max_f32 v100, v100, v101
    v_mov_b32 v101, v100
    s_nop 1
    v_permlane32_swap_b32 v100, v101
    s_nop 1
    v_max_f32 v100, v100, v101
    v_mov_b32 v98, 147456
    ds_write_b32 v98, v100
    s_waitcnt lgkmcnt(0)
L_attn_nokn:
    s_add_u32 m0, s43, 8192
    s_add_u32 s34, s42, 8192
    buffer_load_dwordx4 v2, s[12:15], s34 offen lds
    s_add_u32 m0, s43, 12288
    s_add_u32 s34, s42, 12288
    buffer_load_dwordx4 v2, s[12:15], s34 offen lds
    s_waitcnt vmcnt(2)
    s_barrier
    v_mov_b32 v98, 147456
    ds_read_b32 v100, v98
    ds_read_b128 v[8:11], v96 offset:0
    s_waitcnt lgkmcnt(0)
    v_mul_f32 v102, v100, v102
    v_cmp_nge_f32 vcc, 0x4558589e, v102
    s_nop 4
    s_cbranch_vccnz L_attn_slow
    s_setprio 3
    v_mfma_f32_32x32x16_bf16 v[32:47], v[8:11], v[4:7], 0
    ds_read_b128 v[12:15], v96 offset:1024
    s_mov_b64 exec, s[40:41]
    ds_read_b128 v[16:19], v97 offset:0
    ds_read_b128 v[20:23], v97 offset:512
    s_mov_b64 exec, -1
    s_nop 7
    s_waitcnt lgkmcnt(2)
    v_mfma_f32_32x32x16_bf16 v[48:63], v[12:15], v[4:7], 0
    ds_read_b128 v[8:11], v96 offset:2048
    s_add_u32 m0, s43, 16384
    s_add_u32 s34, s42, 16384
    buffer_load_dwordx4 v2, s[12:15], s34 offen lds
    s_add_u32 m0, s43, 20480
    s_add_u32 s34, s42, 20480
    buffer_load_dwordx4 v2, s[12:15], s34 offen lds
    v_exp_f32 v32, v32
    v_exp_f32 v33, v33
    v_exp_f32 v34, v34
    v_exp_f32 v35, v35
    v_exp_f32 v36, v36
    v_exp_f32 v37, v37
    v_exp_f32 v38, v38
    v_exp_f32 v39, v39
    v_exp_f32 v40, v40
    v_exp_f32 v41, v41
    s_waitcnt lgkmcnt(1)
    v_smfmac_f32_32x32x32_bf16 v[64:79], v[16:19], v[32:39], v107
    v_exp_f32 v42, v42
    v_exp_f32 v43, v43
    v_exp_f32 v44, v44
    v_exp_f32 v45, v45
    v_exp_f32 v46, v46
    v_exp_f32 v47, v47
    s_nop 1
    v_smfmac_f32_32x32x32_bf16 v[64:79], v[20:23], v[40:47], v107
    s_mov_b64 exec, s[40:41]
    ds_read_b128 v[16:19], v97 offset:1024
    ds_read_b128 v[20:23], v97 offset:1536
    s_mov_b64 exec, -1
    s_waitcnt lgkmcnt(2)
    v_mfma_f32_32x32x16_bf16 v[32:47], v[8:11], v[4:7], 0
    ds_read_b128 v[12:15], v96 offset:3072
    s_add_u32 m0, s43, 24576
    s_add_u32 s34, s42, 24576
    buffer_load_dwordx4 v2, s[12:15], s34 offen lds
    s_add_u32 m0, s43, 28672
    s_add_u32 s34, s42, 28672
    buffer_load_dwordx4 v2, s[12:15], s34 offen lds
    v_exp_f32 v48, v48
    v_exp_f32 v49, v49
    v_exp_f32 v50, v50
    v_exp_f32 v51, v51
    v_exp_f32 v52, v52
    v_exp_f32 v53, v53
    v_exp_f32 v54, v54
    v_exp_f32 v55, v55
    v_exp_f32 v56, v56
    v_exp_f32 v57, v57
    s_waitcnt lgkmcnt(1)
    v_smfmac_f32_32x32x32_bf16 v[64:79], v[16:19], v[48:55], v107
    v_exp_f32 v58, v58
    v_exp_f32 v59, v59
    v_exp_f32 v60, v60
    v_exp_f32 v61, v61
    v_exp_f32 v62, v62
    v_exp_f32 v63, v63
    s_nop 1
    v_smfmac_f32_32x32x32_bf16 v[64:79], v[20:23], v[56:63], v107
    s_mov_b64 exec, s[40:41]
    ds_read_b128 v[16:19], v97 offset:2048
    ds_read_b128 v[20:23], v97 offset:2560
    s_mov_b64 exec, -1
    s_waitcnt lgkmcnt(2)
    v_mfma_f32_32x32x16_bf16 v[48:63], v[12:15], v[4:7], 0
    ds_read_b128 v[8:11], v96 offset:4096
    v_exp_f32 v32, v32
    v_exp_f32 v33, v33
    v_exp_f32 v34, v34
    v_exp_f32 v35, v35
    v_exp_f32 v36, v36
    v_exp_f32 v37, v37
    v_exp_f32 v38, v38
    v_exp_f32 v39, v39
    v_exp_f32 v40, v40
    v_exp_f32 v41, v41
    s_waitcnt lgkmcnt(1)
    v_smfmac_f32_32x32x32_bf16 v[64:79], v[16:19], v[32:39], v107
    v_exp_f32 v42, v42
    v_exp_f32 v43, v43
    v_exp_f32 v44, v44
    v_exp_f32 v45, v45
    v_exp_f32 v46, v46
    v_exp_f32 v47, v47
    s_nop 1
    v_smfmac_f32_32x32x32_bf16 v[64:79], v[20:23], v[40:47], v107
    s_mov_b64 exec, s[40:41]
    ds_read_b128 v[16:19], v97 offset:3072
    ds_read_b128 v[20:23], v97 offset:3584
    s_mov_b64 exec, -1
    s_waitcnt lgkmcnt(2)
    v_mfma_f32_32x32x16_bf16 v[32:47], v[8:11], v[4:7], 0
    ds_read_b128 v[12:15], v96 offset:5120
    v_exp_f32 v48, v48
    v_exp_f32 v49, v49
    v_exp_f32 v50, v50
    v_exp_f32 v51, v51
    v_exp_f32 v52, v52
    v_exp_f32 v53, v53
    v_exp_f32 v54, v54
    v_exp_f32 v55, v55
    v_exp_f32 v56, v56
    v_exp_f32 v57, v57
    s_waitcnt lgkmcnt(1)
    v_smfmac_f32_32x32x32_bf16 v[64:79], v[16:19], v[48:55], v107
    v_exp_f32 v58, v58
    v_exp_f32 v59, v59
    v_exp_f32 v60, v60
    v_exp_f32 v61, v61
    v_exp_f32 v62, v62
    v_exp_f32 v63, v63
    s_nop 1
    v_smfmac_f32_32x32x32_bf16 v[64:79], v[20:23], v[56:63], v107
    s_mov_b64 exec, s[40:41]
    ds_read_b128 v[16:19], v97 offset:4096
    ds_read_b128 v[20:23], v97 offset:4608
    s_mov_b64 exec, -1
    s_waitcnt lgkmcnt(2)
    v_mfma_f32_32x32x16_bf16 v[48:63], v[12:15], v[4:7], 0
    ds_read_b128 v[8:11], v96 offset:6144
    v_exp_f32 v32, v32
    v_exp_f32 v33, v33
    v_exp_f32 v34, v34
    v_exp_f32 v35, v35
    v_exp_f32 v36, v36
    v_exp_f32 v37, v37
    v_exp_f32 v38, v38
    v_exp_f32 v39, v39
    v_exp_f32 v40, v40
    v_exp_f32 v41, v41
    s_waitcnt lgkmcnt(1)
    v_smfmac_f32_32x32x32_bf16 v[64:79], v[16:19], v[32:39], v107
    v_exp_f32 v42, v42
    v_exp_f32 v43, v43
    v_exp_f32 v44, v44
    v_exp_f32 v45, v45
    v_exp_f32 v46, v46
    v_exp_f32 v47, v47
    s_nop 1
    v_smfmac_f32_32x32x32_bf16 v[64:79], v[20:23], v[40:47], v107
    s_mov_b64 exec, s[40:41]
    ds_read_b128 v[16:19], v97 offset:5120
    ds_read_b128 v[20:23], v97 offset:5632
    s_mov_b64 exec, -1
    s_waitcnt lgkmcnt(2)
    v_mfma_f32_32x32x16_bf16 v[32:47], v[8:11], v[4:7], 0
    ds_read_b128 v[12:15], v96 offset:7168
    v_exp_f32 v48, v48
    v_exp_f32 v49, v49
    v_exp_f32 v50, v50
    v_exp_f32 v51, v51
    v_exp_f32 v52, v52
    v_exp_f32 v53, v53
    v_exp_f32 v54, v54
    v_exp_f32 v55, v55
    v_exp_f32 v56, v56
    v_exp_f32 v57, v57
    s_waitcnt lgkmcnt(1)
    v_smfmac_f32_32x32x32_bf16 v[64:79], v[16:19], v[48:55], v107
    v_exp_f32 v58, v58
    v_exp_f32 v59, v59
    v_exp_f32 v60, v60
    v_exp_f32 v61, v61
    v_exp_f32 v62, v62
    v_exp_f32 v63, v63
    s_nop 1
    v_smfmac_f32_32x32x32_bf16 v[64:79], v[20:23], v[56:63], v107
    s_mov_b64 exec, s[40:41]
    ds_read_b128 v[16:19], v97 offset:6144
    ds_read_b128 v[20:23], v97 offset:6656
    s_mov_b64 exec, -1
    v_add_u32 v96, 6144, v96
    v_add_u32 v97, 6144, v97
    s_waitcnt vmcnt(0)
    s_barrier
    s_cmp_eq_u32 s58, 0
    s_cbranch_scc1 L_attn_ri
    s_mov_b32 m0, s57
    s_nop 0
    buffer_load_dwordx4 v80, s[16:19], s53 offen lds
L_attn_ri:
    s_lshl_b32 s33, s2, 4
    s_add_u32 s33, s33, s22
    s_cmp_ge_u32 s33, 1408
    s_cselect_b32 s33, 0, s33
    s_lshl_b32 s33, s33, 13
    s_add_u32 s33, s33, 12582912
    s_lshr_b32 s34, s2, 3
    s_lshl_b32 s34, s34, 4
    s_add_u32 s34, s34, s22
    s_cmp_ge_u32 s34, 416
    s_cselect_b32 s34, 0, s34
    s_lshl_b32 s34, s34, 13
    s_add_u32 s34, s34, 26738688
    s_cmp_eq_u32 s52, 1
    s_cselect_b32 s33, s34, s33
    v_lshlrev_b32 v108, 7, v0
    buffer_load_dword v109, v108, s[12:15], s33 offen
    s_cmp_lg_u32 s22, 15
    s_cbranch_scc1 L_attn_ncp
    s_lshr_b32 s35, s2, 3
    s_getpc_b64 s[32:33]
L_pc_attn:
    s_sub_u32 s32, s32, (L_pc_attn - L_code_start)
    s_subb_u32 s33, s33, 0
    s_lshl_b32 s34, s35, 13
    v_lshlrev_b32 v108, 7, v0
    v_add_u32 v108, s34, v108
    v_min_u32 v108, (L_code_end - L_code_start - 4), v108
    global_load_dword v109, v108, s[32:33]
L_attn_ncp:
    s_setprio 3
    s_waitcnt lgkmcnt(2)
    v_mfma_f32_32x32x16_bf16 v[48:63], v[12:15], v[4:7], 0
    ds_read_b128 v[8:11], v96 offset:2048
    v_exp_f32 v32, v32
    v_exp_f32 v33, v33
    v_exp_f32 v34, v34
    v_exp_f32 v35, v35
    v_exp_f32 v36, v36
    v_exp_f32 v37, v37
    v_exp_f32 v38, v38
    v_exp_f32 v39, v39
    v_exp_f32 v40, v40
    v_exp_f32 v41, v41
    s_waitcnt lgkmcnt(1)
    v_smfmac_f32_32x32x32_bf16 v[64:79], v[16:19], v[32:39], v107
    v_exp_f32 v42, v42
    v_exp_f32 v43, v43
    v_exp_f32 v44, v44
    v_exp_f32 v45, v45
    v_exp_f32 v46, v46
    v_exp_f32 v47, v47
    s_nop 1
    v_smfmac_f32_32x32x32_bf16 v[64:79], v[20:23], v[40:47], v107
    s_mov_b64 exec, s[40:41]
    ds_read_b128 v[16:19], v97 offset:1024
    ds_read_b128 v[20:23], v97 offset:1536
    s_mov_b64 exec, -1
    s_waitcnt lgkmcnt(2)
    v_mfma_f32_32x32x16_bf16 v[32:47], v[8:11], v[4:7], 0
    ds_read_b128 v[12:15], v96 offset:3072
    v_exp_f32 v48, v48
    v_exp_f32 v49, v49
    v_exp_f32 v50, v50
    v_exp_f32 v51, v51
    v_exp_f32 v52, v52
    v_exp_f32 v53, v53
    v_exp_f32 v54, v54
    v_exp_f32 v55, v55
    v_exp_f32 v56, v56
    v_exp_f32 v57, v57
    s_waitcnt lgkmcnt(1)
    v_smfmac_f32_32x32x32_bf16 v[64:79], v[16:19], v[48:55], v107
    v_exp_f32 v58, v58
    v_exp_f32 v59, v59
    v_exp_f32 v60, v60
    v_exp_f32 v61, v61
    v_exp_f32 v62, v62
    v_exp_f32 v63, v63
    s_nop 1
    v_smfmac_f32_32x32x32_bf16 v[64:79], v[20:23], v[56:63], v107
    s_mov_b64 exec, s[40:41]
    ds_read_b128 v[16:19], v97 offset:2048
    ds_read_b128 v[20:23], v97 offset:2560
    s_mov_b64 exec, -1
    s_waitcnt lgkmcnt(2)
    v_mfma_f32_32x32x16_bf16 v[48:63], v[12:15], v[4:7], 0
    ds_read_b128 v[8:11], v96 offset:4096
    v_exp_f32 v32, v32
    v_exp_f32 v33, v33
    v_exp_f32 v34, v34
    v_exp_f32 v35, v35
    v_exp_f32 v36, v36
    v_exp_f32 v37, v37
    v_exp_f32 v38, v38
    v_exp_f32 v39, v39
    v_exp_f32 v40, v40
    v_exp_f32 v41, v41
    s_waitcnt lgkmcnt(1)
    v_smfmac_f32_32x32x32_bf16 v[64:79], v[16:19], v[32:39], v107
    v_exp_f32 v42, v42
    v_exp_f32 v43, v43
    v_exp_f32 v44, v44
    v_exp_f32 v45, v45
    v_exp_f32 v46, v46
    v_exp_f32 v47, v47
    s_nop 1
    v_smfmac_f32_32x32x32_bf16 v[64:79], v[20:23], v[40:47], v107
    s_mov_b64 exec, s[40:41]
    ds_read_b128 v[16:19], v97 offset:3072
    ds_read_b128 v[20:23], v97 offset:3584
    s_mov_b64 exec, -1
    s_waitcnt lgkmcnt(2)
    v_mfma_f32_32x32x16_bf16 v[32:47], v[8:11], v[4:7], 0
    ds_read_b128 v[12:15], v96 offset:5120
    v_exp_f32 v48, v48
    v_exp_f32 v49, v49
    v_exp_f32 v50, v50
    v_exp_f32 v51, v51
    v_exp_f32 v52, v52
    v_exp_f32 v53, v53
    v_exp_f32 v54, v54
    v_exp_f32 v55, v55
    v_exp_f32 v56, v56
    v_exp_f32 v57, v57
    s_waitcnt lgkmcnt(1)
    v_smfmac_f32_32x32x32_bf16 v[64:79], v[16:19], v[48:55], v107
    v_exp_f32 v58, v58
    v_exp_f32 v59, v59
    v_exp_f32 v60, v60
    v_exp_f32 v61, v61
    v_exp_f32 v62, v62
    v_exp_f32 v63, v63
    s_nop 1
    v_smfmac_f32_32x32x32_bf16 v[64:79], v[20:23], v[56:63], v107
    s_mov_b64 exec, s[40:41]
    ds_read_b128 v[16:19], v97 offset:4096
    ds_read_b128 v[20:23], v97 offset:4608
    s_mov_b64 exec, -1
    v_add_u32 v96, 4096, v96
    v_add_u32 v97, 4096, v97
    s_setprio 2
    s_mov_b32 s30, 2
L_attn_l1_1:
    s_waitcnt lgkmcnt(2)
    v_mfma_f32_32x32x16_bf16 v[48:63], v[12:15], v[4:7], 0
    ds_read_b128 v[8:11], v96 offset:2048
    v_exp_f32 v32, v32
    v_exp_f32 v33, v33
    v_exp_f32 v34, v34
    v_exp_f32 v35, v35
    v_exp_f32 v36, v36
    v_exp_f32 v37, v37
    v_exp_f32 v38, v38
    v_exp_f32 v39, v39
    v_exp_f32 v40, v40
    v_exp_f32 v41, v41
    s_waitcnt lgkmcnt(1)
    v_smfmac_f32_32x32x32_bf16 v[64:79], v[16:19], v[32:39], v107
    v_exp_f32 v42, v42
    v_exp_f32 v43, v43
    v_exp_f32 v44, v44
    v_exp_f32 v45, v45
    v_exp_f32 v46, v46
    v_exp_f32 v47, v47
    s_nop 1
    v_smfmac_f32_32x32x32_bf16 v[64:79], v[20:23], v[40:47], v107
    s_mov_b64 exec, s[40:41]
    ds_read_b128 v[16:19], v97 offset:1024
    ds_read_b128 v[20:23], v97 offset:1536
    s_mov_b64 exec, -1
    s_waitcnt lgkmcnt(2)
    v_mfma_f32_32x32x16_bf16 v[32:47], v[8:11], v[4:7], 0
    ds_read_b128 v[12:15], v96 offset:3072
    v_exp_f32 v48, v48
    v_exp_f32 v49, v49
    v_exp_f32 v50, v50
    v_exp_f32 v51, v51
    v_exp_f32 v52, v52
    v_exp_f32 v53, v53
    v_exp_f32 v54, v54
    v_exp_f32 v55, v55
    v_exp_f32 v56, v56
    v_exp_f32 v57, v57
    s_waitcnt lgkmcnt(1)
    v_smfmac_f32_32x32x32_bf16 v[64:79], v[16:19], v[48:55], v107
    v_exp_f32 v58, v58
    v_exp_f32 v59, v59
    v_exp_f32 v60, v60
    v_exp_f32 v61, v61
    v_exp_f32 v62, v62
    v_exp_f32 v63, v63
    s_nop 1
    v_smfmac_f32_32x32x32_bf16 v[64:79], v[20:23], v[56:63], v107
    s_mov_b64 exec, s[40:41]
    ds_read_b128 v[16:19], v97 offset:2048
    ds_read_b128 v[20:23], v97 offset:2560
    s_mov_b64 exec, -1
    s_waitcnt lgkmcnt(2)
    v_mfma_f32_32x32x16_bf16 v[48:63], v[12:15], v[4:7], 0
    ds_read_b128 v[8:11], v96 offset:4096
    v_exp_f32 v32, v32
    v_exp_f32 v33, v33
    v_exp_f32 v34, v34
    v_exp_f32 v35, v35
    v_exp_f32 v36, v36
    v_exp_f32 v37, v37
    v_exp_f32 v38, v38
    v_exp_f32 v39, v39
    v_exp_f32 v40, v40
    v_exp_f32 v41, v41
    s_waitcnt lgkmcnt(1)
    v_smfmac_f32_32x32x32_bf16 v[64:79], v[16:19], v[32:39], v107
    v_exp_f32 v42, v42
    v_exp_f32 v43, v43
    v_exp_f32 v44, v44
    v_exp_f32 v45, v45
    v_exp_f32 v46, v46
    v_exp_f32 v47, v47
    s_nop 1
    v_smfmac_f32_32x32x32_bf16 v[64:79], v[20:23], v[40:47], v107
    s_mov_b64 exec, s[40:41]
    ds_read_b128 v[16:19], v97 offset:3072
    ds_read_b128 v[20:23], v97 offset:3584
    s_mov_b64 exec, -1
    s_waitcnt lgkmcnt(2)
    v_mfma_f32_32x32x16_bf16 v[32:47], v[8:11], v[4:7], 0
    ds_read_b128 v[12:15], v96 offset:5120
    v_exp_f32 v48, v48
    v_exp_f32 v49, v49
    v_exp_f32 v50, v50
    v_exp_f32 v51, v51
    v_exp_f32 v52, v52
    v_exp_f32 v53, v53
    v_exp_f32 v54, v54
    v_exp_f32 v55, v55
    v_exp_f32 v56, v56
    v_exp_f32 v57, v57
    s_waitcnt lgkmcnt(1)
    v_smfmac_f32_32x32x32_bf16 v[64:79], v[16:19], v[48:55], v107
    v_exp_f32 v58, v58
    v_exp_f32 v59, v59
    v_exp_f32 v60, v60
    v_exp_f32 v61, v61
    v_exp_f32 v62, v62
    v_exp_f32 v63, v63
    s_nop 1
    v_smfmac_f32_32x32x32_bf16 v[64:79], v[20:23], v[56:63], v107
    s_mov_b64 exec, s[40:41]
    ds_read_b128 v[16:19], v97 offset:4096
    ds_read_b128 v[20:23], v97 offset:4608
    s_mov_b64 exec, -1
    v_add_u32 v96, 4096, v96
    v_add_u32 v97, 4096, v97
    s_sub_u32 s30, s30, 1
    s_cmp_lg_u32 s30, 0
    s_cbranch_scc1 L_attn_l1_1
    s_setprio 1
    s_mov_b32 s30, 2
L_attn_l1_2:
    s_waitcnt lgkmcnt(2)
    v_mfma_f32_32x32x16_bf16 v[48:63], v[12:15], v[4:7], 0
    ds_read_b128 v[8:11], v96 offset:2048
    v_exp_f32 v32, v32
    v_exp_f32 v33, v33
    v_exp_f32 v34, v34
    v_exp_f32 v35, v35
    v_exp_f32 v36, v36
    v_exp_f32 v37, v37
    v_exp_f32 v38, v38
    v_exp_f32 v39, v39
    v_exp_f32 v40, v40
    v_exp_f32 v41, v41
    s_waitcnt lgkmcnt(1)
    v_smfmac_f32_32x32x32_bf16 v[64:79], v[16:19], v[32:39], v107
    v_exp_f32 v42, v42
    v_exp_f32 v43, v43
    v_exp_f32 v44, v44
    v_exp_f32 v45, v45
    v_exp_f32 v46, v46
    v_exp_f32 v47, v47
    s_nop 1
    v_smfmac_f32_32x32x32_bf16 v[64:79], v[20:23], v[40:47], v107
    s_mov_b64 exec, s[40:41]
    ds_read_b128 v[16:19], v97 offset:1024
    ds_read_b128 v[20:23], v97 offset:1536
    s_mov_b64 exec, -1
    s_waitcnt lgkmcnt(2)
    v_mfma_f32_32x32x16_bf16 v[32:47], v[8:11], v[4:7], 0
    ds_read_b128 v[12:15], v96 offset:3072
    v_exp_f32 v48, v48
    v_exp_f32 v49, v49
    v_exp_f32 v50, v50
    v_exp_f32 v51, v51
    v_exp_f32 v52, v52
    v_exp_f32 v53, v53
    v_exp_f32 v54, v54
    v_exp_f32 v55, v55
    v_exp_f32 v56, v56
    v_exp_f32 v57, v57
    s_waitcnt lgkmcnt(1)
    v_smfmac_f32_32x32x32_bf16 v[64:79], v[16:19], v[48:55], v107
    v_exp_f32 v58, v58
    v_exp_f32 v59, v59
    v_exp_f32 v60, v60
    v_exp_f32 v61, v61
    v_exp_f32 v62, v62
    v_exp_f32 v63, v63
    s_nop 1
    v_smfmac_f32_32x32x32_bf16 v[64:79], v[20:23], v[56:63], v107
    s_mov_b64 exec, s[40:41]
    ds_read_b128 v[16:19], v97 offset:2048
    ds_read_b128 v[20:23], v97 offset:2560
    s_mov_b64 exec, -1
    s_waitcnt lgkmcnt(2)
    v_mfma_f32_32x32x16_bf16 v[48:63], v[12:15], v[4:7], 0
    ds_read_b128 v[8:11], v96 offset:4096
    v_exp_f32 v32, v32
    v_exp_f32 v33, v33
    v_exp_f32 v34, v34
    v_exp_f32 v35, v35
    v_exp_f32 v36, v36
    v_exp_f32 v37, v37
    v_exp_f32 v38, v38
    v_exp_f32 v39, v39
    v_exp_f32 v40, v40
    v_exp_f32 v41, v41
    s_waitcnt lgkmcnt(1)
    v_smfmac_f32_32x32x32_bf16 v[64:79], v[16:19], v[32:39], v107
    v_exp_f32 v42, v42
    v_exp_f32 v43, v43
    v_exp_f32 v44, v44
    v_exp_f32 v45, v45
    v_exp_f32 v46, v46
    v_exp_f32 v47, v47
    s_nop 1
    v_smfmac_f32_32x32x32_bf16 v[64:79], v[20:23], v[40:47], v107
    s_mov_b64 exec, s[40:41]
    ds_read_b128 v[16:19], v97 offset:3072
    ds_read_b128 v[20:23], v97 offset:3584
    s_mov_b64 exec, -1
    s_waitcnt lgkmcnt(2)
    v_mfma_f32_32x32x16_bf16 v[32:47], v[8:11], v[4:7], 0
    ds_read_b128 v[12:15], v96 offset:5120
    v_exp_f32 v48, v48
    v_exp_f32 v49, v49
    v_exp_f32 v50, v50
    v_exp_f32 v51, v51
    v_exp_f32 v52, v52
    v_exp_f32 v53, v53
    v_exp_f32 v54, v54
    v_exp_f32 v55, v55
    v_exp_f32 v56, v56
    v_exp_f32 v57, v57
    s_waitcnt lgkmcnt(1)
    v_smfmac_f32_32x32x32_bf16 v[64:79], v[16:19], v[48:55], v107
    v_exp_f32 v58, v58
    v_exp_f32 v59, v59
    v_exp_f32 v60, v60
    v_exp_f32 v61, v61
    v_exp_f32 v62, v62
    v_exp_f32 v63, v63
    s_nop 1
    v_smfmac_f32_32x32x32_bf16 v[64:79], v[20:23], v[56:63], v107
    s_mov_b64 exec, s[40:41]
    ds_read_b128 v[16:19], v97 offset:4096
    ds_read_b128 v[20:23], v97 offset:4608
    s_mov_b64 exec, -1
    v_add_u32 v96, 4096, v96
    v_add_u32 v97, 4096, v97
    s_sub_u32 s30, s30, 1
    s_cmp_lg_u32 s30, 0
    s_cbranch_scc1 L_attn_l1_2
    s_cmp_eq_u32 s58, 0
    s_cbranch_scc1 L_attn_rf0
    s_waitcnt vmcnt(0)
    ds_read_b64_tr_b16 v[84:85], v81
    ds_read_b64_tr_b16 v[86:87], v81 offset:512
    s_waitcnt lgkmcnt(0)
    buffer_store_dwordx4 v[84:87], v2, s[12:15], s54 offen offset:0 sc1
    v_lshlrev_b32 v88, 16, v84
    v_and_b32 v89, 0xffff0000, v84
    v_pk_add_f32 v[82:83], v[82:83], v[88:89]
    v_lshlrev_b32 v88, 16, v85
    v_and_b32 v89, 0xffff0000, v85
    v_pk_add_f32 v[82:83], v[82:83], v[88:89]
    v_lshlrev_b32 v88, 16, v86
    v_and_b32 v89, 0xffff0000, v86
    v_pk_add_f32 v[82:83], v[82:83], v[88:89]
    v_lshlrev_b32 v88, 16, v87
    v_and_b32 v89, 0xffff0000, v87
    v_pk_add_f32 v[82:83], v[82:83], v[88:89]
    s_lshl_b32 s34, s56, 4
    s_add_u32 s53, s53, s34
    s_mov_b32 m0, s57
    s_nop 0
    buffer_load_dwordx4 v80, s[16:19], s53 offen lds
L_attn_rf0:
    s_setprio 0
    s_waitcnt lgkmcnt(2)
    v_mfma_f32_32x32x16_bf16 v[48:63], v[12:15], v[4:7], 0
    ds_read_b128 v[8:11], v96 offset:2048
    v_exp_f32 v32, v32
    v_exp_f32 v33, v33
    v_exp_f32 v34, v34
    v_exp_f32 v35, v35
    v_exp_f32 v36, v36
    v_exp_f32 v37, v37
    v_exp_f32 v38, v38
    v_exp_f32 v39, v39
    v_exp_f32 v40, v40
    v_exp_f32 v41, v41
    s_waitcnt lgkmcnt(1)
    v_smfmac_f32_32x32x32_bf16 v[64:79], v[16:19], v[32:39], v107
    v_exp_f32 v42, v42
    v_exp_f32 v43, v43
    v_exp_f32 v44, v44
    v_exp_f32 v45, v45
    v_exp_f32 v46, v46
    v_exp_f32 v47, v47
    s_nop 1
    v_smfmac_f32_32x32x32_bf16 v[64:79], v[20:23], v[40:47], v107
    s_mov_b64 exec, s[40:41]
    ds_read_b128 v[16:19], v97 offset:1024
    ds_read_b128 v[20:23], v97 offset:1536
    s_mov_b64 exec, -1
    s_waitcnt lgkmcnt(2)
    v_mfma_f32_32x32x16_bf16 v[32:47], v[8:11], v[4:7], 0
    ds_read_b128 v[12:15], v96 offset:3072
    v_exp_f32 v48, v48
    v_exp_f32 v49, v49
    v_exp_f32 v50, v50
    v_exp_f32 v51, v51
    v_exp_f32 v52, v52
    v_exp_f32 v53, v53
    v_exp_f32 v54, v54
    v_exp_f32 v55, v55
    v_exp_f32 v56, v56
    v_exp_f32 v57, v57
    s_waitcnt lgkmcnt(1)
    v_smfmac_f32_32x32x32_bf16 v[64:79], v[16:19], v[48:55], v107
    v_exp_f32 v58, v58
    v_exp_f32 v59, v59
    v_exp_f32 v60, v60
    v_exp_f32 v61, v61
    v_exp_f32 v62, v62
    v_exp_f32 v63, v63
    s_nop 1
    v_smfmac_f32_32x32x32_bf16 v[64:79], v[20:23], v[56:63], v107
    s_mov_b64 exec, s[40:41]
    ds_read_b128 v[16:19], v97 offset:2048
    ds_read_b128 v[20:23], v97 offset:2560
    s_mov_b64 exec, -1
    s_waitcnt lgkmcnt(2)
    v_mfma_f32_32x32x16_bf16 v[48:63], v[12:15], v[4:7], 0
    ds_read_b128 v[8:11], v96 offset:4096
    v_exp_f32 v32, v32
    v_exp_f32 v33, v33
    v_exp_f32 v34, v34
    v_exp_f32 v35, v35
    v_exp_f32 v36, v36
    v_exp_f32 v37, v37
    v_exp_f32 v38, v38
    v_exp_f32 v39, v39
    v_exp_f32 v40, v40
    v_exp_f32 v41, v41
    s_waitcnt lgkmcnt(1)
    v_smfmac_f32_32x32x32_bf16 v[64:79], v[16:19], v[32:39], v107
    v_exp_f32 v42, v42
    v_exp_f32 v43, v43
    v_exp_f32 v44, v44
    v_exp_f32 v45, v45
    v_exp_f32 v46, v46
    v_exp_f32 v47, v47
    s_nop 1
    v_smfmac_f32_32x32x32_bf16 v[64:79], v[20:23], v[40:47], v107
    s_mov_b64 exec, s[40:41]
    ds_read_b128 v[16:19], v97 offset:3072
    ds_read_b128 v[20:23], v97 offset:3584
    s_mov_b64 exec, -1
    s_waitcnt lgkmcnt(2)
    v_mfma_f32_32x32x16_bf16 v[32:47], v[8:11], v[4:7], 0
    ds_read_b128 v[12:15], v96 offset:5120
    v_exp_f32 v48, v48
    v_exp_f32 v49, v49
    v_exp_f32 v50, v50
    v_exp_f32 v51, v51
    v_exp_f32 v52, v52
    v_exp_f32 v53, v53
    v_exp_f32 v54, v54
    v_exp_f32 v55, v55
    v_exp_f32 v56, v56
    v_exp_f32 v57, v57
    s_waitcnt lgkmcnt(1)
    v_smfmac_f32_32x32x32_bf16 v[64:79], v[16:19], v[48:55], v107
    v_exp_f32 v58, v58
    v_exp_f32 v59, v59
    v_exp_f32 v60, v60
    v_exp_f32 v61, v61
    v_exp_f32 v62, v62
    v_exp_f32 v63, v63
    s_nop 1
    v_smfmac_f32_32x32x32_bf16 v[64:79], v[20:23], v[56:63], v107
    s_mov_b64 exec, s[40:41]
    ds_read_b128 v[16:19], v97 offset:4096
    ds_read_b128 v[20:23], v97 offset:4608
    s_mov_b64 exec, -1
    v_add_u32 v96, 4096, v96
    v_add_u32 v97, 4096, v97
    s_cmp_eq_u32 s58, 0
    s_cbranch_scc1 L_attn_rf1
    s_waitcnt vmcnt(0)
    ds_read_b64_tr_b16 v[84:85], v81
    ds_read_b64_tr_b16 v[86:87], v81 offset:512
    s_waitcnt lgkmcnt(0)
    buffer_store_dwordx4 v[84:87], v2, s[12:15], s54 offen offset:1024 sc1
    v_lshlrev_b32 v88, 16, v84
    v_and_b32 v89, 0xffff0000, v84
    v_pk_add_f32 v[82:83], v[82:83], v[88:89]
    v_lshlrev_b32 v88, 16, v85
    v_and_b32 v89, 0xffff0000, v85
    v_pk_add_f32 v[82:83], v[82:83], v[88:89]
    v_lshlrev_b32 v88, 16, v86
    v_and_b32 v89, 0xffff0000, v86
    v_pk_add_f32 v[82:83], v[82:83], v[88:89]
    v_lshlrev_b32 v88, 16, v87
    v_and_b32 v89, 0xffff0000, v87
    v_pk_add_f32 v[82:83], v[82:83], v[88:89]
    s_cmp_eq_u32 s55, 0
    s_cbranch_scc1 L_attn_rn1
    v_add_f32 v82, v82, v83
    v_mov_b32 v88, v82
    s_nop 1
    v_permlane32_swap_b32 v82, v88
    s_nop 1
    v_add_f32 v82, v82, v88
    v_lshlrev_b32 v88, 2, v0
    s_mov_b32 exec_hi, 0
    buffer_atomic_add_f32 v82, v88, s[12:15], s55 offen
    s_mov_b64 exec, -1
L_attn_rn1:
L_attn_rf1:
    s_waitcnt lgkmcnt(2)
    v_mfma_f32_32x32x16_bf16 v[48:63], v[12:15], v[4:7], 0
    v_exp_f32 v32, v32
    v_exp_f32 v33, v33
    v_exp_f32 v34, v34
    v_exp_f32 v35, v35
    v_exp_f32 v36, v36
    v_exp_f32 v37, v37
    v_exp_f32 v38, v38
    v_exp_f32 v39, v39
    v_exp_f32 v40, v40
    v_exp_f32 v41, v41
    s_waitcnt lgkmcnt(0)
    v_smfmac_f32_32x32x32_bf16 v[64:79], v[16:19], v[32:39], v107
    v_exp_f32 v42, v42
    v_exp_f32 v43, v43
    v_exp_f32 v44, v44
    v_exp_f32 v45, v45
    v_exp_f32 v46, v46
    v_exp_f32 v47, v47
    s_nop 1
    v_smfmac_f32_32x32x32_bf16 v[64:79], v[20:23], v[40:47], v107
    s_mov_b64 exec, s[40:41]
    ds_read_b128 v[16:19], v97 offset:1024
    ds_read_b128 v[20:23], v97 offset:1536
    s_mov_b64 exec, -1
    v_exp_f32 v48, v48
    v_exp_f32 v49, v49
    v_exp_f32 v50, v50
    v_exp_f32 v51, v51
    v_exp_f32 v52, v52
    v_exp_f32 v53, v53
    v_exp_f32 v54, v54
    v_exp_f32 v55, v55
    v_exp_f32 v56, v56
    v_exp_f32 v57, v57
    s_waitcnt lgkmcnt(0)
    v_smfmac_f32_32x32x32_bf16 v[64:79], v[16:19], v[48:55], v107
    v_exp_f32 v58, v58
    v_exp_f32 v59, v59
    v_exp_f32 v60, v60
    v_exp_f32 v61, v61
    v_exp_f32 v62, v62
    v_exp_f32 v63, v63
    s_nop 1
    v_smfmac_f32_32x32x32_bf16 v[64:79], v[20:23], v[56:63], v107
    s_branch L_attn_fin
L_attn_slow:
    s_add_u32 m0, s43, 16384
    s_add_u32 s34, s42, 16384
    buffer_load_dwordx4 v2, s[12:15], s34 offen lds
    s_add_u32 m0, s43, 20480
    s_add_u32 s34, s42, 20480
    buffer_load_dwordx4 v2, s[12:15], s34 offen lds
    s_add_u32 m0, s43, 24576
    s_add_u32 s34, s42, 24576
    buffer_load_dwordx4 v2, s[12:15], s34 offen lds
    s_add_u32 m0, s43, 28672
    s_add_u32 s34, s42, 28672
    buffer_load_dwordx4 v2, s[12:15], s34 offen lds
    s_waitcnt vmcnt(0)
    s_barrier
    s_cmp_eq_u32 s58, 0
    s_cbranch_scc1 L_attns_ri
    s_mov_b32 m0, s57
    s_nop 0
    buffer_load_dwordx4 v80, s[16:19], s53 offen lds
L_attns_ri:
    s_cmp_eq_u32 s58, 0
    s_cbranch_scc1 L_attns_rf0
    s_waitcnt vmcnt(0)
    ds_read_b64_tr_b16 v[84:85], v81
    ds_read_b64_tr_b16 v[86:87], v81 offset:512
    s_waitcnt lgkmcnt(0)
    buffer_store_dwordx4 v[84:87], v2, s[12:15], s54 offen offset:0 sc1
    v_lshlrev_b32 v88, 16, v84
    v_and_b32 v89, 0xffff0000, v84
    v_pk_add_f32 v[82:83], v[82:83], v[88:89]
    v_lshlrev_b32 v88, 16, v85
    v_and_b32 v89, 0xffff0000, v85
    v_pk_add_f32 v[82:83], v[82:83], v[88:89]
    v_lshlrev_b32 v88, 16, v86
    v_and_b32 v89, 0xffff0000, v86
    v_pk_add_f32 v[82:83], v[82:83], v[88:89]
    v_lshlrev_b32 v88, 16, v87
    v_and_b32 v89, 0xffff0000, v87
    v_pk_add_f32 v[82:83], v[82:83], v[88:89]
    s_lshl_b32 s34, s56, 4
    s_add_u32 s53, s53, s34
    s_mov_b32 m0, s57
    s_nop 0
    buffer_load_dwordx4 v80, s[16:19], s53 offen lds
L_attns_rf0:
    s_cmp_eq_u32 s58, 0
    s_cbranch_scc1 L_attns_rf1
    s_waitcnt vmcnt(0)
    ds_read_b64_tr_b16 v[84:85], v81
    ds_read_b64_tr_b16 v[86:87], v81 offset:512
    s_waitcnt lgkmcnt(0)
    buffer_store_dwordx4 v[84:87], v2, s[12:15], s54 offen offset:1024 sc1
    v_lshlrev_b32 v88, 16, v84
    v_and_b32 v89, 0xffff0000, v84
    v_pk_add_f32 v[82:83], v[82:83], v[88:89]
    v_lshlrev_b32 v88, 16, v85
    v_and_b32 v89, 0xffff0000, v85
    v_pk_add_f32 v[82:83], v[82:83], v[88:89]
    v_lshlrev_b32 v88, 16, v86
    v_and_b32 v89, 0xffff0000, v86
    v_pk_add_f32 v[82:83], v[82:83], v[88:89]
    v_lshlrev_b32 v88, 16, v87
    v_and_b32 v89, 0xffff0000, v87
    v_pk_add_f32 v[82:83], v[82:83], v[88:89]
    s_cmp_eq_u32 s55, 0
    s_cbranch_scc1 L_attns_rn1
    v_add_f32 v82, v82, v83
    v_mov_b32 v88, v82
    s_nop 1
    v_permlane32_swap_b32 v82, v88
    s_nop 1
    v_add_f32 v82, v82, v88
    v_lshlrev_b32 v88, 2, v0
    s_mov_b32 exec_hi, 0
    buffer_atomic_add_f32 v82, v88, s[12:15], s55 offen
    s_mov_b64 exec, -1
L_attns_rn1:
L_attns_rf1:
    v_mov_b32 v106, 0xff800000
    s_mov_b32 s30, 32
L_attn_sl:
    ds_read_b128 v[8:11], v96 offset:0
    s_mov_b64 exec, s[40:41]
    ds_read_b128 v[16:19], v97 offset:0
    ds_read_b128 v[20:23], v97 offset:512
    s_mov_b64 exec, -1
    s_waitcnt lgkmcnt(0)
    v_mfma_f32_32x32x16_bf16 v[32:47], v[8:11], v[4:7], 0
    s_nop 15
    v_max3_f32 v99, v32, v33, v34
    v_max3_f32 v99, v99, v35, v36
    v_max3_f32 v99, v99, v37, v38
    v_max3_f32 v99, v99, v39, v40
    v_max3_f32 v99, v99, v41, v42
    v_max3_f32 v99, v99, v43, v44
    v_max3_f32 v99, v99, v45, v46
    v_max_f32 v99, v99, v47
    v_mov_b32 v100, v99
    s_nop 1
    v_permlane32_swap_b32 v99, v100
    s_nop 1
    v_max3_f32 v99, v99, v100, v106
    v_sub_f32 v100, v106, v99
    v_exp_f32 v100, v100
    v_mov_b32 v106, v99
    v_mul_f32 v64, v64, v100
    v_mul_f32 v65, v65, v100
    v_mul_f32 v66, v66, v100
    v_mul_f32 v67, v67, v100
    v_mul_f32 v68, v68, v100
    v_mul_f32 v69, v69, v100
    v_mul_f32 v70, v70, v100
    v_mul_f32 v71, v71, v100
    v_mul_f32 v72, v72, v100
    v_mul_f32 v73, v73, v100
    v_mul_f32 v74, v74, v100
    v_mul_f32 v75, v75, v100
    v_mul_f32 v76, v76, v100
    v_mul_f32 v77, v77, v100
    v_mul_f32 v78, v78, v100
    v_mul_f32 v79, v79, v100
    v_sub_f32 v32, v32, v106
    v_sub_f32 v33, v33, v106
    v_sub_f32 v34, v34, v106
    v_sub_f32 v35, v35, v106
    v_sub_f32 v36, v36, v106
    v_sub_f32 v37, v37, v106
    v_sub_f32 v38, v38, v106
    v_sub_f32 v39, v39, v106
    v_sub_f32 v40, v40, v106
    v_sub_f32 v41, v41, v106
    v_sub_f32 v42, v42, v106
    v_sub_f32 v43, v43, v106
    v_sub_f32 v44, v44, v106
    v_sub_f32 v45, v45, v106
    v_sub_f32 v46, v46, v106
    v_sub_f32 v47, v47, v106
    v_exp_f32 v32, v32
    v_exp_f32 v33, v33
    v_exp_f32 v34, v34
    v_exp_f32 v35, v35
    v_exp_f32 v36, v36
    v_exp_f32 v37, v37
    v_exp_f32 v38, v38
    v_exp_f32 v39, v39
    v_exp_f32 v40, v40
    v_exp_f32 v41, v41
    v_exp_f32 v42, v42
    v_exp_f32 v43, v43
    v_exp_f32 v44, v44
    v_exp_f32 v45, v45
    v_exp_f32 v46, v46
    v_exp_f32 v47, v47
    s_nop 2
    v_smfmac_f32_32x32x32_bf16 v[64:79], v[16:19], v[32:39], v107
    v_smfmac_f32_32x32x32_bf16 v[64:79], v[20:23], v[40:47], v107
    s_nop 15
    v_add_u32 v96, 1024, v96
    v_add_u32 v97, 1024, v97
    s_nop 15
    s_sub_u32 s30, s30, 1
    s_cmp_lg_u32 s30, 0
    s_cbranch_scc1 L_attn_sl
L_attn_fin:
    s_and_b32 s30, s22, 7
    s_mul_i32 s30, s30, 2560
    s_add_u32 s30, s30, 0
    v_lshlrev_b32 v98, 2, v0
    v_add_u32 v98, s30, v98
    s_waitcnt lgkmcnt(0)
    s_barrier
    s_nop 15
    s_nop 15
    s_cmp_eq_u32 s24, 0
    s_cbranch_scc1 L_attn_lo
    ds_write_b32 v98, v64 offset:0
    ds_write_b32 v98, v65 offset:256
    ds_write_b32 v98, v66 offset:512
    ds_write_b32 v98, v67 offset:768
    ds_write_b32 v98, v68 offset:1024
    ds_write_b32 v98, v69 offset:1280
    ds_write_b32 v98, v70 offset:1536
    ds_write_b32 v98, v71 offset:1792
    ds_write_b32 v98, v72 offset:2048
    ds_write_b32 v98, v106 offset:2304
    s_waitcnt lgkmcnt(0)
    s_barrier
    s_endpgm
L_attn_lo:
    s_barrier
    ds_read_b32 v32, v98 offset:0
    ds_read_b32 v33, v98 offset:256
    ds_read_b32 v34, v98 offset:512
    ds_read_b32 v35, v98 offset:768
    ds_read_b32 v36, v98 offset:1024
    ds_read_b32 v37, v98 offset:1280
    ds_read_b32 v38, v98 offset:1536
    ds_read_b32 v39, v98 offset:1792
    ds_read_b32 v40, v98 offset:2048
    ds_read_b32 v41, v98 offset:2304
    s_lshl_b32 s30, s23, 15
    s_lshl_b32 s31, s20, 10
    s_add_u32 s30, s30, s31
    s_add_u32 s30, s30, s50
    s_waitcnt lgkmcnt(0)
    v_max_f32 v98, v106, v41
    v_sub_f32 v99, v106, v98
    v_sub_f32 v100, v41, v98
    v_exp_f32 v99, v99
    v_exp_f32 v100, v100
    s_nop 0
    v_mul_f32 v64, v64, v99
    v_mul_f32 v65, v65, v99
    v_mul_f32 v66, v66, v99
    v_mul_f32 v67, v67, v99
    v_mul_f32 v68, v68, v99
    v_mul_f32 v69, v69, v99
    v_mul_f32 v70, v70, v99
    v_mul_f32 v71, v71, v99
    v_mul_f32 v72, v72, v99
    v_fmac_f32 v64, v32, v100
    v_fmac_f32 v65, v33, v100
    v_fmac_f32 v66, v34, v100
    v_fmac_f32 v67, v35, v100
    v_fmac_f32 v68, v36, v100
    v_fmac_f32 v69, v37, v100
    v_fmac_f32 v70, v38, v100
    v_fmac_f32 v71, v39, v100
    v_fmac_f32 v72, v40, v100
    v_rcp_f32 v99, v72
    s_nop 0
    v_mul_f32 v64, v64, v99
    v_mul_f32 v65, v65, v99
    v_mul_f32 v66, v66, v99
    v_mul_f32 v67, v67, v99
    v_mul_f32 v68, v68, v99
    v_mul_f32 v69, v69, v99
    v_mul_f32 v70, v70, v99
    v_mul_f32 v71, v71, v99
    v_cvt_pk_bf16_f32 v24, v64, v65
    v_cvt_pk_bf16_f32 v25, v66, v67
    v_cvt_pk_bf16_f32 v26, v68, v69
    v_cvt_pk_bf16_f32 v27, v70, v71
    buffer_store_dwordx4 v[24:27], v2, s[12:15], s30 offen sc1
L_attn_end:
    s_endpgm
.section .rodata,"a"
.p2align 6
.amdhsa_kernel attn0_kernel
  .amdhsa_next_free_vgpr 112
  .amdhsa_next_free_sgpr 64
  .amdhsa_accum_offset 112
  .amdhsa_group_segment_fixed_size 0
  .amdhsa_kernarg_size 88
  .amdhsa_user_sgpr_count 2
  .amdhsa_user_sgpr_kernarg_segment_ptr 1
  .amdhsa_system_sgpr_workgroup_id_x 1
  .amdhsa_float_denorm_mode_32 3
.end_amdhsa_kernel
.text
.section .rodata,"a"
.p2align 6
.amdhsa_kernel attn1_kernel
  .amdhsa_next_free_vgpr 112
  .amdhsa_next_free_sgpr 64
  .amdhsa_accum_offset 112
  .amdhsa_group_segment_fixed_size 0
  .amdhsa_kernarg_size 88
  .amdhsa_user_sgpr_count 2
  .amdhsa_user_sgpr_kernarg_segment_ptr 1
  .amdhsa_system_sgpr_workgroup_id_x 1
  .amdhsa_float_denorm_mode_32 3
.end_amdhsa_kernel
.text
.text
.globl chain0_kernel
.p2align 8
.type chain0_kernel,@function
chain0_kernel:
    s_cmp_ge_u32 s2, 256
    s_cbranch_scc1 L_chain0_kernel_end
    s_load_dwordx2 s[6:7], s[0:1], 80
    s_load_dwordx2 s[4:5], s[0:1], 0
    v_lshrrev_b32 v1, 6, v0
    v_and_b32 v0, 63, v0
    s_and_b32 s30, s2, 7
    s_lshr_b32 s31, s2, 3
    v_readfirstlane_b32 s22, v1
    s_and_b32 s21, s31, 7
    s_lshr_b32 s31, s31, 3
    s_lshl_b32 s20, s30, 2
    s_add_u32 s20, s20, s31
    s_and_b32 s23, s22, 1
    s_bfe_u32 s24, s22, 0x10001
    s_and_b32 s25, s22, 3
    s_lshl_b32 s28, s20, 1
    s_add_u32 s28, s28, s23
    s_lshl_b32 s50, s20, 8
    s_add_u32 s50, s50, 1048576
    s_mov_b32 s29, 0
    s_waitcnt lgkmcnt(0)
    s_add_u32 s48, s6, s50
    s_addc_u32 s49, s7, 0
    s_mov_b32 s12, s6
    s_mov_b32 s13, s7
    s_mov_b32 s14, 0x2800000
    s_mov_b32 s15, 0x00020000
    s_mov_b32 s16, s4
    s_mov_b32 s17, s5
    s_mov_b32 s18, 0x200000
    s_mov_b32 s19, 0x00020000
    s_cmp_ge_u32 s22, 4
    s_cbranch_scc1 L_chain0_kernel_ld
    s_lshl_b32 s44, s21, 1
    s_add_u32 s44, s44, s24
    s_lshl_b32 s45, s44, 1
    v_lshlrev_b32 v14, 4, v0
    s_lshl_b32 s32, s28, 15
    s_lshl_b32 s33, s44, 6
    s_add_u32 s32, s32, s33
    v_and_b32 v2, 31, v0
    v_lshlrev_b32 v2, 10, v2
    v_lshrrev_b32 v3, 5, v0
    v_lshl_add_u32 v2, v3, 4, v2
    buffer_load_dwordx4 v[188:191], v2, s[16:19], s32 offen
    buffer_load_dwordx4 v[192:195], v2, s[16:19], s32 offen offset:32
    s_cmp_lg_u32 s22, 3
    s_cbranch_scc1 L_chain0_kernel_cp1
    s_lshr_b32 s35, s2, 3
    s_getpc_b64 s[32:33]
L_pc_chain0_kernel:
    s_sub_u32 s32, s32, (L_pc_chain0_kernel - L_code_start)
    s_subb_u32 s33, s33, 0
    s_lshl_b32 s34, s35, 13
    v_lshlrev_b32 v246, 7, v0
    v_add_u32 v246, s34, v246
    v_min_u32 v246, (L_code_end - L_code_start - 4), v246
    global_load_dword v247, v246, s[32:33]
L_chain0_kernel_cp1:
    s_cmp_lg_u32 s22, 0
    s_cbranch_scc1 L_chain0_kernel_hs2
    s_getreg_b32 s34, hwreg(HW_REG_XCC_ID, 0, 3)
    s_lshl_b32 s34, s34, 2
    s_lshl_b32 s34, 1, s34
    s_mov_b64 s[40:41], exec
    s_mov_b64 exec, 1
    v_mov_b32 v2, s50
    v_mov_b32 v3, s34
    buffer_atomic_add v3, v2, s[12:15], 0 offen sc1
    s_mov_b64 exec, s[40:41]
L_chain0_kernel_hs2:
    s_mul_i32 s30, s24, 1024
    s_add_u32 s30, s30, 2048
    v_lshlrev_b32 v11, 4, v0
    v_add_u32 v8, s30, v11
    s_lshl_b32 s30, s23, 10
    v_add_u32 v11, s30, v11
    v_add_u32 v9, 65536, v8
    v_add_u32 v12, 65536, v11
    s_barrier
    ds_read_b128 v[124:127], v11 offset:0
    ds_read_b128 v[128:131], v8 offset:0
    ds_read_b128 v[132:135], v11 offset:4096
    ds_read_b128 v[136:139], v8 offset:4096
    ds_read_b128 v[140:143], v11 offset:8192
    ds_read_b128 v[144:147], v8 offset:8192
    ds_read_b128 v[148:151], v11 offset:12288
    ds_read_b128 v[152:155], v8 offset:12288
    s_barrier
    ds_read_b128 v[156:159], v11 offset:16384
    ds_read_b128 v[160:163], v8 offset:16384
    s_waitcnt lgkmcnt(8)
    v_mfma_f32_32x32x16_bf16 v[60:75], v[128:131], v[124:127], 0
    ds_read_b128 v[124:127], v11 offset:20480
    ds_read_b128 v[128:131], v8 offset:20480
    s_waitcnt lgkmcnt(8)
    v_mfma_f32_32x32x16_bf16 v[60:75], v[136:139], v[132:135], v[60:75]
    ds_read_b128 v[132:135], v11 offset:24576
    ds_read_b128 v[136:139], v8 offset:24576
    s_waitcnt lgkmcnt(8)
    v_mfma_f32_32x32x16_bf16 v[60:75], v[144:147], v[140:143], v[60:75]
    ds_read_b128 v[140:143], v11 offset:28672
    ds_read_b128 v[144:147], v8 offset:28672
    s_waitcnt lgkmcnt(8)
    v_mfma_f32_32x32x16_bf16 v[60:75], v[152:155], v[148:151], v[60:75]
    s_barrier
    v_mov_b32 v245, s50
    buffer_load_dword v244, v245, s[12:15], 0 offen sc1
    ds_read_b128 v[148:151], v11 offset:32768
    ds_read_b128 v[152:155], v8 offset:32768
    s_waitcnt lgkmcnt(8)
    v_mfma_f32_32x32x16_bf16 v[60:75], v[160:163], v[156:159], v[60:75]
    ds_read_b128 v[156:159], v11 offset:36864
    ds_read_b128 v[160:163], v8 offset:36864
    s_waitcnt lgkmcnt(8)
    v_mfma_f32_32x32x16_bf16 v[60:75], v[128:131], v[124:127], v[60:75]
    ds_read_b128 v[124:127], v11 offset:40960
    ds_read_b128 v[128:131], v8 offset:40960
    s_waitcnt lgkmcnt(8)
    v_mfma_f32_32x32x16_bf16 v[60:75], v[136:139], v[132:135], v[60:75]
    ds_read_b128 v[132:135], v11 offset:45056
    ds_read_b128 v[136:139], v8 offset:45056
    s_waitcnt lgkmcnt(8)
    v_mfma_f32_32x32x16_bf16 v[60:75], v[144:147], v[140:143], v[60:75]
    s_barrier
    ds_read_b128 v[140:143], v11 offset:49152
    ds_read_b128 v[144:147], v8 offset:49152
    s_waitcnt lgkmcnt(8)
    v_mfma_f32_32x32x16_bf16 v[60:75], v[152:155], v[148:151], v[60:75]
    ds_read_b128 v[148:151], v11 offset:53248
    ds_read_b128 v[152:155], v8 offset:53248
    s_waitcnt lgkmcnt(8)
    v_mfma_f32_32x32x16_bf16 v[60:75], v[160:163], v[156:159], v[60:75]
    ds_read_b128 v[156:159], v11 offset:57344
    ds_read_b128 v[160:163], v8 offset:57344
    s_waitcnt lgkmcnt(8)
    v_mfma_f32_32x32x16_bf16 v[60:75], v[128:131], v[124:127], v[60:75]
    ds_read_b128 v[124:127], v11 offset:61440
    ds_read_b128 v[128:131], v8 offset:61440
    s_waitcnt lgkmcnt(8)
    v_mfma_f32_32x32x16_bf16 v[60:75], v[136:139], v[132:135], v[60:75]
    s_barrier
    ds_read_b128 v[132:135], v12 offset:0
    ds_read_b128 v[136:139], v9 offset:0
    s_waitcnt lgkmcnt(8)
    v_mfma_f32_32x32x16_bf16 v[60:75], v[144:147], v[140:143], v[60:75]
    ds_read_b128 v[140:143], v12 offset:4096
    ds_read_b128 v[144:147], v9 offset:4096
    s_waitcnt lgkmcnt(8)
    v_mfma_f32_32x32x16_bf16 v[60:75], v[152:155], v[148:151], v[60:75]
    ds_read_b128 v[148:151], v12 offset:8192
    ds_read_b128 v[152:155], v9 offset:8192
    s_waitcnt lgkmcnt(8)
    v_mfma_f32_32x32x16_bf16 v[60:75], v[160:163], v[156:159], v[60:75]
    ds_read_b128 v[156:159], v12 offset:12288
    ds_read_b128 v[160:163], v9 offset:12288
    s_waitcnt lgkmcnt(8)
    v_mfma_f32_32x32x16_bf16 v[60:75], v[128:131], v[124:127], v[60:75]
    s_barrier
    ds_read_b128 v[124:127], v12 offset:16384
    ds_read_b128 v[128:131], v9 offset:16384
    s_waitcnt lgkmcnt(8)
    v_mfma_f32_32x32x16_bf16 v[60:75], v[136:139], v[132:135], v[60:75]
    ds_read_b128 v[132:135], v12 offset:20480
    ds_read_b128 v[136:139], v9 offset:20480
    s_waitcnt lgkmcnt(8)
    v_mfma_f32_32x32x16_bf16 v[60:75], v[144:147], v[140:143], v[60:75]
    ds_read_b128 v[140:143], v12 offset:24576
    ds_read_b128 v[144:147], v9 offset:24576
    s_waitcnt lgkmcnt(8)
    v_mfma_f32_32x32x16_bf16 v[60:75], v[152:155], v[148:151], v[60:75]
    ds_read_b128 v[148:151], v12 offset:28672
    ds_read_b128 v[152:155], v9 offset:28672
    s_waitcnt lgkmcnt(8)
    v_mfma_f32_32x32x16_bf16 v[60:75], v[160:163], v[156:159], v[60:75]
    s_barrier
    ds_read_b128 v[156:159], v12 offset:32768
    ds_read_b128 v[160:163], v9 offset:32768
    s_waitcnt lgkmcnt(8)
    v_mfma_f32_32x32x16_bf16 v[60:75], v[128:131], v[124:127], v[60:75]
    ds_read_b128 v[124:127], v12 offset:36864
    ds_read_b128 v[128:131], v9 offset:36864
    s_waitcnt lgkmcnt(8)
    v_mfma_f32_32x32x16_bf16 v[60:75], v[136:139], v[132:135], v[60:75]
    ds_read_b128 v[132:135], v12 offset:40960
    ds_read_b128 v[136:139], v9 offset:40960
    s_waitcnt lgkmcnt(8)
    v_mfma_f32_32x32x16_bf16 v[60:75], v[144:147], v[140:143], v[60:75]
    ds_read_b128 v[140:143], v12 offset:45056
    ds_read_b128 v[144:147], v9 offset:45056
    s_waitcnt lgkmcnt(8)
    v_mfma_f32_32x32x16_bf16 v[60:75], v[152:155], v[148:151], v[60:75]
    s_barrier
    s_waitcnt vmcnt(0)
    s_getreg_b32 s34, hwreg(HW_REG_XCC_ID, 0, 3)
    s_lshl_b32 s34, s34, 2
    s_lshl_b32 s34, 8, s34
    s_mov_b32 s47, 0
    s_branch L_chain0_kernel_hc5
L_chain0_kernel_hl3:
    buffer_load_dword v244, v245, s[12:15], 0 offen sc1
    s_waitcnt vmcnt(0)
L_chain0_kernel_hc5:
    v_readfirstlane_b32 s36, v244
    s_add_u32 s47, s47, 1
    s_cmp_gt_u32 s47, 262144
    s_cbranch_scc1 L_chain0_kernel_hd4
    s_and_b32 s37, s36, 0x0f0f0f0f
    s_lshr_b32 s38, s36, 4
    s_and_b32 s38, s38, 0x0f0f0f0f
    s_add_u32 s37, s37, s38
    s_mul_i32 s37, s37, 0x01010101
    s_lshr_b32 s37, s37, 24
    s_cmp_lt_u32 s37, 8
    s_cbranch_scc1 L_chain0_kernel_hl3
L_chain0_kernel_hd4:
    s_cmp_eq_u32 s36, s34
    s_cselect_b32 s29, 1, 0
    v_permlane32_swap_b32 v188, v190
    v_permlane32_swap_b32 v189, v191
    v_permlane32_swap_b32 v192, v194
    v_permlane32_swap_b32 v193, v195
    s_nop 1
    v_lshlrev_b32 v28, 16, v188
    v_and_b32 v29, 0xffff0000, v188
    v_lshlrev_b32 v30, 16, v189
    v_and_b32 v31, 0xffff0000, v189
    v_lshlrev_b32 v32, 16, v190
    v_and_b32 v33, 0xffff0000, v190
    v_lshlrev_b32 v34, 16, v191
    v_and_b32 v35, 0xffff0000, v191
    v_lshlrev_b32 v36, 16, v192
    v_and_b32 v37, 0xffff0000, v192
    v_lshlrev_b32 v38, 16, v193
    v_and_b32 v39, 0xffff0000, v193
    v_lshlrev_b32 v40, 16, v194
    v_and_b32 v41, 0xffff0000, v194
    v_lshlrev_b32 v42, 16, v195
    v_and_b32 v43, 0xffff0000, v195
    ds_read_b128 v[148:151], v12 offset:49152
    ds_read_b128 v[152:155], v9 offset:49152
    s_waitcnt lgkmcnt(8)
    v_mfma_f32_32x32x16_bf16 v[60:75], v[160:163], v[156:159], v[60:75]
    ds_read_b128 v[156:159], v12 offset:53248
    ds_read_b128 v[160:163], v9 offset:53248
    s_waitcnt lgkmcnt(8)
    v_mfma_f32_32x32x16_bf16 v[60:75], v[128:131], v[124:127], v[60:75]
    ds_read_b128 v[124:127], v12 offset:57344
    ds_read_b128 v[128:131], v9 offset:57344
    s_waitcnt lgkmcnt(8)
    v_mfma_f32_32x32x16_bf16 v[60:75], v[136:139], v[132:135], v[60:75]
    ds_read_b128 v[132:135], v12 offset:61440
    ds_read_b128 v[136:139], v9 offset:61440
    s_waitcnt lgkmcnt(8)
    v_mfma_f32_32x32x16_bf16 v[60:75], v[144:147], v[140:143], v[60:75]
    s_waitcnt lgkmcnt(6)
    v_mfma_f32_32x32x16_bf16 v[60:75], v[152:155], v[148:151], v[60:75]
    s_waitcnt lgkmcnt(4)
    v_mfma_f32_32x32x16_bf16 v[60:75], v[160:163], v[156:159], v[60:75]
    s_waitcnt lgkmcnt(2)
    v_mfma_f32_32x32x16_bf16 v[60:75], v[128:131], v[124:127], v[60:75]
    s_waitcnt lgkmcnt(0)
    v_mfma_f32_32x32x16_bf16 v[60:75], v[136:139], v[132:135], v[60:75]
    s_barrier
    s_mul_i32 s32, s28, 32768
    s_lshl_b32 s33, s45, 10
    s_add_u32 s32, s32, s33
    s_add_u32 s32, s32, 22020096
    s_nop 7
    v_pk_add_f32 v[28:29], v[28:29], v[60:61]
    v_pk_add_f32 v[30:31], v[30:31], v[62:63]
    v_pk_add_f32 v[32:33], v[32:33], v[64:65]
    v_pk_add_f32 v[34:35], v[34:35], v[66:67]
    v_pk_add_f32 v[36:37], v[36:37], v[68:69]
    v_pk_add_f32 v[38:39], v[38:39], v[70:71]
    v_pk_add_f32 v[40:41], v[40:41], v[72:73]
    v_pk_add_f32 v[42:43], v[42:43], v[74:75]
    v_cvt_pk_bf16_f32 v236, v28, v29
    v_cvt_pk_bf16_f32 v237, v30, v31
    v_cvt_pk_bf16_f32 v238, v32, v33
    v_cvt_pk_bf16_f32 v239, v34, v35
    v_cvt_pk_bf16_f32 v240, v36, v37
    v_cvt_pk_bf16_f32 v241, v38, v39
    v_cvt_pk_bf16_f32 v242, v40, v41
    v_cvt_pk_bf16_f32 v243, v42, v43
    s_cmp_eq_u32 s29, 1
    s_cbranch_scc1 L_chain0_kernel_sf6
    buffer_store_dwordx4 v[236:239], v14, s[12:15], s32 offen offset:0 sc1
    buffer_store_dwordx4 v[240:243], v14, s[12:15], s32 offen offset:1024 sc1
    s_branch L_chain0_kernel_sd7
L_chain0_kernel_sf6:
    buffer_store_dwordx4 v[236:239], v14, s[12:15], s32 offen offset:0
    buffer_store_dwordx4 v[240:243], v14, s[12:15], s32 offen offset:1024
L_chain0_kernel_sd7:
    v_pk_add_f32 v[2:3], v[28:29], v[30:31]
    v_pk_mul_f32 v[4:5], v[28:29], v[28:29]
    v_pk_fma_f32 v[4:5], v[30:31], v[30:31], v[4:5]
    v_pk_add_f32 v[2:3], v[2:3], v[32:33]
    v_pk_fma_f32 v[4:5], v[32:33], v[32:33], v[4:5]
    v_pk_add_f32 v[2:3], v[2:3], v[34:35]
    v_pk_fma_f32 v[4:5], v[34:35], v[34:35], v[4:5]
    v_pk_add_f32 v[2:3], v[2:3], v[36:37]
    v_pk_fma_f32 v[4:5], v[36:37], v[36:37], v[4:5]
    v_pk_add_f32 v[2:3], v[2:3], v[38:39]
    v_pk_fma_f32 v[4:5], v[38:39], v[38:39], v[4:5]
    v_pk_add_f32 v[2:3], v[2:3], v[40:41]
    v_pk_fma_f32 v[4:5], v[40:41], v[40:41], v[4:5]
    v_pk_add_f32 v[2:3], v[2:3], v[42:43]
    v_pk_fma_f32 v[4:5], v[42:43], v[42:43], v[4:5]
    v_add_f32 v2, v2, v3
    v_add_f32 v3, v4, v5
    s_nop 1
    v_permlane32_swap_b32 v2, v3
    s_nop 1
    v_add_f32 v2, v2, v3
    s_lshl_b32 s34, s28, 12
    s_lshl_b32 s35, s44, 8
    s_add_u32 s34, s34, s35
    s_add_u32 s34, s34, 20185088
    v_lshlrev_b32 v4, 2, v0
    s_cmp_eq_u32 s29, 1
    s_cbranch_scc1 L_chain0_kernel_sf8
    buffer_store_dword v2, v4, s[12:15], s34 offen sc1
    s_branch L_chain0_kernel_sd9
L_chain0_kernel_sf8:
    buffer_store_dword v2, v4, s[12:15], s34 offen
L_chain0_kernel_sd9:
    s_waitcnt vmcnt(0)
    s_barrier
    s_cmp_lg_u32 s22, 0
    s_cbranch_scc1 L_chain0_kernel_ya10
    s_mov_b64 s[40:41], exec
    s_cmp_eq_u32 s29, 1
    s_cbranch_scc0 L_chain0_kernel_yb11
    s_mov_b32 s30, 1
    s_atomic_add s30, s[48:49], 0x2000
    s_branch L_chain0_kernel_yc12
L_chain0_kernel_yb11:
    s_add_u32 s30, s50, 8192
    s_mov_b64 exec, 1
    v_mov_b32 v2, s30
    v_mov_b32 v3, 1
    buffer_atomic_add v3, v2, s[12:15], 0 offen sc1
L_chain0_kernel_yc12:
    s_mov_b64 exec, s[40:41]
L_chain0_kernel_ya10:
    s_cmp_lg_u32 s22, 0
    s_cbranch_scc1 L_chain0_kernel_yk13
    s_mov_b64 s[40:41], exec
    s_cmp_eq_u32 s29, 1
    s_cbranch_scc0 L_chain0_kernel_ys14
    s_mov_b32 s47, 0
L_chain0_kernel_yl16:
    s_mov_b32 s31, 0
    s_atomic_add s31, s[48:49], 0x2000 glc
    s_add_u32 s47, s47, 1
    s_cmp_gt_u32 s47, 262144
    s_cbranch_scc1 L_chain0_kernel_ye17
    s_waitcnt lgkmcnt(0)
    s_cmp_ge_u32 s31, 8
    s_cbranch_scc0 L_chain0_kernel_yl16
L_chain0_kernel_ye17:
    s_waitcnt lgkmcnt(0)
    s_branch L_chain0_kernel_yd15
L_chain0_kernel_ys14:
    s_add_u32 s30, s50, 8192
    s_mov_b64 exec, 1
    v_mov_b32 v2, s30
    v_mov_b32 v3, 8
    s_mov_b32 s47, 0
L_chain0_kernel_pl18:
    buffer_load_dword v4, v2, s[12:15], 0 offen sc1
    s_add_u32 s47, s47, 1
    s_cmp_gt_u32 s47, 262144
    s_cbranch_scc1 L_chain0_kernel_pd19
    s_waitcnt vmcnt(0)
    v_cmp_ge_u32 vcc, v4, v3
    s_nop 1
    s_cmp_eq_u32 vcc_lo, 1
    s_cbranch_scc0 L_chain0_kernel_pl18
L_chain0_kernel_pd19:
    s_waitcnt vmcnt(0)
L_chain0_kernel_yd15:
    s_mov_b64 exec, s[40:41]
L_chain0_kernel_yk13:
    s_barrier
    s_mul_i32 s30, s24, 1024
    s_add_u32 s30, s30, 2048
    v_lshlrev_b32 v11, 4, v0
    v_add_u32 v8, s30, v11
    s_lshl_b32 s30, s23, 10
    v_add_u32 v11, s30, v11
    v_add_u32 v9, 65536, v8
    v_add_u32 v12, 65536, v11
    s_barrier
    ds_read_b128 v[124:127], v11 offset:0
    ds_read_b128 v[128:131], v8 offset:0
    ds_read_b128 v[132:135], v11 offset:4096
    ds_read_b128 v[136:139], v8 offset:4096
    ds_read_b128 v[140:143], v11 offset:8192
    ds_read_b128 v[144:147], v8 offset:8192
    ds_read_b128 v[148:151], v11 offset:12288
    ds_read_b128 v[152:155], v8 offset:12288
    s_waitcnt lgkmcnt(0)
    s_lshl_b32 s30, s23, 12
    s_add_u32 s30, s30, 149504
    v_lshlrev_b32 v2, 2, v0
    v_add_u32 v2, s30, v2
    ds_read2st64_b32 v[188:189], v2 offset0:0 offset1:1
    ds_read2st64_b32 v[190:191], v2 offset0:2 offset1:3
    ds_read2st64_b32 v[192:193], v2 offset0:4 offset1:5
    ds_read2st64_b32 v[194:195], v2 offset0:6 offset1:7
    ds_read2st64_b32 v[196:197], v2 offset0:8 offset1:9
    ds_read2st64_b32 v[198:199], v2 offset0:10 offset1:11
    ds_read2st64_b32 v[200:201], v2 offset0:12 offset1:13
    ds_read2st64_b32 v[202:203], v2 offset0:14 offset1:15
    s_lshl_b32 s33, s24, 7
    s_add_u32 s33, s33, 148480
    v_lshrrev_b32 v3, 5, v0
    v_lshlrev_b32 v3, 4, v3
    v_add_u32 v15, s33, v3
    ds_read_b128 v[204:207], v15 offset:0
    ds_read_b128 v[208:211], v15 offset:32
    ds_read_b128 v[212:215], v15 offset:64
    ds_read_b128 v[216:219], v15 offset:96
    s_waitcnt lgkmcnt(0)
    v_add_f32 v188, v188, v196
    v_add_f32 v189, v189, v197
    v_add_f32 v190, v190, v198
    v_add_f32 v191, v191, v199
    v_add_f32 v192, v192, v200
    v_add_f32 v193, v193, v201
    v_add_f32 v194, v194, v202
    v_add_f32 v195, v195, v203
    v_add_f32 v188, v188, v192
    v_add_f32 v189, v189, v193
    v_add_f32 v190, v190, v194
    v_add_f32 v191, v191, v195
    v_add_f32 v188, v188, v190
    v_add_f32 v189, v189, v191
    v_add_f32 v188, v188, v189
    v_mov_b32 v189, v188
    s_nop 1
    v_permlane32_swap_b32 v188, v189
    s_nop 1
    v_mul_f32 v16, 0x3b000000, v188
    v_mul_f32 v25, 0x3b000000, v189
    v_fma_f32 v25, -v16, v16, v25
    v_max_f32 v25, 0, v25
    v_add_f32 v17, 0x3727c5ac, v25
    v_rsq_f32 v17, v17
    s_nop 0
    v_mul_f32 v27, v17, v17
    v_mul_f32 v27, v27, v25
    v_add_f32 v27, 0x3727c5ac, v27
    v_rsq_f32 v27, v27
    s_nop 0
    v_mul_f32 v18, v17, v27
    v_mul_f32_e64 v19, -v16, v18
    v_mov_b32 v22, 0xc0135761
    v_mov_b32 v23, 0xbdd2d3e8
    v_pk_mul_f32 v[204:205], v[204:205], v[18:19] op_sel:[0,1] op_sel_hi:[1,1]
    v_pk_mul_f32 v[206:207], v[206:207], v[18:19] op_sel:[0,1] op_sel_hi:[1,1]
    v_pk_mul_f32 v[208:209], v[208:209], v[18:19] op_sel:[0,1] op_sel_hi:[1,1]
    v_pk_mul_f32 v[210:211], v[210:211], v[18:19] op_sel:[0,1] op_sel_hi:[1,1]
    v_pk_mul_f32 v[212:213], v[212:213], v[18:19] op_sel:[0,1] op_sel_hi:[1,1]
    v_pk_mul_f32 v[214:215], v[214:215], v[18:19] op_sel:[0,1] op_sel_hi:[1,1]
    v_pk_mul_f32 v[216:217], v[216:217], v[18:19] op_sel:[0,1] op_sel_hi:[1,1]
    v_pk_mul_f32 v[218:219], v[218:219], v[18:19] op_sel:[0,1] op_sel_hi:[1,1]
    s_barrier
    ds_read_b128 v[156:159], v11 offset:16384
    ds_read_b128 v[160:163], v8 offset:16384
    v_mfma_f32_32x32x16_bf16 v[60:75], v[128:131], v[124:127], 0
    ds_read_b128 v[124:127], v11 offset:20480
    ds_read_b128 v[128:131], v8 offset:20480
    v_mfma_f32_32x32x16_bf16 v[60:75], v[136:139], v[132:135], v[60:75]
    ds_read_b128 v[132:135], v11 offset:24576
    ds_read_b128 v[136:139], v8 offset:24576
    v_mfma_f32_32x32x16_bf16 v[60:75], v[144:147], v[140:143], v[60:75]
    ds_read_b128 v[140:143], v11 offset:28672
    ds_read_b128 v[144:147], v8 offset:28672
    v_mfma_f32_32x32x16_bf16 v[60:75], v[152:155], v[148:151], v[60:75]
    s_barrier
    ds_read_b128 v[148:151], v11 offset:32768
    ds_read_b128 v[152:155], v8 offset:32768
    s_waitcnt lgkmcnt(8)
    v_mfma_f32_32x32x16_bf16 v[60:75], v[160:163], v[156:159], v[60:75]
    ds_read_b128 v[156:159], v11 offset:36864
    ds_read_b128 v[160:163], v8 offset:36864
    s_waitcnt lgkmcnt(8)
    v_mfma_f32_32x32x16_bf16 v[60:75], v[128:131], v[124:127], v[60:75]
    ds_read_b128 v[124:127], v11 offset:40960
    ds_read_b128 v[128:131], v8 offset:40960
    s_waitcnt lgkmcnt(8)
    v_mfma_f32_32x32x16_bf16 v[60:75], v[136:139], v[132:135], v[60:75]
    ds_read_b128 v[132:135], v11 offset:45056
    ds_read_b128 v[136:139], v8 offset:45056
    s_waitcnt lgkmcnt(8)
    v_mfma_f32_32x32x16_bf16 v[60:75], v[144:147], v[140:143], v[60:75]
    s_barrier
    ds_read_b128 v[140:143], v11 offset:49152
    ds_read_b128 v[144:147], v8 offset:49152
    s_waitcnt lgkmcnt(8)
    v_mfma_f32_32x32x16_bf16 v[60:75], v[152:155], v[148:151], v[60:75]
    ds_read_b128 v[148:151], v11 offset:53248
    ds_read_b128 v[152:155], v8 offset:53248
    s_waitcnt lgkmcnt(8)
    v_mfma_f32_32x32x16_bf16 v[60:75], v[160:163], v[156:159], v[60:75]
    ds_read_b128 v[156:159], v11 offset:57344
    ds_read_b128 v[160:163], v8 offset:57344
    s_waitcnt lgkmcnt(8)
    v_mfma_f32_32x32x16_bf16 v[60:75], v[128:131], v[124:127], v[60:75]
    ds_read_b128 v[124:127], v11 offset:61440
    ds_read_b128 v[128:131], v8 offset:61440
    s_waitcnt lgkmcnt(8)
    v_mfma_f32_32x32x16_bf16 v[60:75], v[136:139], v[132:135], v[60:75]
    s_barrier
    ds_read_b128 v[132:135], v12 offset:0
    ds_read_b128 v[136:139], v9 offset:0
    s_waitcnt lgkmcnt(8)
    v_mfma_f32_32x32x16_bf16 v[60:75], v[144:147], v[140:143], v[60:75]
    ds_read_b128 v[140:143], v12 offset:4096
    ds_read_b128 v[144:147], v9 offset:4096
    s_waitcnt lgkmcnt(8)
    v_mfma_f32_32x32x16_bf16 v[60:75], v[152:155], v[148:151], v[60:75]
    ds_read_b128 v[148:151], v12 offset:8192
    ds_read_b128 v[152:155], v9 offset:8192
    s_waitcnt lgkmcnt(8)
    v_mfma_f32_32x32x16_bf16 v[60:75], v[160:163], v[156:159], v[60:75]
    ds_read_b128 v[156:159], v12 offset:12288
    ds_read_b128 v[160:163], v9 offset:12288
    s_waitcnt lgkmcnt(8)
    v_mfma_f32_32x32x16_bf16 v[60:75], v[128:131], v[124:127], v[60:75]
    s_barrier
    ds_read_b128 v[124:127], v12 offset:16384
    ds_read_b128 v[128:131], v9 offset:16384
    s_waitcnt lgkmcnt(8)
    v_mfma_f32_32x32x16_bf16 v[60:75], v[136:139], v[132:135], v[60:75]
    ds_read_b128 v[132:135], v12 offset:20480
    ds_read_b128 v[136:139], v9 offset:20480
    s_waitcnt lgkmcnt(8)
    v_mfma_f32_32x32x16_bf16 v[60:75], v[144:147], v[140:143], v[60:75]
    ds_read_b128 v[140:143], v12 offset:24576
    ds_read_b128 v[144:147], v9 offset:24576
    s_waitcnt lgkmcnt(8)
    v_mfma_f32_32x32x16_bf16 v[60:75], v[152:155], v[148:151], v[60:75]
    ds_read_b128 v[148:151], v12 offset:28672
    ds_read_b128 v[152:155], v9 offset:28672
    s_waitcnt lgkmcnt(8)
    v_mfma_f32_32x32x16_bf16 v[60:75], v[160:163], v[156:159], v[60:75]
    s_barrier
    ds_read_b128 v[156:159], v12 offset:32768
    ds_read_b128 v[160:163], v9 offset:32768
    s_waitcnt lgkmcnt(8)
    v_mfma_f32_32x32x16_bf16 v[60:75], v[128:131], v[124:127], v[60:75]
    ds_read_b128 v[124:127], v12 offset:36864
    ds_read_b128 v[128:131], v9 offset:36864
    s_waitcnt lgkmcnt(8)
    v_mfma_f32_32x32x16_bf16 v[60:75], v[136:139], v[132:135], v[60:75]
    ds_read_b128 v[132:135], v12 offset:40960
    ds_read_b128 v[136:139], v9 offset:40960
    s_waitcnt lgkmcnt(8)
    v_mfma_f32_32x32x16_bf16 v[60:75], v[144:147], v[140:143], v[60:75]
    ds_read_b128 v[140:143], v12 offset:45056
    ds_read_b128 v[144:147], v9 offset:45056
    s_waitcnt lgkmcnt(8)
    v_mfma_f32_32x32x16_bf16 v[60:75], v[152:155], v[148:151], v[60:75]
    s_barrier
    ds_read_b128 v[148:151], v12 offset:49152
    ds_read_b128 v[152:155], v9 offset:49152
    s_waitcnt lgkmcnt(8)
    v_mfma_f32_32x32x16_bf16 v[60:75], v[160:163], v[156:159], v[60:75]
    ds_read_b128 v[156:159], v12 offset:53248
    ds_read_b128 v[160:163], v9 offset:53248
    s_waitcnt lgkmcnt(8)
    v_mfma_f32_32x32x16_bf16 v[60:75], v[128:131], v[124:127], v[60:75]
    ds_read_b128 v[124:127], v12 offset:57344
    ds_read_b128 v[128:131], v9 offset:57344
    s_waitcnt lgkmcnt(8)
    v_mfma_f32_32x32x16_bf16 v[60:75], v[136:139], v[132:135], v[60:75]
    ds_read_b128 v[132:135], v12 offset:61440
    ds_read_b128 v[136:139], v9 offset:61440
    s_waitcnt lgkmcnt(8)
    v_mfma_f32_32x32x16_bf16 v[60:75], v[144:147], v[140:143], v[60:75]
    s_waitcnt lgkmcnt(6)
    v_mfma_f32_32x32x16_bf16 v[60:75], v[152:155], v[148:151], v[60:75]
    s_waitcnt lgkmcnt(4)
    v_mfma_f32_32x32x16_bf16 v[60:75], v[160:163], v[156:159], v[60:75]
    s_waitcnt lgkmcnt(2)
    v_mfma_f32_32x32x16_bf16 v[60:75], v[128:131], v[124:127], v[60:75]
    s_waitcnt lgkmcnt(0)
    v_mfma_f32_32x32x16_bf16 v[60:75], v[136:139], v[132:135], v[60:75]
    s_barrier
    s_mul_i32 s32, s28, 32768
    s_lshl_b32 s33, s45, 10
    s_add_u32 s32, s32, s33
    s_add_u32 s32, s32, 2097152
    s_nop 7
    v_pk_fma_f32 v[60:61], v[60:61], v[18:19], v[204:205] op_sel:[0,0,0] op_sel_hi:[1,0,1]
    v_pk_fma_f32 v[62:63], v[62:63], v[18:19], v[206:207] op_sel:[0,0,0] op_sel_hi:[1,0,1]
    v_pk_fma_f32 v[64:65], v[64:65], v[18:19], v[208:209] op_sel:[0,0,0] op_sel_hi:[1,0,1]
    v_pk_fma_f32 v[66:67], v[66:67], v[18:19], v[210:211] op_sel:[0,0,0] op_sel_hi:[1,0,1]
    v_pk_fma_f32 v[68:69], v[68:69], v[18:19], v[212:213] op_sel:[0,0,0] op_sel_hi:[1,0,1]
    v_pk_fma_f32 v[70:71], v[70:71], v[18:19], v[214:215] op_sel:[0,0,0] op_sel_hi:[1,0,1]
    v_pk_fma_f32 v[72:73], v[72:73], v[18:19], v[216:217] op_sel:[0,0,0] op_sel_hi:[1,0,1]
    v_pk_fma_f32 v[74:75], v[74:75], v[18:19], v[218:219] op_sel:[0,0,0] op_sel_hi:[1,0,1]
    v_pk_mul_f32 v[124:125], v[60:61], v[60:61]
    v_pk_mul_f32 v[126:127], v[62:63], v[62:63]
    v_pk_mul_f32 v[128:129], v[64:65], v[64:65]
    v_pk_mul_f32 v[130:131], v[66:67], v[66:67]
    v_pk_mul_f32 v[132:133], v[68:69], v[68:69]
    v_pk_mul_f32 v[134:135], v[70:71], v[70:71]
    v_pk_mul_f32 v[136:137], v[72:73], v[72:73]
    v_pk_mul_f32 v[138:139], v[74:75], v[74:75]
    v_pk_fma_f32 v[124:125], v[124:125], v[22:23], v[22:23] op_sel:[0,1,0] op_sel_hi:[1,1,0]
    v_pk_fma_f32 v[126:127], v[126:127], v[22:23], v[22:23] op_sel:[0,1,0] op_sel_hi:[1,1,0]
    v_pk_fma_f32 v[128:129], v[128:129], v[22:23], v[22:23] op_sel:[0,1,0] op_sel_hi:[1,1,0]
    v_pk_fma_f32 v[130:131], v[130:131], v[22:23], v[22:23] op_sel:[0,1,0] op_sel_hi:[1,1,0]
    v_pk_fma_f32 v[132:133], v[132:133], v[22:23], v[22:23] op_sel:[0,1,0] op_sel_hi:[1,1,0]
    v_pk_fma_f32 v[134:135], v[134:135], v[22:23], v[22:23] op_sel:[0,1,0] op_sel_hi:[1,1,0]
    v_pk_fma_f32 v[136:137], v[136:137], v[22:23], v[22:23] op_sel:[0,1,0] op_sel_hi:[1,1,0]
    v_pk_fma_f32 v[138:139], v[138:139], v[22:23], v[22:23] op_sel:[0,1,0] op_sel_hi:[1,1,0]
    v_pk_mul_f32 v[124:125], v[124:125], v[60:61]
    v_pk_mul_f32 v[126:127], v[126:127], v[62:63]
    v_pk_mul_f32 v[128:129], v[128:129], v[64:65]
    v_pk_mul_f32 v[130:131], v[130:131], v[66:67]
    v_pk_mul_f32 v[132:133], v[132:133], v[68:69]
    v_pk_mul_f32 v[134:135], v[134:135], v[70:71]
    v_pk_mul_f32 v[136:137], v[136:137], v[72:73]
    v_pk_mul_f32 v[138:139], v[138:139], v[74:75]
    v_exp_f32 v124, v124
    v_exp_f32 v125, v125
    v_exp_f32 v126, v126
    v_exp_f32 v127, v127
    v_exp_f32 v128, v128
    v_exp_f32 v129, v129
    v_exp_f32 v130, v130
    v_exp_f32 v131, v131
    v_exp_f32 v132, v132
    v_exp_f32 v133, v133
    v_exp_f32 v134, v134
    v_exp_f32 v135, v135
    v_exp_f32 v136, v136
    v_exp_f32 v137, v137
    v_exp_f32 v138, v138
    v_exp_f32 v139, v139
    v_pk_add_f32 v[124:125], v[124:125], 1.0 op_sel_hi:[1,0]
    v_pk_add_f32 v[126:127], v[126:127], 1.0 op_sel_hi:[1,0]
    v_pk_add_f32 v[128:129], v[128:129], 1.0 op_sel_hi:[1,0]
    v_pk_add_f32 v[130:131], v[130:131], 1.0 op_sel_hi:[1,0]
    v_pk_add_f32 v[132:133], v[132:133], 1.0 op_sel_hi:[1,0]
    v_pk_add_f32 v[134:135], v[134:135], 1.0 op_sel_hi:[1,0]
    v_pk_add_f32 v[136:137], v[136:137], 1.0 op_sel_hi:[1,0]
    v_pk_add_f32 v[138:139], v[138:139], 1.0 op_sel_hi:[1,0]
    v_rcp_f32 v124, v124
    v_rcp_f32 v125, v125
    v_rcp_f32 v126, v126
    v_rcp_f32 v127, v127
    v_rcp_f32 v128, v128
    v_rcp_f32 v129, v129
    v_rcp_f32 v130, v130
    v_rcp_f32 v131, v131
    v_rcp_f32 v132, v132
    v_rcp_f32 v133, v133
    v_rcp_f32 v134, v134
    v_rcp_f32 v135, v135
    v_rcp_f32 v136, v136
    v_rcp_f32 v137, v137
    v_rcp_f32 v138, v138
    v_rcp_f32 v139, v139
    v_pk_mul_f32 v[60:61], v[60:61], v[124:125]
    v_pk_mul_f32 v[62:63], v[62:63], v[126:127]
    v_pk_mul_f32 v[64:65], v[64:65], v[128:129]
    v_pk_mul_f32 v[66:67], v[66:67], v[130:131]
    v_pk_mul_f32 v[68:69], v[68:69], v[132:133]
    v_pk_mul_f32 v[70:71], v[70:71], v[134:135]
    v_pk_mul_f32 v[72:73], v[72:73], v[136:137]
    v_pk_mul_f32 v[74:75], v[74:75], v[138:139]
    v_cvt_pk_bf16_f32 v236, v60, v61
    v_cvt_pk_bf16_f32 v237, v62, v63
    v_cvt_pk_bf16_f32 v238, v64, v65
    v_cvt_pk_bf16_f32 v239, v66, v67
    v_cvt_pk_bf16_f32 v240, v68, v69
    v_cvt_pk_bf16_f32 v241, v70, v71
    v_cvt_pk_bf16_f32 v242, v72, v73
    v_cvt_pk_bf16_f32 v243, v74, v75
    s_cmp_eq_u32 s29, 1
    s_cbranch_scc1 L_chain0_kernel_sf20
    buffer_store_dwordx4 v[236:239], v14, s[12:15], s32 offen offset:0 sc1
    buffer_store_dwordx4 v[240:243], v14, s[12:15], s32 offen offset:1024 sc1
    s_branch L_chain0_kernel_sd21
L_chain0_kernel_sf20:
    buffer_store_dwordx4 v[236:239], v14, s[12:15], s32 offen offset:0
    buffer_store_dwordx4 v[240:243], v14, s[12:15], s32 offen offset:1024
L_chain0_kernel_sd21:
    s_bfe_u32 s34, s21, 0x10001
    s_xor_b32 s35, s34, 1
    s_cmp_lg_u32 s35, s23
    s_cbranch_scc1 L_chain0_kernel_nh22
    s_mul_i32 s35, s35, 30
    v_and_b32 v2, 31, v0
    v_subrev_u32 v2, s35, v2
    v_cmp_gt_u32 vcc, 2, v2
    v_lshlrev_b32 v2, 4, v2
    v_lshrrev_b32 v3, 5, v0
    v_lshl_add_u32 v2, v3, 5, v2
    s_lshl_b32 s36, s20, 11
    s_lshl_b32 s37, s45, 6
    s_add_u32 s36, s36, s37
    s_add_u32 s36, s36, 20971520
    s_and_saveexec_b64 s[40:41], vcc
    buffer_store_dwordx4 v[236:239], v2, s[12:15], s36 offen sc1
    buffer_store_dwordx4 v[240:243], v2, s[12:15], s36 offen offset:64 sc1
    s_mov_b64 exec, s[40:41]
    s_waitcnt vmcnt(2)
    s_branch L_chain0_kernel_hd23
L_chain0_kernel_nh22:
    s_waitcnt vmcnt(0)
L_chain0_kernel_hd23:
    s_barrier
    s_cmp_lg_u32 s22, 1
    s_cbranch_scc1 L_chain0_kernel_w124
    v_lshrrev_b32 v2, 2, v0
    v_add_u32 v2, 0, v2
    v_bfe_u32 v3, v0, 1, 1
    v_and_b32 v4, 1, v0
    v_bfe_u32 v5, v2, 3, 1
    v_lshlrev_b32 v6, 12, v5
    s_lshl_b32 s30, s20, 11
    s_add_u32 s30, s30, 20969472
    v_add_u32 v6, s30, v6
    v_lshl_add_u32 v6, v2, 6, v6
    v_lshl_add_u32 v6, v3, 5, v6
    v_lshl_add_u32 v196, v4, 4, v6
    v_lshrrev_b32 v6, 2, v2
    v_lshlrev_b32 v6, 14, v6
    v_and_b32 v7, 3, v2
    v_lshl_add_u32 v6, v7, 12, v6
    v_lshl_add_u32 v6, v5, 10, v6
    v_lshl_add_u32 v6, v3, 9, v6
    v_mul_u32_u24 v7, 31, v5
    v_lshl_add_u32 v198, v7, 4, v6
    v_xor_b32 v200, v4, v5
    s_cmp_eq_u32 s20, 0
    s_cselect_b32 s30, 1, 0
    s_cmp_eq_u32 s20, 31
    s_cselect_b32 s31, 1, 0
    v_mov_b32 v6, s30
    v_mov_b32 v7, s31
    v_cmp_eq_u32 vcc, 1, v5
    s_nop 1
    v_cndmask_b32 v6, v6, v7, vcc
    v_lshlrev_b32 v6, v6, v200
    v_mov_b32 v200, v6
    v_lshrrev_b32 v2, 2, v0
    v_add_u32 v2, 16, v2
    v_bfe_u32 v3, v0, 1, 1
    v_and_b32 v4, 1, v0
    v_bfe_u32 v5, v2, 3, 1
    v_lshlrev_b32 v6, 12, v5
    s_lshl_b32 s30, s20, 11
    s_add_u32 s30, s30, 20969472
    v_add_u32 v6, s30, v6
    v_lshl_add_u32 v6, v2, 6, v6
    v_lshl_add_u32 v6, v3, 5, v6
    v_lshl_add_u32 v197, v4, 4, v6
    v_lshrrev_b32 v6, 2, v2
    v_lshlrev_b32 v6, 14, v6
    v_and_b32 v7, 3, v2
    v_lshl_add_u32 v6, v7, 12, v6
    v_lshl_add_u32 v6, v5, 10, v6
    v_lshl_add_u32 v6, v3, 9, v6
    v_mul_u32_u24 v7, 30, v5
    v_add_u32 v7, v7, v4
    v_lshl_add_u32 v199, v7, 4, v6
    v_mov_b32 v201, 1
    s_cmp_eq_u32 s20, 0
    s_cselect_b32 s30, 1, 0
    s_cmp_eq_u32 s20, 31
    s_cselect_b32 s31, 1, 0
    v_mov_b32 v6, s30
    v_mov_b32 v7, s31
    v_cmp_eq_u32 vcc, 1, v5
    s_nop 1
    v_cndmask_b32 v6, v6, v7, vcc
    v_lshlrev_b32 v6, v6, v201
    v_mov_b32 v201, v6
    buffer_load_dwordx4 v[188:191], v196, s[12:15], 0 offen sc1
    buffer_load_dwordx4 v[192:195], v197, s[12:15], 0 offen sc1
L_chain0_kernel_w124:
    s_cmp_lg_u32 s22, 0
    s_cbranch_scc1 L_chain0_kernel_ya25
    s_mov_b64 s[40:41], exec
    s_cmp_eq_u32 s29, 1
    s_cbranch_scc0 L_chain0_kernel_yb26
    s_mov_b32 s30, 1
    s_atomic_add s30, s[48:49], 0x4000
    s_branch L_chain0_kernel_yc27
L_chain0_kernel_yb26:
    s_add_u32 s30, s50, 16384
    s_mov_b64 exec, 1
    v_mov_b32 v2, s30
    v_mov_b32 v3, 1
    buffer_atomic_add v3, v2, s[12:15], 0 offen sc1
L_chain0_kernel_yc27:
    s_mov_b64 exec, s[40:41]
L_chain0_kernel_ya25:
    s_cmp_lg_u32 s22, 0
    s_cbranch_scc1 L_chain0_kernel_yk28
    s_mov_b64 s[40:41], exec
    s_cmp_eq_u32 s29, 1
    s_cbranch_scc0 L_chain0_kernel_ys29
    s_mov_b32 s47, 0
L_chain0_kernel_yl31:
    s_mov_b32 s31, 0
    s_atomic_add s31, s[48:49], 0x4000 glc
    s_add_u32 s47, s47, 1
    s_cmp_gt_u32 s47, 262144
    s_cbranch_scc1 L_chain0_kernel_ye32
    s_waitcnt lgkmcnt(0)
    s_cmp_ge_u32 s31, 8
    s_cbranch_scc0 L_chain0_kernel_yl31
L_chain0_kernel_ye32:
    s_waitcnt lgkmcnt(0)
    s_branch L_chain0_kernel_yd30
L_chain0_kernel_ys29:
    s_add_u32 s30, s50, 16384
    s_mov_b64 exec, 1
    v_mov_b32 v2, s30
    v_mov_b32 v3, 8
    s_mov_b32 s47, 0
L_chain0_kernel_pl33:
    buffer_load_dword v4, v2, s[12:15], 0 offen sc1
    s_add_u32 s47, s47, 1
    s_cmp_gt_u32 s47, 262144
    s_cbranch_scc1 L_chain0_kernel_pd34
    s_waitcnt vmcnt(0)
    v_cmp_ge_u32 vcc, v4, v3
    s_nop 1
    s_cmp_eq_u32 vcc_lo, 1
    s_cbranch_scc0 L_chain0_kernel_pl33
L_chain0_kernel_pd34:
    s_waitcnt vmcnt(0)
L_chain0_kernel_yd30:
    s_mov_b64 exec, s[40:41]
L_chain0_kernel_yk28:
    s_barrier
    v_mov_b32 v18, v17
    v_mul_f32_e64 v19, -v16, v17
    v_pk_fma_f32 v[44:45], v[28:29], v[18:19], v[18:19] op_sel:[0,0,1] op_sel_hi:[1,0,1]
    v_pk_fma_f32 v[46:47], v[30:31], v[18:19], v[18:19] op_sel:[0,0,1] op_sel_hi:[1,0,1]
    v_pk_fma_f32 v[48:49], v[32:33], v[18:19], v[18:19] op_sel:[0,0,1] op_sel_hi:[1,0,1]
    v_pk_fma_f32 v[50:51], v[34:35], v[18:19], v[18:19] op_sel:[0,0,1] op_sel_hi:[1,0,1]
    v_pk_fma_f32 v[52:53], v[36:37], v[18:19], v[18:19] op_sel:[0,0,1] op_sel_hi:[1,0,1]
    v_pk_fma_f32 v[54:55], v[38:39], v[18:19], v[18:19] op_sel:[0,0,1] op_sel_hi:[1,0,1]
    v_pk_fma_f32 v[56:57], v[40:41], v[18:19], v[18:19] op_sel:[0,0,1] op_sel_hi:[1,0,1]
    v_pk_fma_f32 v[58:59], v[42:43], v[18:19], v[18:19] op_sel:[0,0,1] op_sel_hi:[1,0,1]
    s_cmp_lg_u32 s22, 1
    s_cbranch_scc1 L_chain0_kernel_w135
    s_mov_b32 s47, 0
    s_branch L_chain0_kernel_hp36c
L_chain0_kernel_hp36:
    buffer_load_dwordx4 v[188:191], v196, s[12:15], 0 offen sc1
    buffer_load_dwordx4 v[192:195], v197, s[12:15], 0 offen sc1
    s_add_u32 s47, s47, 1
    s_cmp_gt_u32 s47, 262144
    s_cbranch_scc1 L_chain0_kernel_hq37
L_chain0_kernel_hp36c:
    s_waitcnt vmcnt(0)
    v_max3_u32 v2, v188, v189, v190
    v_max_u32 v2, v2, v191
    v_cmp_eq_u32 vcc, -1, v2
    v_cmp_eq_u32 s[32:33], 1, v200
    s_nop 1
    s_and_b64 s[34:35], vcc, s[32:33]
    v_max3_u32 v2, v192, v193, v194
    v_max_u32 v2, v2, v195
    v_cmp_eq_u32 vcc, -1, v2
    v_cmp_eq_u32 s[32:33], 1, v201
    s_nop 1
    s_and_b64 s[36:37], vcc, s[32:33]
    s_or_b64 s[34:35], s[34:35], s[36:37]
    s_cmp_eq_u64 s[34:35], 0
    s_cbranch_scc0 L_chain0_kernel_hp36
L_chain0_kernel_hq37:
    s_waitcnt vmcnt(0)
    v_cmp_eq_u32 vcc, 2, v200
    s_nop 1
    v_cndmask_b32_e64 v188, v188, 0, vcc
    v_cndmask_b32_e64 v189, v189, 0, vcc
    v_cndmask_b32_e64 v190, v190, 0, vcc
    v_cndmask_b32_e64 v191, v191, 0, vcc
    v_cmp_lt_u32 vcc, 0, v200
    s_and_saveexec_b64 s[40:41], vcc
    ds_write_b128 v198, v[188:191]
    s_mov_b64 exec, s[40:41]
    v_cmp_eq_u32 vcc, 2, v201
    s_nop 1
    v_cndmask_b32_e64 v192, v192, 0, vcc
    v_cndmask_b32_e64 v193, v193, 0, vcc
    v_cndmask_b32_e64 v194, v194, 0, vcc
    v_cndmask_b32_e64 v195, v195, 0, vcc
    v_cmp_lt_u32 vcc, 0, v201
    s_and_saveexec_b64 s[40:41], vcc
    ds_write_b128 v199, v[192:195]
    s_mov_b64 exec, s[40:41]
    s_waitcnt lgkmcnt(0)
L_chain0_kernel_w135:
    s_mul_i32 s30, s24, 1024
    s_add_u32 s30, s30, 2048
    v_lshlrev_b32 v11, 4, v0
    v_add_u32 v8, s30, v11
    s_lshl_b32 s30, s23, 10
    v_add_u32 v11, s30, v11
    v_add_u32 v9, 65536, v8
    v_add_u32 v12, 65536, v11
    s_barrier
    ds_read_b128 v[124:127], v11 offset:0
    ds_read_b128 v[128:131], v8 offset:0
    ds_read_b128 v[132:135], v11 offset:4096
    ds_read_b128 v[136:139], v8 offset:4096
    ds_read_b128 v[140:143], v11 offset:8192
    ds_read_b128 v[144:147], v8 offset:8192
    ds_read_b128 v[148:151], v11 offset:12288
    ds_read_b128 v[152:155], v8 offset:12288
    s_barrier
    ds_read_b128 v[156:159], v11 offset:16384
    ds_read_b128 v[160:163], v8 offset:16384
    s_waitcnt lgkmcnt(8)
    v_mfma_f32_32x32x16_bf16 v[60:75], v[128:131], v[124:127], 0
    ds_read_b128 v[124:127], v11 offset:20480
    ds_read_b128 v[128:131], v8 offset:20480
    s_waitcnt lgkmcnt(8)
    v_mfma_f32_32x32x16_bf16 v[60:75], v[136:139], v[132:135], v[60:75]
    ds_read_b128 v[132:135], v11 offset:24576
    ds_read_b128 v[136:139], v8 offset:24576
    s_waitcnt lgkmcnt(8)
    v_mfma_f32_32x32x16_bf16 v[60:75], v[144:147], v[140:143], v[60:75]
    ds_read_b128 v[140:143], v11 offset:28672
    ds_read_b128 v[144:147], v8 offset:28672
    s_waitcnt lgkmcnt(8)
    v_mfma_f32_32x32x16_bf16 v[60:75], v[152:155], v[148:151], v[60:75]
    s_barrier
    ds_read_b128 v[148:151], v11 offset:32768
    ds_read_b128 v[152:155], v8 offset:32768
    s_waitcnt lgkmcnt(8)
    v_mfma_f32_32x32x16_bf16 v[60:75], v[160:163], v[156:159], v[60:75]
    ds_read_b128 v[156:159], v11 offset:36864
    ds_read_b128 v[160:163], v8 offset:36864
    s_waitcnt lgkmcnt(8)
    v_mfma_f32_32x32x16_bf16 v[60:75], v[128:131], v[124:127], v[60:75]
    ds_read_b128 v[124:127], v11 offset:40960
    ds_read_b128 v[128:131], v8 offset:40960
    s_waitcnt lgkmcnt(8)
    v_mfma_f32_32x32x16_bf16 v[60:75], v[136:139], v[132:135], v[60:75]
    ds_read_b128 v[132:135], v11 offset:45056
    ds_read_b128 v[136:139], v8 offset:45056
    s_waitcnt lgkmcnt(8)
    v_mfma_f32_32x32x16_bf16 v[60:75], v[144:147], v[140:143], v[60:75]
    s_barrier
    ds_read_b128 v[140:143], v11 offset:49152
    ds_read_b128 v[144:147], v8 offset:49152
    s_waitcnt lgkmcnt(8)
    v_mfma_f32_32x32x16_bf16 v[60:75], v[152:155], v[148:151], v[60:75]
    ds_read_b128 v[148:151], v11 offset:53248
    ds_read_b128 v[152:155], v8 offset:53248
    s_waitcnt lgkmcnt(8)
    v_mfma_f32_32x32x16_bf16 v[60:75], v[160:163], v[156:159], v[60:75]
    ds_read_b128 v[156:159], v11 offset:57344
    ds_read_b128 v[160:163], v8 offset:57344
    s_waitcnt lgkmcnt(8)
    v_mfma_f32_32x32x16_bf16 v[60:75], v[128:131], v[124:127], v[60:75]
    ds_read_b128 v[124:127], v11 offset:61440
    ds_read_b128 v[128:131], v8 offset:61440
    s_waitcnt lgkmcnt(8)
    v_mfma_f32_32x32x16_bf16 v[60:75], v[136:139], v[132:135], v[60:75]
    s_barrier
    ds_read_b128 v[132:135], v12 offset:0
    ds_read_b128 v[136:139], v9 offset:0
    s_waitcnt lgkmcnt(8)
    v_mfma_f32_32x32x16_bf16 v[60:75], v[144:147], v[140:143], v[60:75]
    ds_read_b128 v[140:143], v12 offset:4096
    ds_read_b128 v[144:147], v9 offset:4096
    s_waitcnt lgkmcnt(8)
    v_mfma_f32_32x32x16_bf16 v[60:75], v[152:155], v[148:151], v[60:75]
    ds_read_b128 v[148:151], v12 offset:8192
    ds_read_b128 v[152:155], v9 offset:8192
    s_waitcnt lgkmcnt(8)
    v_mfma_f32_32x32x16_bf16 v[60:75], v[160:163], v[156:159], v[60:75]
    ds_read_b128 v[156:159], v12 offset:12288
    ds_read_b128 v[160:163], v9 offset:12288
    s_waitcnt lgkmcnt(8)
    v_mfma_f32_32x32x16_bf16 v[60:75], v[128:131], v[124:127], v[60:75]
    s_barrier
    ds_read_b128 v[124:127], v12 offset:16384
    ds_read_b128 v[128:131], v9 offset:16384
    s_waitcnt lgkmcnt(8)
    v_mfma_f32_32x32x16_bf16 v[60:75], v[136:139], v[132:135], v[60:75]
    ds_read_b128 v[132:135], v12 offset:20480
    ds_read_b128 v[136:139], v9 offset:20480
    s_waitcnt lgkmcnt(8)
    v_mfma_f32_32x32x16_bf16 v[60:75], v[144:147], v[140:143], v[60:75]
    ds_read_b128 v[140:143], v12 offset:24576
    ds_read_b128 v[144:147], v9 offset:24576
    s_waitcnt lgkmcnt(8)
    v_mfma_f32_32x32x16_bf16 v[60:75], v[152:155], v[148:151], v[60:75]
    ds_read_b128 v[148:151], v12 offset:28672
    ds_read_b128 v[152:155], v9 offset:28672
    s_waitcnt lgkmcnt(8)
    v_mfma_f32_32x32x16_bf16 v[60:75], v[160:163], v[156:159], v[60:75]
    s_barrier
    ds_read_b128 v[156:159], v12 offset:32768
    ds_read_b128 v[160:163], v9 offset:32768
    s_waitcnt lgkmcnt(8)
    v_mfma_f32_32x32x16_bf16 v[60:75], v[128:131], v[124:127], v[60:75]
    ds_read_b128 v[124:127], v12 offset:36864
    ds_read_b128 v[128:131], v9 offset:36864
    s_waitcnt lgkmcnt(8)
    v_mfma_f32_32x32x16_bf16 v[60:75], v[136:139], v[132:135], v[60:75]
    ds_read_b128 v[132:135], v12 offset:40960
    ds_read_b128 v[136:139], v9 offset:40960
    s_waitcnt lgkmcnt(8)
    v_mfma_f32_32x32x16_bf16 v[60:75], v[144:147], v[140:143], v[60:75]
    ds_read_b128 v[140:143], v12 offset:45056
    ds_read_b128 v[144:147], v9 offset:45056
    s_waitcnt lgkmcnt(8)
    v_mfma_f32_32x32x16_bf16 v[60:75], v[152:155], v[148:151], v[60:75]
    s_barrier
    ds_read_b128 v[148:151], v12 offset:49152
    ds_read_b128 v[152:155], v9 offset:49152
    s_waitcnt lgkmcnt(8)
    v_mfma_f32_32x32x16_bf16 v[60:75], v[160:163], v[156:159], v[60:75]
    ds_read_b128 v[156:159], v12 offset:53248
    ds_read_b128 v[160:163], v9 offset:53248
    s_waitcnt lgkmcnt(8)
    v_mfma_f32_32x32x16_bf16 v[60:75], v[128:131], v[124:127], v[60:75]
    ds_read_b128 v[124:127], v12 offset:57344
    ds_read_b128 v[128:131], v9 offset:57344
    s_waitcnt lgkmcnt(8)
    v_mfma_f32_32x32x16_bf16 v[60:75], v[136:139], v[132:135], v[60:75]
    ds_read_b128 v[132:135], v12 offset:61440
    ds_read_b128 v[136:139], v9 offset:61440
    s_waitcnt lgkmcnt(8)
    v_mfma_f32_32x32x16_bf16 v[60:75], v[144:147], v[140:143], v[60:75]
    s_waitcnt lgkmcnt(6)
    v_mfma_f32_32x32x16_bf16 v[60:75], v[152:155], v[148:151], v[60:75]
    s_waitcnt lgkmcnt(4)
    v_mfma_f32_32x32x16_bf16 v[60:75], v[160:163], v[156:159], v[60:75]
    s_waitcnt lgkmcnt(2)
    v_mfma_f32_32x32x16_bf16 v[60:75], v[128:131], v[124:127], v[60:75]
    s_waitcnt lgkmcnt(0)
    v_mfma_f32_32x32x16_bf16 v[60:75], v[136:139], v[132:135], v[60:75]
    s_barrier
    s_mul_i32 s32, s28, 32768
    s_lshl_b32 s33, s45, 10
    s_add_u32 s32, s32, s33
    s_add_u32 s32, s32, 22020096
    s_nop 7
    v_pk_add_f32 v[44:45], v[44:45], v[60:61]
    v_pk_add_f32 v[46:47], v[46:47], v[62:63]
    v_pk_add_f32 v[48:49], v[48:49], v[64:65]
    v_pk_add_f32 v[50:51], v[50:51], v[66:67]
    v_pk_add_f32 v[52:53], v[52:53], v[68:69]
    v_pk_add_f32 v[54:55], v[54:55], v[70:71]
    v_pk_add_f32 v[56:57], v[56:57], v[72:73]
    v_pk_add_f32 v[58:59], v[58:59], v[74:75]
    v_cvt_pk_bf16_f32 v236, v44, v45
    v_cvt_pk_bf16_f32 v237, v46, v47
    v_cvt_pk_bf16_f32 v238, v48, v49
    v_cvt_pk_bf16_f32 v239, v50, v51
    v_cvt_pk_bf16_f32 v240, v52, v53
    v_cvt_pk_bf16_f32 v241, v54, v55
    v_cvt_pk_bf16_f32 v242, v56, v57
    v_cvt_pk_bf16_f32 v243, v58, v59
    s_cmp_eq_u32 s29, 1
    s_cbranch_scc1 L_chain0_kernel_sf38
    buffer_store_dwordx4 v[236:239], v14, s[12:15], s32 offen offset:0 sc1
    buffer_store_dwordx4 v[240:243], v14, s[12:15], s32 offen offset:1024 sc1
    s_branch L_chain0_kernel_sd39
L_chain0_kernel_sf38:
    buffer_store_dwordx4 v[236:239], v14, s[12:15], s32 offen offset:0
    buffer_store_dwordx4 v[240:243], v14, s[12:15], s32 offen offset:1024
L_chain0_kernel_sd39:
    v_pk_add_f32 v[2:3], v[44:45], v[46:47]
    v_pk_mul_f32 v[4:5], v[44:45], v[44:45]
    v_pk_fma_f32 v[4:5], v[46:47], v[46:47], v[4:5]
    v_pk_add_f32 v[2:3], v[2:3], v[48:49]
    v_pk_fma_f32 v[4:5], v[48:49], v[48:49], v[4:5]
    v_pk_add_f32 v[2:3], v[2:3], v[50:51]
    v_pk_fma_f32 v[4:5], v[50:51], v[50:51], v[4:5]
    v_pk_add_f32 v[2:3], v[2:3], v[52:53]
    v_pk_fma_f32 v[4:5], v[52:53], v[52:53], v[4:5]
    v_pk_add_f32 v[2:3], v[2:3], v[54:55]
    v_pk_fma_f32 v[4:5], v[54:55], v[54:55], v[4:5]
    v_pk_add_f32 v[2:3], v[2:3], v[56:57]
    v_pk_fma_f32 v[4:5], v[56:57], v[56:57], v[4:5]
    v_pk_add_f32 v[2:3], v[2:3], v[58:59]
    v_pk_fma_f32 v[4:5], v[58:59], v[58:59], v[4:5]
    v_add_f32 v2, v2, v3
    v_add_f32 v3, v4, v5
    s_nop 1
    v_permlane32_swap_b32 v2, v3
    s_nop 1
    v_add_f32 v2, v2, v3
    s_lshl_b32 s34, s28, 12
    s_lshl_b32 s35, s44, 8
    s_add_u32 s34, s34, s35
    s_add_u32 s34, s34, 20447232
    v_lshlrev_b32 v4, 2, v0
    s_cmp_eq_u32 s29, 1
    s_cbranch_scc1 L_chain0_kernel_sf40
    buffer_store_dword v2, v4, s[12:15], s34 offen sc1
    s_branch L_chain0_kernel_sd41
L_chain0_kernel_sf40:
    buffer_store_dword v2, v4, s[12:15], s34 offen
L_chain0_kernel_sd41:
    s_waitcnt vmcnt(0)
    s_barrier
L_chain0_kernel_com:
    v_lshlrev_b32 v14, 4, v0
    s_min_u32 s52, s22, 6
    s_mul_i32 s53, s21, 7
    s_add_u32 s53, s53, s52
    s_lshl_b32 s53, s53, 15
    s_add_u32 s53, s53, 28311552
    s_cmp_lg_u32 s22, 0
    s_cbranch_scc1 L_chain0_kernel_ya42
    s_mov_b64 s[40:41], exec
    s_cmp_eq_u32 s29, 1
    s_cbranch_scc0 L_chain0_kernel_yb43
    s_mov_b32 s30, 1
    s_atomic_add s30, s[48:49], 0xa000
    s_branch L_chain0_kernel_yc44
L_chain0_kernel_yb43:
    s_add_u32 s30, s50, 40960
    s_mov_b64 exec, 1
    v_mov_b32 v2, s30
    v_mov_b32 v3, 1
    buffer_atomic_add v3, v2, s[12:15], 0 offen sc1
L_chain0_kernel_yc44:
    s_mov_b64 exec, s[40:41]
L_chain0_kernel_ya42:
    s_cmp_eq_u32 s22, 7
    s_cbranch_scc1 L_chain0_kernel_s748
    s_add_u32 s26, s53, 0
    buffer_load_dwordx4 v[92:95], v14, s[12:15], s26 offen
    s_add_u32 s26, s53, 4096
    buffer_load_dwordx4 v[96:99], v14, s[12:15], s26 offen
    s_add_u32 s26, s53, 8192
    buffer_load_dwordx4 v[100:103], v14, s[12:15], s26 offen
    s_add_u32 s26, s53, 12288
    buffer_load_dwordx4 v[104:107], v14, s[12:15], s26 offen
    s_add_u32 s26, s53, 16384
    buffer_load_dwordx4 v[108:111], v14, s[12:15], s26 offen
    s_add_u32 s26, s53, 20480
    buffer_load_dwordx4 v[112:115], v14, s[12:15], s26 offen
    s_add_u32 s26, s53, 24576
    buffer_load_dwordx4 v[116:119], v14, s[12:15], s26 offen
    s_add_u32 s26, s53, 28672
    buffer_load_dwordx4 v[120:123], v14, s[12:15], s26 offen
    s_add_u32 s26, s53, 1024
    buffer_load_dwordx4 v[124:127], v14, s[12:15], s26 offen
    s_add_u32 s26, s53, 5120
    buffer_load_dwordx4 v[128:131], v14, s[12:15], s26 offen
L_chain0_kernel_s748:
    s_cmp_lg_u32 s22, 0
    s_cbranch_scc1 L_chain0_kernel_yk45
    s_mov_b64 s[40:41], exec
    s_cmp_eq_u32 s29, 1
    s_cbranch_scc0 L_chain0_kernel_ys46
    s_mov_b32 s47, 0
L_chain0_kernel_yl49:
    s_mov_b32 s31, 0
    s_atomic_add s31, s[48:49], 0xa000 glc
    s_add_u32 s47, s47, 1
    s_cmp_gt_u32 s47, 262144
    s_cbranch_scc1 L_chain0_kernel_ye50
    s_waitcnt lgkmcnt(0)
    s_cmp_ge_u32 s31, 8
    s_cbranch_scc0 L_chain0_kernel_yl49
L_chain0_kernel_ye50:
    s_waitcnt lgkmcnt(0)
    s_branch L_chain0_kernel_yd47
L_chain0_kernel_ys46:
    s_add_u32 s30, s50, 40960
    s_mov_b64 exec, 1
    v_mov_b32 v2, s30
    v_mov_b32 v3, 8
    s_mov_b32 s47, 0
L_chain0_kernel_pl51:
    buffer_load_dword v4, v2, s[12:15], 0 offen sc1
    s_add_u32 s47, s47, 1
    s_cmp_gt_u32 s47, 262144
    s_cbranch_scc1 L_chain0_kernel_pd52
    s_waitcnt vmcnt(0)
    v_cmp_ge_u32 vcc, v4, v3
    s_nop 1
    s_cmp_eq_u32 vcc_lo, 1
    s_cbranch_scc0 L_chain0_kernel_pl51
L_chain0_kernel_pd52:
    s_waitcnt vmcnt(0)
L_chain0_kernel_yd47:
    s_mov_b64 exec, s[40:41]
L_chain0_kernel_yk45:
    s_barrier
    s_cmp_eq_u32 s22, 7
    s_cbranch_scc1 L_chain0_kernel_w7a
    s_lshl_b32 s30, s20, 13
    s_lshl_b32 s31, s22, 10
    s_add_u32 s30, s30, s31
    s_add_u32 s30, s30, 20447232
    s_add_u32 m0, s31, 149504
    s_nop 0
    buffer_load_dwordx4 v14, s[12:15], s30 offen sc1 lds
    s_lshl_b32 s30, s20, 16
    s_lshl_b32 s31, s22, 12
    s_add_u32 s30, s30, s31
    s_add_u32 s30, s30, 22020096
    s_add_u32 m0, s31, 0
    s_add_u32 s26, s30, 0
    buffer_load_dwordx4 v14, s[12:15], s26 offen sc1 lds
    s_add_u32 m0, s31, 32768
    s_add_u32 s26, s30, 32768
    buffer_load_dwordx4 v14, s[12:15], s26 offen sc1 lds
    s_add_u32 m0, s31, 1024
    s_add_u32 s26, s30, 1024
    buffer_load_dwordx4 v14, s[12:15], s26 offen sc1 lds
    s_add_u32 m0, s31, 33792
    s_add_u32 s26, s30, 33792
    buffer_load_dwordx4 v14, s[12:15], s26 offen sc1 lds
    s_add_u32 m0, s31, 2048
    s_add_u32 s26, s30, 2048
    buffer_load_dwordx4 v14, s[12:15], s26 offen sc1 lds
    s_add_u32 m0, s31, 34816
    s_add_u32 s26, s30, 34816
    buffer_load_dwordx4 v14, s[12:15], s26 offen sc1 lds
    s_add_u32 m0, s31, 3072
    s_add_u32 s26, s30, 3072
    buffer_load_dwordx4 v14, s[12:15], s26 offen sc1 lds
    s_add_u32 m0, s31, 35840
    s_add_u32 s26, s30, 35840
    buffer_load_dwordx4 v14, s[12:15], s26 offen sc1 lds
    s_waitcnt vmcnt(6)
    s_barrier
    ds_read_b128 v[220:223], v14 offset:0
    ds_read_b128 v[224:227], v14 offset:32768
    ds_read_b128 v[228:231], v14 offset:4096
    ds_read_b128 v[232:235], v14 offset:36864
    ds_read_b128 v[236:239], v14 offset:8192
    ds_read_b128 v[240:243], v14 offset:40960
    v_lshlrev_b32 v2, 2, v0
    v_add_u32 v2, 149504, v2
    s_waitcnt lgkmcnt(0)
    ds_read2st64_b32 v[60:61], v2 offset0:0 offset1:1
    ds_read2st64_b32 v[62:63], v2 offset0:2 offset1:3
    ds_read2st64_b32 v[64:65], v2 offset0:4 offset1:5
    ds_read2st64_b32 v[66:67], v2 offset0:6 offset1:7
    ds_read2st64_b32 v[68:69], v2 offset0:8 offset1:9
    ds_read2st64_b32 v[70:71], v2 offset0:10 offset1:11
    ds_read2st64_b32 v[72:73], v2 offset0:12 offset1:13
    ds_read2st64_b32 v[74:75], v2 offset0:14 offset1:15
    s_waitcnt lgkmcnt(0)
    v_add_f32 v60, v60, v68
    v_add_f32 v61, v61, v69
    v_add_f32 v62, v62, v70
    v_add_f32 v63, v63, v71
    v_add_f32 v64, v64, v72
    v_add_f32 v65, v65, v73
    v_add_f32 v66, v66, v74
    v_add_f32 v67, v67, v75
    v_add_f32 v60, v60, v64
    v_add_f32 v61, v61, v65
    v_add_f32 v62, v62, v66
    v_add_f32 v63, v63, v67
    v_add_f32 v60, v60, v62
    v_add_f32 v61, v61, v63
    v_add_f32 v60, v60, v61
    v_mov_b32 v61, v60
    s_nop 1
    v_permlane32_swap_b32 v60, v61
    s_nop 1
    v_mul_f32 v24, 0x3b000000, v60
    v_mul_f32 v25, 0x3b000000, v61
    v_fma_f32 v25, -v24, v24, v25
    v_max_f32 v25, 0, v25
    v_add_f32 v18, 0x3727c5ac, v25
    v_rsq_f32 v18, v18
    s_nop 0
    v_mul_f32_e64 v19, -v24, v18
    v_lshlrev_b32 v2, 2, v0
    v_add_u32 v2, 153600, v2
    s_waitcnt lgkmcnt(0)
    ds_read2st64_b32 v[60:61], v2 offset0:0 offset1:1
    ds_read2st64_b32 v[62:63], v2 offset0:2 offset1:3
    ds_read2st64_b32 v[64:65], v2 offset0:4 offset1:5
    ds_read2st64_b32 v[66:67], v2 offset0:6 offset1:7
    ds_read2st64_b32 v[68:69], v2 offset0:8 offset1:9
    ds_read2st64_b32 v[70:71], v2 offset0:10 offset1:11
    ds_read2st64_b32 v[72:73], v2 offset0:12 offset1:13
    ds_read2st64_b32 v[74:75], v2 offset0:14 offset1:15
    s_waitcnt lgkmcnt(0)
    v_add_f32 v60, v60, v68
    v_add_f32 v61, v61, v69
    v_add_f32 v62, v62, v70
    v_add_f32 v63, v63, v71
    v_add_f32 v64, v64, v72
    v_add_f32 v65, v65, v73
    v_add_f32 v66, v66, v74
    v_add_f32 v67, v67, v75
    v_add_f32 v60, v60, v64
    v_add_f32 v61, v61, v65
    v_add_f32 v62, v62, v66
    v_add_f32 v63, v63, v67
    v_add_f32 v60, v60, v62
    v_add_f32 v61, v61, v63
    v_add_f32 v60, v60, v61
    v_mov_b32 v61, v60
    s_nop 1
    v_permlane32_swap_b32 v60, v61
    s_nop 1
    v_mul_f32 v24, 0x3b000000, v60
    v_mul_f32 v25, 0x3b000000, v61
    v_fma_f32 v25, -v24, v24, v25
    v_max_f32 v25, 0, v25
    v_add_f32 v20, 0x3727c5ac, v25
    v_rsq_f32 v20, v20
    s_nop 0
    v_mul_f32_e64 v21, -v24, v20
    v_mov_b32 v22, 0xc0135761
    v_mov_b32 v23, 0xbdd2d3e8
    s_add_u32 s26, s53, 9216
    buffer_load_dwordx4 v[132:135], v14, s[12:15], s26 offen
    ds_read_b128 v[244:247], v14 offset:12288
    ds_read_b128 v[248:251], v14 offset:45056
    v_mfma_f32_32x32x16_bf16 v[60:75], v[92:95], v[220:223], 0
    v_mfma_f32_32x32x16_bf16 v[76:91], v[92:95], v[224:227], 0
    s_add_u32 s26, s53, 13312
    buffer_load_dwordx4 v[136:139], v14, s[12:15], s26 offen
    ds_read_b128 v[220:223], v14 offset:16384
    ds_read_b128 v[224:227], v14 offset:49152
    v_mfma_f32_32x32x16_bf16 v[60:75], v[96:99], v[228:231], v[60:75]
    v_mfma_f32_32x32x16_bf16 v[76:91], v[96:99], v[232:235], v[76:91]
    s_add_u32 s26, s53, 17408
    buffer_load_dwordx4 v[140:143], v14, s[12:15], s26 offen
    ds_read_b128 v[228:231], v14 offset:20480
    ds_read_b128 v[232:235], v14 offset:53248
    v_mfma_f32_32x32x16_bf16 v[60:75], v[100:103], v[236:239], v[60:75]
    v_mfma_f32_32x32x16_bf16 v[76:91], v[100:103], v[240:243], v[76:91]
    s_add_u32 s26, s53, 21504
    buffer_load_dwordx4 v[144:147], v14, s[12:15], s26 offen
    ds_read_b128 v[236:239], v14 offset:24576
    ds_read_b128 v[240:243], v14 offset:57344
    s_waitcnt lgkmcnt(6)
    v_mfma_f32_32x32x16_bf16 v[60:75], v[104:107], v[244:247], v[60:75]
    v_mfma_f32_32x32x16_bf16 v[76:91], v[104:107], v[248:251], v[76:91]
    s_add_u32 s26, s53, 25600
    buffer_load_dwordx4 v[148:151], v14, s[12:15], s26 offen
    ds_read_b128 v[244:247], v14 offset:28672
    ds_read_b128 v[248:251], v14 offset:61440
    s_waitcnt lgkmcnt(6)
    v_mfma_f32_32x32x16_bf16 v[60:75], v[108:111], v[220:223], v[60:75]
    v_mfma_f32_32x32x16_bf16 v[76:91], v[108:111], v[224:227], v[76:91]
    s_add_u32 s26, s53, 29696
    buffer_load_dwordx4 v[152:155], v14, s[12:15], s26 offen
    s_waitcnt vmcnt(10)
    s_barrier
    ds_read_b128 v[220:223], v14 offset:1024
    ds_read_b128 v[224:227], v14 offset:33792
    s_waitcnt lgkmcnt(6)
    v_mfma_f32_32x32x16_bf16 v[60:75], v[112:115], v[228:231], v[60:75]
    v_mfma_f32_32x32x16_bf16 v[76:91], v[112:115], v[232:235], v[76:91]
    s_add_u32 s26, s53, 2048
    buffer_load_dwordx4 v[156:159], v14, s[12:15], s26 offen
    ds_read_b128 v[228:231], v14 offset:5120
    ds_read_b128 v[232:235], v14 offset:37888
    s_waitcnt lgkmcnt(6)
    v_mfma_f32_32x32x16_bf16 v[60:75], v[116:119], v[236:239], v[60:75]
    v_mfma_f32_32x32x16_bf16 v[76:91], v[116:119], v[240:243], v[76:91]
    s_add_u32 s26, s53, 6144
    buffer_load_dwordx4 v[160:163], v14, s[12:15], s26 offen
    ds_read_b128 v[236:239], v14 offset:9216
    ds_read_b128 v[240:243], v14 offset:41984
    s_waitcnt lgkmcnt(6)
    v_mfma_f32_32x32x16_bf16 v[60:75], v[120:123], v[244:247], v[60:75]
    v_mfma_f32_32x32x16_bf16 v[76:91], v[120:123], v[248:251], v[76:91]
    s_add_u32 s26, s53, 10240
    buffer_load_dwordx4 v[164:167], v14, s[12:15], s26 offen
    ds_read_b128 v[244:247], v14 offset:13312
    ds_read_b128 v[248:251], v14 offset:46080
    s_waitcnt lgkmcnt(6)
    v_mfma_f32_32x32x16_bf16 v[60:75], v[124:127], v[220:223], v[60:75]
    v_mfma_f32_32x32x16_bf16 v[76:91], v[124:127], v[224:227], v[76:91]
    s_add_u32 s26, s53, 14336
    buffer_load_dwordx4 v[168:171], v14, s[12:15], s26 offen
    ds_read_b128 v[220:223], v14 offset:17408
    ds_read_b128 v[224:227], v14 offset:50176
    s_waitcnt lgkmcnt(6)
    v_mfma_f32_32x32x16_bf16 v[60:75], v[128:131], v[228:231], v[60:75]
    v_mfma_f32_32x32x16_bf16 v[76:91], v[128:131], v[232:235], v[76:91]
    s_add_u32 s26, s53, 18432
    buffer_load_dwordx4 v[172:175], v14, s[12:15], s26 offen
    ds_read_b128 v[228:231], v14 offset:21504
    ds_read_b128 v[232:235], v14 offset:54272
    s_waitcnt lgkmcnt(6)
    s_waitcnt vmcnt(10)
    v_mfma_f32_32x32x16_bf16 v[60:75], v[132:135], v[236:239], v[60:75]
    v_mfma_f32_32x32x16_bf16 v[76:91], v[132:135], v[240:243], v[76:91]
    s_add_u32 s26, s53, 22528
    buffer_load_dwordx4 v[176:179], v14, s[12:15], s26 offen
    ds_read_b128 v[236:239], v14 offset:25600
    ds_read_b128 v[240:243], v14 offset:58368
    s_waitcnt lgkmcnt(6)
    s_waitcnt vmcnt(10)
    v_mfma_f32_32x32x16_bf16 v[60:75], v[136:139], v[244:247], v[60:75]
    v_mfma_f32_32x32x16_bf16 v[76:91], v[136:139], v[248:251], v[76:91]
    s_add_u32 s26, s53, 26624
    buffer_load_dwordx4 v[180:183], v14, s[12:15], s26 offen
    ds_read_b128 v[244:247], v14 offset:29696
    ds_read_b128 v[248:251], v14 offset:62464
    s_waitcnt lgkmcnt(6)
    s_waitcnt vmcnt(10)
    v_mfma_f32_32x32x16_bf16 v[60:75], v[140:143], v[220:223], v[60:75]
    v_mfma_f32_32x32x16_bf16 v[76:91], v[140:143], v[224:227], v[76:91]
    s_add_u32 s26, s53, 30720
    buffer_load_dwordx4 v[184:187], v14, s[12:15], s26 offen
    s_barrier
    ds_read_b128 v[220:223], v14 offset:2048
    ds_read_b128 v[224:227], v14 offset:34816
    s_waitcnt lgkmcnt(6)
    s_waitcnt vmcnt(10)
    v_mfma_f32_32x32x16_bf16 v[60:75], v[144:147], v[228:231], v[60:75]
    v_mfma_f32_32x32x16_bf16 v[76:91], v[144:147], v[232:235], v[76:91]
    s_add_u32 s26, s53, 3072
    buffer_load_dwordx4 v[188:191], v14, s[12:15], s26 offen
    ds_read_b128 v[228:231], v14 offset:6144
    ds_read_b128 v[232:235], v14 offset:38912
    s_waitcnt lgkmcnt(6)
    s_waitcnt vmcnt(10)
    v_mfma_f32_32x32x16_bf16 v[60:75], v[148:151], v[236:239], v[60:75]
    v_mfma_f32_32x32x16_bf16 v[76:91], v[148:151], v[240:243], v[76:91]
    s_add_u32 s26, s53, 7168
    buffer_load_dwordx4 v[192:195], v14, s[12:15], s26 offen
    ds_read_b128 v[236:239], v14 offset:10240
    ds_read_b128 v[240:243], v14 offset:43008
    s_waitcnt lgkmcnt(6)
    s_waitcnt vmcnt(10)
    v_mfma_f32_32x32x16_bf16 v[60:75], v[152:155], v[244:247], v[60:75]
    v_mfma_f32_32x32x16_bf16 v[76:91], v[152:155], v[248:251], v[76:91]
    s_add_u32 s26, s53, 11264
    buffer_load_dwordx4 v[196:199], v14, s[12:15], s26 offen
    ds_read_b128 v[244:247], v14 offset:14336
    ds_read_b128 v[248:251], v14 offset:47104
    s_waitcnt lgkmcnt(6)
    s_waitcnt vmcnt(10)
    v_mfma_f32_32x32x16_bf16 v[60:75], v[156:159], v[220:223], v[60:75]
    v_mfma_f32_32x32x16_bf16 v[76:91], v[156:159], v[224:227], v[76:91]
    s_add_u32 s26, s53, 15360
    buffer_load_dwordx4 v[200:203], v14, s[12:15], s26 offen
    ds_read_b128 v[220:223], v14 offset:18432
    ds_read_b128 v[224:227], v14 offset:51200
    s_waitcnt lgkmcnt(6)
    s_waitcnt vmcnt(10)
    v_mfma_f32_32x32x16_bf16 v[60:75], v[160:163], v[228:231], v[60:75]
    v_mfma_f32_32x32x16_bf16 v[76:91], v[160:163], v[232:235], v[76:91]
    s_add_u32 s26, s53, 19456
    buffer_load_dwordx4 v[204:207], v14, s[12:15], s26 offen
    ds_read_b128 v[228:231], v14 offset:22528
    ds_read_b128 v[232:235], v14 offset:55296
    s_waitcnt lgkmcnt(6)
    s_waitcnt vmcnt(10)
    v_mfma_f32_32x32x16_bf16 v[60:75], v[164:167], v[236:239], v[60:75]
    v_mfma_f32_32x32x16_bf16 v[76:91], v[164:167], v[240:243], v[76:91]
    s_add_u32 s26, s53, 23552
    buffer_load_dwordx4 v[208:211], v14, s[12:15], s26 offen
    ds_read_b128 v[236:239], v14 offset:26624
    ds_read_b128 v[240:243], v14 offset:59392
    s_waitcnt lgkmcnt(6)
    s_waitcnt vmcnt(10)
    v_mfma_f32_32x32x16_bf16 v[60:75], v[168:171], v[244:247], v[60:75]
    v_mfma_f32_32x32x16_bf16 v[76:91], v[168:171], v[248:251], v[76:91]
    s_add_u32 s26, s53, 27648
    buffer_load_dwordx4 v[212:215], v14, s[12:15], s26 offen
    ds_read_b128 v[244:247], v14 offset:30720
    ds_read_b128 v[248:251], v14 offset:63488
    s_waitcnt lgkmcnt(6)
    s_waitcnt vmcnt(10)
    v_mfma_f32_32x32x16_bf16 v[60:75], v[172:175], v[220:223], v[60:75]
    v_mfma_f32_32x32x16_bf16 v[76:91], v[172:175], v[224:227], v[76:91]
    s_add_u32 s26, s53, 31744
    buffer_load_dwordx4 v[216:219], v14, s[12:15], s26 offen
    s_barrier
    ds_read_b128 v[220:223], v14 offset:3072
    ds_read_b128 v[224:227], v14 offset:35840
    s_waitcnt lgkmcnt(6)
    s_waitcnt vmcnt(10)
    v_mfma_f32_32x32x16_bf16 v[60:75], v[176:179], v[228:231], v[60:75]
    v_mfma_f32_32x32x16_bf16 v[76:91], v[176:179], v[232:235], v[76:91]
    ds_read_b128 v[228:231], v14 offset:7168
    ds_read_b128 v[232:235], v14 offset:39936
    s_waitcnt lgkmcnt(6)
    s_waitcnt vmcnt(9)
    v_mfma_f32_32x32x16_bf16 v[60:75], v[180:183], v[236:239], v[60:75]
    v_mfma_f32_32x32x16_bf16 v[76:91], v[180:183], v[240:243], v[76:91]
    ds_read_b128 v[236:239], v14 offset:11264
    ds_read_b128 v[240:243], v14 offset:44032
    s_waitcnt lgkmcnt(6)
    s_waitcnt vmcnt(8)
    v_mfma_f32_32x32x16_bf16 v[60:75], v[184:187], v[244:247], v[60:75]
    v_mfma_f32_32x32x16_bf16 v[76:91], v[184:187], v[248:251], v[76:91]
    ds_read_b128 v[244:247], v14 offset:15360
    ds_read_b128 v[248:251], v14 offset:48128
    s_waitcnt lgkmcnt(6)
    s_waitcnt vmcnt(7)
    v_mfma_f32_32x32x16_bf16 v[60:75], v[188:191], v[220:223], v[60:75]
    v_mfma_f32_32x32x16_bf16 v[76:91], v[188:191], v[224:227], v[76:91]
    ds_read_b128 v[220:223], v14 offset:19456
    ds_read_b128 v[224:227], v14 offset:52224
    s_waitcnt lgkmcnt(6)
    s_waitcnt vmcnt(6)
    v_mfma_f32_32x32x16_bf16 v[60:75], v[192:195], v[228:231], v[60:75]
    v_mfma_f32_32x32x16_bf16 v[76:91], v[192:195], v[232:235], v[76:91]
    ds_read_b128 v[228:231], v14 offset:23552
    ds_read_b128 v[232:235], v14 offset:56320
    s_waitcnt lgkmcnt(6)
    s_waitcnt vmcnt(5)
    v_mfma_f32_32x32x16_bf16 v[60:75], v[196:199], v[236:239], v[60:75]
    v_mfma_f32_32x32x16_bf16 v[76:91], v[196:199], v[240:243], v[76:91]
    ds_read_b128 v[236:239], v14 offset:27648
    ds_read_b128 v[240:243], v14 offset:60416
    s_waitcnt lgkmcnt(6)
    s_waitcnt vmcnt(4)
    v_mfma_f32_32x32x16_bf16 v[60:75], v[200:203], v[244:247], v[60:75]
    v_mfma_f32_32x32x16_bf16 v[76:91], v[200:203], v[248:251], v[76:91]
    ds_read_b128 v[244:247], v14 offset:31744
    ds_read_b128 v[248:251], v14 offset:64512
    s_waitcnt lgkmcnt(6)
    s_waitcnt vmcnt(3)
    v_mfma_f32_32x32x16_bf16 v[60:75], v[204:207], v[220:223], v[60:75]
    v_mfma_f32_32x32x16_bf16 v[76:91], v[204:207], v[224:227], v[76:91]
    s_waitcnt lgkmcnt(4)
    s_waitcnt vmcnt(2)
    v_mfma_f32_32x32x16_bf16 v[60:75], v[208:211], v[228:231], v[60:75]
    v_mfma_f32_32x32x16_bf16 v[76:91], v[208:211], v[232:235], v[76:91]
    s_waitcnt lgkmcnt(2)
    s_waitcnt vmcnt(1)
    v_mfma_f32_32x32x16_bf16 v[60:75], v[212:215], v[236:239], v[60:75]
    v_mfma_f32_32x32x16_bf16 v[76:91], v[212:215], v[240:243], v[76:91]
    s_waitcnt lgkmcnt(0)
    s_waitcnt vmcnt(0)
    v_mfma_f32_32x32x16_bf16 v[60:75], v[216:219], v[244:247], v[60:75]
    v_mfma_f32_32x32x16_bf16 v[76:91], v[216:219], v[248:251], v[76:91]
    s_branch L_chain0_kernel_w7b
L_chain0_kernel_w7a:
    s_lshl_b32 s30, s20, 13
    s_lshl_b32 s31, s22, 10
    s_add_u32 s30, s30, s31
    s_add_u32 s30, s30, 20447232
    s_add_u32 m0, s31, 149504
    s_nop 0
    buffer_load_dwordx4 v14, s[12:15], s30 offen sc1 lds
    s_lshl_b32 s30, s20, 16
    s_lshl_b32 s31, s22, 12
    s_add_u32 s30, s30, s31
    s_add_u32 s30, s30, 22020096
    s_add_u32 m0, s31, 0
    s_add_u32 s26, s30, 0
    buffer_load_dwordx4 v14, s[12:15], s26 offen sc1 lds
    s_add_u32 m0, s31, 32768
    s_add_u32 s26, s30, 32768
    buffer_load_dwordx4 v14, s[12:15], s26 offen sc1 lds
    s_add_u32 m0, s31, 1024
    s_add_u32 s26, s30, 1024
    buffer_load_dwordx4 v14, s[12:15], s26 offen sc1 lds
    s_add_u32 m0, s31, 33792
    s_add_u32 s26, s30, 33792
    buffer_load_dwordx4 v14, s[12:15], s26 offen sc1 lds
    s_add_u32 m0, s31, 2048
    s_add_u32 s26, s30, 2048
    buffer_load_dwordx4 v14, s[12:15], s26 offen sc1 lds
    s_add_u32 m0, s31, 34816
    s_add_u32 s26, s30, 34816
    buffer_load_dwordx4 v14, s[12:15], s26 offen sc1 lds
    s_add_u32 m0, s31, 3072
    s_add_u32 s26, s30, 3072
    buffer_load_dwordx4 v14, s[12:15], s26 offen sc1 lds
    s_add_u32 m0, s31, 35840
    s_add_u32 s26, s30, 35840
    buffer_load_dwordx4 v14, s[12:15], s26 offen sc1 lds
    s_waitcnt vmcnt(6)
    s_barrier
    s_waitcnt vmcnt(4)
    s_barrier
    s_waitcnt vmcnt(2)
    s_barrier
    s_waitcnt vmcnt(0)
    s_barrier
L_chain0_kernel_w7b:
    s_barrier
    s_cmp_eq_u32 s22, 7
    s_cbranch_scc1 L_chain0_kernel_ne53
    s_lshl_b32 s30, s22, 7
    s_add_u32 s30, s30, 148480
    v_lshrrev_b32 v3, 5, v0
    v_lshlrev_b32 v3, 4, v3
    v_add_u32 v3, s30, v3
    ds_read_b128 v[92:95], v3 offset:0
    ds_read_b128 v[96:99], v3 offset:32
    ds_read_b128 v[100:103], v3 offset:64
    ds_read_b128 v[104:107], v3 offset:96
    s_mul_i32 s32, s21, 7
    s_add_u32 s32, s32, s22
    s_lshl_b32 s32, s32, 11
    s_mul_i32 s33, s20, 229376
    s_add_u32 s32, s32, s33
    s_add_u32 s32, s32, 12582912
    s_waitcnt lgkmcnt(0)
    v_pk_mul_f32 v[108:109], v[92:93], v[18:19] op_sel:[0,1] op_sel_hi:[1,1]
    v_pk_mul_f32 v[110:111], v[94:95], v[18:19] op_sel:[0,1] op_sel_hi:[1,1]
    v_pk_mul_f32 v[112:113], v[96:97], v[18:19] op_sel:[0,1] op_sel_hi:[1,1]
    v_pk_mul_f32 v[114:115], v[98:99], v[18:19] op_sel:[0,1] op_sel_hi:[1,1]
    v_pk_mul_f32 v[116:117], v[100:101], v[18:19] op_sel:[0,1] op_sel_hi:[1,1]
    v_pk_mul_f32 v[118:119], v[102:103], v[18:19] op_sel:[0,1] op_sel_hi:[1,1]
    v_pk_mul_f32 v[120:121], v[104:105], v[18:19] op_sel:[0,1] op_sel_hi:[1,1]
    v_pk_mul_f32 v[122:123], v[106:107], v[18:19] op_sel:[0,1] op_sel_hi:[1,1]
    v_pk_fma_f32 v[60:61], v[60:61], v[18:19], v[108:109] op_sel:[0,0,0] op_sel_hi:[1,0,1]
    v_pk_fma_f32 v[62:63], v[62:63], v[18:19], v[110:111] op_sel:[0,0,0] op_sel_hi:[1,0,1]
    v_pk_fma_f32 v[64:65], v[64:65], v[18:19], v[112:113] op_sel:[0,0,0] op_sel_hi:[1,0,1]
    v_pk_fma_f32 v[66:67], v[66:67], v[18:19], v[114:115] op_sel:[0,0,0] op_sel_hi:[1,0,1]
    v_pk_fma_f32 v[68:69], v[68:69], v[18:19], v[116:117] op_sel:[0,0,0] op_sel_hi:[1,0,1]
    v_pk_fma_f32 v[70:71], v[70:71], v[18:19], v[118:119] op_sel:[0,0,0] op_sel_hi:[1,0,1]
    v_pk_fma_f32 v[72:73], v[72:73], v[18:19], v[120:121] op_sel:[0,0,0] op_sel_hi:[1,0,1]
    v_pk_fma_f32 v[74:75], v[74:75], v[18:19], v[122:123] op_sel:[0,0,0] op_sel_hi:[1,0,1]
    v_pk_mul_f32 v[108:109], v[60:61], v[60:61]
    v_pk_mul_f32 v[110:111], v[62:63], v[62:63]
    v_pk_mul_f32 v[112:113], v[64:65], v[64:65]
    v_pk_mul_f32 v[114:115], v[66:67], v[66:67]
    v_pk_mul_f32 v[116:117], v[68:69], v[68:69]
    v_pk_mul_f32 v[118:119], v[70:71], v[70:71]
    v_pk_mul_f32 v[120:121], v[72:73], v[72:73]
    v_pk_mul_f32 v[122:123], v[74:75], v[74:75]
    v_pk_fma_f32 v[108:109], v[108:109], v[22:23], v[22:23] op_sel:[0,1,0] op_sel_hi:[1,1,0]
    v_pk_fma_f32 v[110:111], v[110:111], v[22:23], v[22:23] op_sel:[0,1,0] op_sel_hi:[1,1,0]
    v_pk_fma_f32 v[112:113], v[112:113], v[22:23], v[22:23] op_sel:[0,1,0] op_sel_hi:[1,1,0]
    v_pk_fma_f32 v[114:115], v[114:115], v[22:23], v[22:23] op_sel:[0,1,0] op_sel_hi:[1,1,0]
    v_pk_fma_f32 v[116:117], v[116:117], v[22:23], v[22:23] op_sel:[0,1,0] op_sel_hi:[1,1,0]
    v_pk_fma_f32 v[118:119], v[118:119], v[22:23], v[22:23] op_sel:[0,1,0] op_sel_hi:[1,1,0]
    v_pk_fma_f32 v[120:121], v[120:121], v[22:23], v[22:23] op_sel:[0,1,0] op_sel_hi:[1,1,0]
    v_pk_fma_f32 v[122:123], v[122:123], v[22:23], v[22:23] op_sel:[0,1,0] op_sel_hi:[1,1,0]
    v_pk_mul_f32 v[108:109], v[108:109], v[60:61]
    v_pk_mul_f32 v[110:111], v[110:111], v[62:63]
    v_pk_mul_f32 v[112:113], v[112:113], v[64:65]
    v_pk_mul_f32 v[114:115], v[114:115], v[66:67]
    v_pk_mul_f32 v[116:117], v[116:117], v[68:69]
    v_pk_mul_f32 v[118:119], v[118:119], v[70:71]
    v_pk_mul_f32 v[120:121], v[120:121], v[72:73]
    v_pk_mul_f32 v[122:123], v[122:123], v[74:75]
    v_exp_f32 v108, v108
    v_exp_f32 v109, v109
    v_exp_f32 v110, v110
    v_exp_f32 v111, v111
    v_exp_f32 v112, v112
    v_exp_f32 v113, v113
    v_exp_f32 v114, v114
    v_exp_f32 v115, v115
    v_exp_f32 v116, v116
    v_exp_f32 v117, v117
    v_exp_f32 v118, v118
    v_exp_f32 v119, v119
    v_exp_f32 v120, v120
    v_exp_f32 v121, v121
    v_exp_f32 v122, v122
    v_exp_f32 v123, v123
    v_pk_add_f32 v[108:109], v[108:109], 1.0 op_sel_hi:[1,0]
    v_pk_add_f32 v[110:111], v[110:111], 1.0 op_sel_hi:[1,0]
    v_pk_add_f32 v[112:113], v[112:113], 1.0 op_sel_hi:[1,0]
    v_pk_add_f32 v[114:115], v[114:115], 1.0 op_sel_hi:[1,0]
    v_pk_add_f32 v[116:117], v[116:117], 1.0 op_sel_hi:[1,0]
    v_pk_add_f32 v[118:119], v[118:119], 1.0 op_sel_hi:[1,0]
    v_pk_add_f32 v[120:121], v[120:121], 1.0 op_sel_hi:[1,0]
    v_pk_add_f32 v[122:123], v[122:123], 1.0 op_sel_hi:[1,0]
    v_rcp_f32 v108, v108
    v_rcp_f32 v109, v109
    v_rcp_f32 v110, v110
    v_rcp_f32 v111, v111
    v_rcp_f32 v112, v112
    v_rcp_f32 v113, v113
    v_rcp_f32 v114, v114
    v_rcp_f32 v115, v115
    v_rcp_f32 v116, v116
    v_rcp_f32 v117, v117
    v_rcp_f32 v118, v118
    v_rcp_f32 v119, v119
    v_rcp_f32 v120, v120
    v_rcp_f32 v121, v121
    v_rcp_f32 v122, v122
    v_rcp_f32 v123, v123
    v_pk_mul_f32 v[60:61], v[60:61], v[108:109]
    v_pk_mul_f32 v[62:63], v[62:63], v[110:111]
    v_pk_mul_f32 v[64:65], v[64:65], v[112:113]
    v_pk_mul_f32 v[66:67], v[66:67], v[114:115]
    v_pk_mul_f32 v[68:69], v[68:69], v[116:117]
    v_pk_mul_f32 v[70:71], v[70:71], v[118:119]
    v_pk_mul_f32 v[72:73], v[72:73], v[120:121]
    v_pk_mul_f32 v[74:75], v[74:75], v[122:123]
    v_cvt_pk_bf16_f32 v124, v60, v61
    v_cvt_pk_bf16_f32 v125, v62, v63
    v_cvt_pk_bf16_f32 v126, v64, v65
    v_cvt_pk_bf16_f32 v127, v66, v67
    v_cvt_pk_bf16_f32 v128, v68, v69
    v_cvt_pk_bf16_f32 v129, v70, v71
    v_cvt_pk_bf16_f32 v130, v72, v73
    v_cvt_pk_bf16_f32 v131, v74, v75
    s_cmp_eq_u32 s29, 1
    s_cbranch_scc1 L_chain0_kernel_sf55
    buffer_store_dwordx4 v[124:127], v14, s[12:15], s32 offen sc1
    buffer_store_dwordx4 v[128:131], v14, s[12:15], s32 offen offset:1024 sc1
    s_branch L_chain0_kernel_sd56
L_chain0_kernel_sf55:
    buffer_store_dwordx4 v[124:127], v14, s[12:15], s32 offen
    buffer_store_dwordx4 v[128:131], v14, s[12:15], s32 offen offset:1024
L_chain0_kernel_sd56:
    s_add_u32 s32, s32, 114688
    v_pk_mul_f32 v[108:109], v[92:93], v[20:21] op_sel:[0,1] op_sel_hi:[1,1]
    v_pk_mul_f32 v[110:111], v[94:95], v[20:21] op_sel:[0,1] op_sel_hi:[1,1]
    v_pk_mul_f32 v[112:113], v[96:97], v[20:21] op_sel:[0,1] op_sel_hi:[1,1]
    v_pk_mul_f32 v[114:115], v[98:99], v[20:21] op_sel:[0,1] op_sel_hi:[1,1]
    v_pk_mul_f32 v[116:117], v[100:101], v[20:21] op_sel:[0,1] op_sel_hi:[1,1]
    v_pk_mul_f32 v[118:119], v[102:103], v[20:21] op_sel:[0,1] op_sel_hi:[1,1]
    v_pk_mul_f32 v[120:121], v[104:105], v[20:21] op_sel:[0,1] op_sel_hi:[1,1]
    v_pk_mul_f32 v[122:123], v[106:107], v[20:21] op_sel:[0,1] op_sel_hi:[1,1]
    v_pk_fma_f32 v[76:77], v[76:77], v[20:21], v[108:109] op_sel:[0,0,0] op_sel_hi:[1,0,1]
    v_pk_fma_f32 v[78:79], v[78:79], v[20:21], v[110:111] op_sel:[0,0,0] op_sel_hi:[1,0,1]
    v_pk_fma_f32 v[80:81], v[80:81], v[20:21], v[112:113] op_sel:[0,0,0] op_sel_hi:[1,0,1]
    v_pk_fma_f32 v[82:83], v[82:83], v[20:21], v[114:115] op_sel:[0,0,0] op_sel_hi:[1,0,1]
    v_pk_fma_f32 v[84:85], v[84:85], v[20:21], v[116:117] op_sel:[0,0,0] op_sel_hi:[1,0,1]
    v_pk_fma_f32 v[86:87], v[86:87], v[20:21], v[118:119] op_sel:[0,0,0] op_sel_hi:[1,0,1]
    v_pk_fma_f32 v[88:89], v[88:89], v[20:21], v[120:121] op_sel:[0,0,0] op_sel_hi:[1,0,1]
    v_pk_fma_f32 v[90:91], v[90:91], v[20:21], v[122:123] op_sel:[0,0,0] op_sel_hi:[1,0,1]
    v_pk_mul_f32 v[108:109], v[76:77], v[76:77]
    v_pk_mul_f32 v[110:111], v[78:79], v[78:79]
    v_pk_mul_f32 v[112:113], v[80:81], v[80:81]
    v_pk_mul_f32 v[114:115], v[82:83], v[82:83]
    v_pk_mul_f32 v[116:117], v[84:85], v[84:85]
    v_pk_mul_f32 v[118:119], v[86:87], v[86:87]
    v_pk_mul_f32 v[120:121], v[88:89], v[88:89]
    v_pk_mul_f32 v[122:123], v[90:91], v[90:91]
    v_pk_fma_f32 v[108:109], v[108:109], v[22:23], v[22:23] op_sel:[0,1,0] op_sel_hi:[1,1,0]
    v_pk_fma_f32 v[110:111], v[110:111], v[22:23], v[22:23] op_sel:[0,1,0] op_sel_hi:[1,1,0]
    v_pk_fma_f32 v[112:113], v[112:113], v[22:23], v[22:23] op_sel:[0,1,0] op_sel_hi:[1,1,0]
    v_pk_fma_f32 v[114:115], v[114:115], v[22:23], v[22:23] op_sel:[0,1,0] op_sel_hi:[1,1,0]
    v_pk_fma_f32 v[116:117], v[116:117], v[22:23], v[22:23] op_sel:[0,1,0] op_sel_hi:[1,1,0]
    v_pk_fma_f32 v[118:119], v[118:119], v[22:23], v[22:23] op_sel:[0,1,0] op_sel_hi:[1,1,0]
    v_pk_fma_f32 v[120:121], v[120:121], v[22:23], v[22:23] op_sel:[0,1,0] op_sel_hi:[1,1,0]
    v_pk_fma_f32 v[122:123], v[122:123], v[22:23], v[22:23] op_sel:[0,1,0] op_sel_hi:[1,1,0]
    v_pk_mul_f32 v[108:109], v[108:109], v[76:77]
    v_pk_mul_f32 v[110:111], v[110:111], v[78:79]
    v_pk_mul_f32 v[112:113], v[112:113], v[80:81]
    v_pk_mul_f32 v[114:115], v[114:115], v[82:83]
    v_pk_mul_f32 v[116:117], v[116:117], v[84:85]
    v_pk_mul_f32 v[118:119], v[118:119], v[86:87]
    v_pk_mul_f32 v[120:121], v[120:121], v[88:89]
    v_pk_mul_f32 v[122:123], v[122:123], v[90:91]
    v_exp_f32 v108, v108
    v_exp_f32 v109, v109
    v_exp_f32 v110, v110
    v_exp_f32 v111, v111
    v_exp_f32 v112, v112
    v_exp_f32 v113, v113
    v_exp_f32 v114, v114
    v_exp_f32 v115, v115
    v_exp_f32 v116, v116
    v_exp_f32 v117, v117
    v_exp_f32 v118, v118
    v_exp_f32 v119, v119
    v_exp_f32 v120, v120
    v_exp_f32 v121, v121
    v_exp_f32 v122, v122
    v_exp_f32 v123, v123
    v_pk_add_f32 v[108:109], v[108:109], 1.0 op_sel_hi:[1,0]
    v_pk_add_f32 v[110:111], v[110:111], 1.0 op_sel_hi:[1,0]
    v_pk_add_f32 v[112:113], v[112:113], 1.0 op_sel_hi:[1,0]
    v_pk_add_f32 v[114:115], v[114:115], 1.0 op_sel_hi:[1,0]
    v_pk_add_f32 v[116:117], v[116:117], 1.0 op_sel_hi:[1,0]
    v_pk_add_f32 v[118:119], v[118:119], 1.0 op_sel_hi:[1,0]
    v_pk_add_f32 v[120:121], v[120:121], 1.0 op_sel_hi:[1,0]
    v_pk_add_f32 v[122:123], v[122:123], 1.0 op_sel_hi:[1,0]
    v_rcp_f32 v108, v108
    v_rcp_f32 v109, v109
    v_rcp_f32 v110, v110
    v_rcp_f32 v111, v111
    v_rcp_f32 v112, v112
    v_rcp_f32 v113, v113
    v_rcp_f32 v114, v114
    v_rcp_f32 v115, v115
    v_rcp_f32 v116, v116
    v_rcp_f32 v117, v117
    v_rcp_f32 v118, v118
    v_rcp_f32 v119, v119
    v_rcp_f32 v120, v120
    v_rcp_f32 v121, v121
    v_rcp_f32 v122, v122
    v_rcp_f32 v123, v123
    v_pk_mul_f32 v[76:77], v[76:77], v[108:109]
    v_pk_mul_f32 v[78:79], v[78:79], v[110:111]
    v_pk_mul_f32 v[80:81], v[80:81], v[112:113]
    v_pk_mul_f32 v[82:83], v[82:83], v[114:115]
    v_pk_mul_f32 v[84:85], v[84:85], v[116:117]
    v_pk_mul_f32 v[86:87], v[86:87], v[118:119]
    v_pk_mul_f32 v[88:89], v[88:89], v[120:121]
    v_pk_mul_f32 v[90:91], v[90:91], v[122:123]
    v_cvt_pk_bf16_f32 v124, v76, v77
    v_cvt_pk_bf16_f32 v125, v78, v79
    v_cvt_pk_bf16_f32 v126, v80, v81
    v_cvt_pk_bf16_f32 v127, v82, v83
    v_cvt_pk_bf16_f32 v128, v84, v85
    v_cvt_pk_bf16_f32 v129, v86, v87
    v_cvt_pk_bf16_f32 v130, v88, v89
    v_cvt_pk_bf16_f32 v131, v90, v91
    s_cmp_eq_u32 s29, 1
    s_cbranch_scc1 L_chain0_kernel_sf57
    buffer_store_dwordx4 v[124:127], v14, s[12:15], s32 offen sc1
    buffer_store_dwordx4 v[128:131], v14, s[12:15], s32 offen offset:1024 sc1
    s_branch L_chain0_kernel_sd58
L_chain0_kernel_sf57:
    buffer_store_dwordx4 v[124:127], v14, s[12:15], s32 offen
    buffer_store_dwordx4 v[128:131], v14, s[12:15], s32 offen offset:1024
L_chain0_kernel_sd58:
L_chain0_kernel_ne53:
    s_waitcnt vmcnt(0)
    s_barrier
    s_cmp_ge_u32 s22, 4
    s_cbranch_scc1 L_chain0_kernel_ldtail
    s_cmp_lg_u32 s22, 0
    s_cbranch_scc1 L_chain0_kernel_ya59
    s_mov_b64 s[40:41], exec
    s_cmp_eq_u32 s29, 1
    s_cbranch_scc0 L_chain0_kernel_yb60
    s_mov_b32 s30, 1
    s_atomic_add s30, s[48:49], 0xc000
    s_branch L_chain0_kernel_yc61
L_chain0_kernel_yb60:
    s_add_u32 s30, s50, 49152
    s_mov_b64 exec, 1
    v_mov_b32 v2, s30
    v_mov_b32 v3, 1
    buffer_atomic_add v3, v2, s[12:15], 0 offen sc1
L_chain0_kernel_yc61:
    s_mov_b64 exec, s[40:41]
L_chain0_kernel_ya59:
    s_cmp_lg_u32 s22, 0
    s_cbranch_scc1 L_chain0_kernel_yk62
    s_mov_b64 s[40:41], exec
    s_cmp_eq_u32 s29, 1
    s_cbranch_scc0 L_chain0_kernel_ys63
    s_mov_b32 s47, 0
L_chain0_kernel_yl65:
    s_mov_b32 s31, 0
    s_atomic_add s31, s[48:49], 0xc000 glc
    s_add_u32 s47, s47, 1
    s_cmp_gt_u32 s47, 262144
    s_cbranch_scc1 L_chain0_kernel_ye66
    s_waitcnt lgkmcnt(0)
    s_cmp_ge_u32 s31, 8
    s_cbranch_scc0 L_chain0_kernel_yl65
L_chain0_kernel_ye66:
    s_waitcnt lgkmcnt(0)
    s_branch L_chain0_kernel_yd64
L_chain0_kernel_ys63:
    s_add_u32 s30, s50, 49152
    s_mov_b64 exec, 1
    v_mov_b32 v2, s30
    v_mov_b32 v3, 8
    s_mov_b32 s47, 0
L_chain0_kernel_pl67:
    buffer_load_dword v4, v2, s[12:15], 0 offen sc1
    s_add_u32 s47, s47, 1
    s_cmp_gt_u32 s47, 262144
    s_cbranch_scc1 L_chain0_kernel_pd68
    s_waitcnt vmcnt(0)
    v_cmp_ge_u32 vcc, v4, v3
    s_nop 1
    s_cmp_eq_u32 vcc_lo, 1
    s_cbranch_scc0 L_chain0_kernel_pl67
L_chain0_kernel_pd68:
    s_waitcnt vmcnt(0)
L_chain0_kernel_yd64:
    s_mov_b64 exec, s[40:41]
L_chain0_kernel_yk62:
    s_barrier
    s_lshl_b32 s44, s21, 1
    s_add_u32 s44, s44, s24
    s_lshl_b32 s45, s44, 1
    s_mul_i32 s30, s24, 1024
    s_add_u32 s30, s30, 2048
    v_lshlrev_b32 v11, 4, v0
    v_add_u32 v8, s30, v11
    s_lshl_b32 s30, s23, 10
    v_add_u32 v11, s30, v11
    v_add_u32 v9, 65536, v8
    v_add_u32 v12, 65536, v11
    s_barrier
    ds_read_b128 v[124:127], v11 offset:0
    ds_read_b128 v[128:131], v8 offset:0
    ds_read_b128 v[132:135], v11 offset:4096
    ds_read_b128 v[136:139], v8 offset:4096
    ds_read_b128 v[140:143], v11 offset:8192
    ds_read_b128 v[144:147], v8 offset:8192
    ds_read_b128 v[148:151], v11 offset:12288
    ds_read_b128 v[152:155], v8 offset:12288
    s_barrier
    ds_read_b128 v[156:159], v11 offset:16384
    ds_read_b128 v[160:163], v8 offset:16384
    s_waitcnt lgkmcnt(8)
    v_mfma_f32_32x32x16_bf16 v[60:75], v[128:131], v[124:127], 0
    ds_read_b128 v[124:127], v11 offset:20480
    ds_read_b128 v[128:131], v8 offset:20480
    s_waitcnt lgkmcnt(8)
    v_mfma_f32_32x32x16_bf16 v[60:75], v[136:139], v[132:135], v[60:75]
    ds_read_b128 v[132:135], v11 offset:24576
    ds_read_b128 v[136:139], v8 offset:24576
    s_waitcnt lgkmcnt(8)
    v_mfma_f32_32x32x16_bf16 v[60:75], v[144:147], v[140:143], v[60:75]
    ds_read_b128 v[140:143], v11 offset:28672
    ds_read_b128 v[144:147], v8 offset:28672
    s_waitcnt lgkmcnt(8)
    v_mfma_f32_32x32x16_bf16 v[60:75], v[152:155], v[148:151], v[60:75]
    s_barrier
    ds_read_b128 v[148:151], v11 offset:32768
    ds_read_b128 v[152:155], v8 offset:32768
    s_waitcnt lgkmcnt(8)
    v_mfma_f32_32x32x16_bf16 v[60:75], v[160:163], v[156:159], v[60:75]
    ds_read_b128 v[156:159], v11 offset:36864
    ds_read_b128 v[160:163], v8 offset:36864
    s_waitcnt lgkmcnt(8)
    v_mfma_f32_32x32x16_bf16 v[60:75], v[128:131], v[124:127], v[60:75]
    ds_read_b128 v[124:127], v11 offset:40960
    ds_read_b128 v[128:131], v8 offset:40960
    s_waitcnt lgkmcnt(8)
    v_mfma_f32_32x32x16_bf16 v[60:75], v[136:139], v[132:135], v[60:75]
    ds_read_b128 v[132:135], v11 offset:45056
    ds_read_b128 v[136:139], v8 offset:45056
    s_waitcnt lgkmcnt(8)
    v_mfma_f32_32x32x16_bf16 v[60:75], v[144:147], v[140:143], v[60:75]
    s_barrier
    ds_read_b128 v[140:143], v11 offset:49152
    ds_read_b128 v[144:147], v8 offset:49152
    s_waitcnt lgkmcnt(8)
    v_mfma_f32_32x32x16_bf16 v[60:75], v[152:155], v[148:151], v[60:75]
    ds_read_b128 v[148:151], v11 offset:53248
    ds_read_b128 v[152:155], v8 offset:53248
    s_waitcnt lgkmcnt(8)
    v_mfma_f32_32x32x16_bf16 v[60:75], v[160:163], v[156:159], v[60:75]
    ds_read_b128 v[156:159], v11 offset:57344
    ds_read_b128 v[160:163], v8 offset:57344
    s_waitcnt lgkmcnt(8)
    v_mfma_f32_32x32x16_bf16 v[60:75], v[128:131], v[124:127], v[60:75]
    ds_read_b128 v[124:127], v11 offset:61440
    ds_read_b128 v[128:131], v8 offset:61440
    s_waitcnt lgkmcnt(8)
    v_mfma_f32_32x32x16_bf16 v[60:75], v[136:139], v[132:135], v[60:75]
    s_barrier
    ds_read_b128 v[132:135], v12 offset:0
    ds_read_b128 v[136:139], v9 offset:0
    s_waitcnt lgkmcnt(8)
    v_mfma_f32_32x32x16_bf16 v[60:75], v[144:147], v[140:143], v[60:75]
    ds_read_b128 v[140:143], v12 offset:4096
    ds_read_b128 v[144:147], v9 offset:4096
    s_waitcnt lgkmcnt(8)
    v_mfma_f32_32x32x16_bf16 v[60:75], v[152:155], v[148:151], v[60:75]
    ds_read_b128 v[148:151], v12 offset:8192
    ds_read_b128 v[152:155], v9 offset:8192
    s_waitcnt lgkmcnt(8)
    v_mfma_f32_32x32x16_bf16 v[60:75], v[160:163], v[156:159], v[60:75]
    ds_read_b128 v[156:159], v12 offset:12288
    ds_read_b128 v[160:163], v9 offset:12288
    s_waitcnt lgkmcnt(8)
    v_mfma_f32_32x32x16_bf16 v[60:75], v[128:131], v[124:127], v[60:75]
    s_barrier
    ds_read_b128 v[124:127], v12 offset:16384
    ds_read_b128 v[128:131], v9 offset:16384
    s_waitcnt lgkmcnt(8)
    v_mfma_f32_32x32x16_bf16 v[60:75], v[136:139], v[132:135], v[60:75]
    ds_read_b128 v[132:135], v12 offset:20480
    ds_read_b128 v[136:139], v9 offset:20480
    s_waitcnt lgkmcnt(8)
    v_mfma_f32_32x32x16_bf16 v[60:75], v[144:147], v[140:143], v[60:75]
    ds_read_b128 v[140:143], v12 offset:24576
    ds_read_b128 v[144:147], v9 offset:24576
    s_waitcnt lgkmcnt(8)
    v_mfma_f32_32x32x16_bf16 v[60:75], v[152:155], v[148:151], v[60:75]
    ds_read_b128 v[148:151], v12 offset:28672
    ds_read_b128 v[152:155], v9 offset:28672
    s_waitcnt lgkmcnt(8)
    v_mfma_f32_32x32x16_bf16 v[60:75], v[160:163], v[156:159], v[60:75]
    s_barrier
    ds_read_b128 v[156:159], v12 offset:32768
    ds_read_b128 v[160:163], v9 offset:32768
    s_waitcnt lgkmcnt(8)
    v_mfma_f32_32x32x16_bf16 v[60:75], v[128:131], v[124:127], v[60:75]
    ds_read_b128 v[124:127], v12 offset:36864
    ds_read_b128 v[128:131], v9 offset:36864
    s_waitcnt lgkmcnt(8)
    v_mfma_f32_32x32x16_bf16 v[60:75], v[136:139], v[132:135], v[60:75]
    ds_read_b128 v[132:135], v12 offset:40960
    ds_read_b128 v[136:139], v9 offset:40960
    s_waitcnt lgkmcnt(8)
    v_mfma_f32_32x32x16_bf16 v[60:75], v[144:147], v[140:143], v[60:75]
    ds_read_b128 v[140:143], v12 offset:45056
    ds_read_b128 v[144:147], v9 offset:45056
    s_waitcnt lgkmcnt(8)
    v_mfma_f32_32x32x16_bf16 v[60:75], v[152:155], v[148:151], v[60:75]
    s_barrier
    ds_read_b128 v[148:151], v12 offset:49152
    ds_read_b128 v[152:155], v9 offset:49152
    s_waitcnt lgkmcnt(8)
    v_mfma_f32_32x32x16_bf16 v[60:75], v[160:163], v[156:159], v[60:75]
    ds_read_b128 v[156:159], v12 offset:53248
    ds_read_b128 v[160:163], v9 offset:53248
    s_waitcnt lgkmcnt(8)
    v_mfma_f32_32x32x16_bf16 v[60:75], v[128:131], v[124:127], v[60:75]
    ds_read_b128 v[124:127], v12 offset:57344
    ds_read_b128 v[128:131], v9 offset:57344
    s_waitcnt lgkmcnt(8)
    v_mfma_f32_32x32x16_bf16 v[60:75], v[136:139], v[132:135], v[60:75]
    ds_read_b128 v[132:135], v12 offset:61440
    ds_read_b128 v[136:139], v9 offset:61440
    s_waitcnt lgkmcnt(8)
    v_mfma_f32_32x32x16_bf16 v[60:75], v[144:147], v[140:143], v[60:75]
    s_barrier
    ds_read_b128 v[140:143], v11 offset:0
    ds_read_b128 v[144:147], v8 offset:0
    s_waitcnt lgkmcnt(8)
    v_mfma_f32_32x32x16_bf16 v[60:75], v[152:155], v[148:151], v[60:75]
    ds_read_b128 v[148:151], v11 offset:4096
    ds_read_b128 v[152:155], v8 offset:4096
    s_waitcnt lgkmcnt(8)
    v_mfma_f32_32x32x16_bf16 v[60:75], v[160:163], v[156:159], v[60:75]
    ds_read_b128 v[156:159], v11 offset:8192
    ds_read_b128 v[160:163], v8 offset:8192
    s_waitcnt lgkmcnt(8)
    v_mfma_f32_32x32x16_bf16 v[60:75], v[128:131], v[124:127], v[60:75]
    ds_read_b128 v[124:127], v11 offset:12288
    ds_read_b128 v[128:131], v8 offset:12288
    s_waitcnt lgkmcnt(8)
    v_mfma_f32_32x32x16_bf16 v[60:75], v[136:139], v[132:135], v[60:75]
    s_barrier
    ds_read_b128 v[132:135], v11 offset:16384
    ds_read_b128 v[136:139], v8 offset:16384
    s_waitcnt lgkmcnt(8)
    v_mfma_f32_32x32x16_bf16 v[60:75], v[144:147], v[140:143], v[60:75]
    ds_read_b128 v[140:143], v11 offset:20480
    ds_read_b128 v[144:147], v8 offset:20480
    s_waitcnt lgkmcnt(8)
    v_mfma_f32_32x32x16_bf16 v[60:75], v[152:155], v[148:151], v[60:75]
    ds_read_b128 v[148:151], v11 offset:24576
    ds_read_b128 v[152:155], v8 offset:24576
    s_waitcnt lgkmcnt(8)
    v_mfma_f32_32x32x16_bf16 v[60:75], v[160:163], v[156:159], v[60:75]
    ds_read_b128 v[156:159], v11 offset:28672
    ds_read_b128 v[160:163], v8 offset:28672
    s_waitcnt lgkmcnt(8)
    v_mfma_f32_32x32x16_bf16 v[60:75], v[128:131], v[124:127], v[60:75]
    s_barrier
    ds_read_b128 v[124:127], v11 offset:32768
    ds_read_b128 v[128:131], v8 offset:32768
    s_waitcnt lgkmcnt(8)
    v_mfma_f32_32x32x16_bf16 v[60:75], v[136:139], v[132:135], v[60:75]
    ds_read_b128 v[132:135], v11 offset:36864
    ds_read_b128 v[136:139], v8 offset:36864
    s_waitcnt lgkmcnt(8)
    v_mfma_f32_32x32x16_bf16 v[60:75], v[144:147], v[140:143], v[60:75]
    ds_read_b128 v[140:143], v11 offset:40960
    ds_read_b128 v[144:147], v8 offset:40960
    s_waitcnt lgkmcnt(8)
    v_mfma_f32_32x32x16_bf16 v[60:75], v[152:155], v[148:151], v[60:75]
    ds_read_b128 v[148:151], v11 offset:45056
    ds_read_b128 v[152:155], v8 offset:45056
    s_waitcnt lgkmcnt(8)
    v_mfma_f32_32x32x16_bf16 v[60:75], v[160:163], v[156:159], v[60:75]
    s_barrier
    ds_read_b128 v[156:159], v11 offset:49152
    ds_read_b128 v[160:163], v8 offset:49152
    s_waitcnt lgkmcnt(8)
    v_mfma_f32_32x32x16_bf16 v[60:75], v[128:131], v[124:127], v[60:75]
    ds_read_b128 v[124:127], v11 offset:53248
    ds_read_b128 v[128:131], v8 offset:53248
    s_waitcnt lgkmcnt(8)
    v_mfma_f32_32x32x16_bf16 v[60:75], v[136:139], v[132:135], v[60:75]
    ds_read_b128 v[132:135], v11 offset:57344
    ds_read_b128 v[136:139], v8 offset:57344
    s_waitcnt lgkmcnt(8)
    v_mfma_f32_32x32x16_bf16 v[60:75], v[144:147], v[140:143], v[60:75]
    ds_read_b128 v[140:143], v11 offset:61440
    ds_read_b128 v[144:147], v8 offset:61440
    s_waitcnt lgkmcnt(8)
    v_mfma_f32_32x32x16_bf16 v[60:75], v[152:155], v[148:151], v[60:75]
    s_barrier
    ds_read_b128 v[148:151], v12 offset:0
    ds_read_b128 v[152:155], v9 offset:0
    s_waitcnt lgkmcnt(8)
    v_mfma_f32_32x32x16_bf16 v[60:75], v[160:163], v[156:159], v[60:75]
    ds_read_b128 v[156:159], v12 offset:4096
    ds_read_b128 v[160:163], v9 offset:4096
    s_waitcnt lgkmcnt(8)
    v_mfma_f32_32x32x16_bf16 v[60:75], v[128:131], v[124:127], v[60:75]
    ds_read_b128 v[124:127], v12 offset:8192
    ds_read_b128 v[128:131], v9 offset:8192
    s_waitcnt lgkmcnt(8)
    v_mfma_f32_32x32x16_bf16 v[60:75], v[136:139], v[132:135], v[60:75]
    ds_read_b128 v[132:135], v12 offset:12288
    ds_read_b128 v[136:139], v9 offset:12288
    s_waitcnt lgkmcnt(8)
    v_mfma_f32_32x32x16_bf16 v[60:75], v[144:147], v[140:143], v[60:75]
    s_barrier
    ds_read_b128 v[140:143], v12 offset:16384
    ds_read_b128 v[144:147], v9 offset:16384
    s_waitcnt lgkmcnt(8)
    v_mfma_f32_32x32x16_bf16 v[60:75], v[152:155], v[148:151], v[60:75]
    ds_read_b128 v[148:151], v12 offset:20480
    ds_read_b128 v[152:155], v9 offset:20480
    s_waitcnt lgkmcnt(8)
    v_mfma_f32_32x32x16_bf16 v[60:75], v[160:163], v[156:159], v[60:75]
    ds_read_b128 v[156:159], v12 offset:24576
    ds_read_b128 v[160:163], v9 offset:24576
    s_waitcnt lgkmcnt(8)
    v_mfma_f32_32x32x16_bf16 v[60:75], v[128:131], v[124:127], v[60:75]
    ds_read_b128 v[124:127], v12 offset:28672
    ds_read_b128 v[128:131], v9 offset:28672
    s_waitcnt lgkmcnt(8)
    v_mfma_f32_32x32x16_bf16 v[60:75], v[136:139], v[132:135], v[60:75]
    s_barrier
    ds_read_b128 v[132:135], v12 offset:32768
    ds_read_b128 v[136:139], v9 offset:32768
    s_waitcnt lgkmcnt(8)
    v_mfma_f32_32x32x16_bf16 v[60:75], v[144:147], v[140:143], v[60:75]
    ds_read_b128 v[140:143], v12 offset:36864
    ds_read_b128 v[144:147], v9 offset:36864
    s_waitcnt lgkmcnt(8)
    v_mfma_f32_32x32x16_bf16 v[60:75], v[152:155], v[148:151], v[60:75]
    ds_read_b128 v[148:151], v12 offset:40960
    ds_read_b128 v[152:155], v9 offset:40960
    s_waitcnt lgkmcnt(8)
    v_mfma_f32_32x32x16_bf16 v[60:75], v[160:163], v[156:159], v[60:75]
    ds_read_b128 v[156:159], v12 offset:45056
    ds_read_b128 v[160:163], v9 offset:45056
    s_waitcnt lgkmcnt(8)
    v_mfma_f32_32x32x16_bf16 v[60:75], v[128:131], v[124:127], v[60:75]
    s_barrier
    ds_read_b128 v[124:127], v12 offset:49152
    ds_read_b128 v[128:131], v9 offset:49152
    s_waitcnt lgkmcnt(8)
    v_mfma_f32_32x32x16_bf16 v[60:75], v[136:139], v[132:135], v[60:75]
    ds_read_b128 v[132:135], v12 offset:53248
    ds_read_b128 v[136:139], v9 offset:53248
    s_waitcnt lgkmcnt(8)
    v_mfma_f32_32x32x16_bf16 v[60:75], v[144:147], v[140:143], v[60:75]
    ds_read_b128 v[140:143], v12 offset:57344
    ds_read_b128 v[144:147], v9 offset:57344
    s_waitcnt lgkmcnt(8)
    v_mfma_f32_32x32x16_bf16 v[60:75], v[152:155], v[148:151], v[60:75]
    ds_read_b128 v[148:151], v12 offset:61440
    ds_read_b128 v[152:155], v9 offset:61440
    s_waitcnt lgkmcnt(8)
    v_mfma_f32_32x32x16_bf16 v[60:75], v[160:163], v[156:159], v[60:75]
    s_barrier
    ds_read_b128 v[156:159], v11 offset:0
    ds_read_b128 v[160:163], v8 offset:0
    s_waitcnt lgkmcnt(8)
    v_mfma_f32_32x32x16_bf16 v[60:75], v[128:131], v[124:127], v[60:75]
    ds_read_b128 v[124:127], v11 offset:4096
    ds_read_b128 v[128:131], v8 offset:4096
    s_waitcnt lgkmcnt(8)
    v_mfma_f32_32x32x16_bf16 v[60:75], v[136:139], v[132:135], v[60:75]
    ds_read_b128 v[132:135], v11 offset:8192
    ds_read_b128 v[136:139], v8 offset:8192
    s_waitcnt lgkmcnt(8)
    v_mfma_f32_32x32x16_bf16 v[60:75], v[144:147], v[140:143], v[60:75]
    ds_read_b128 v[140:143], v11 offset:12288
    ds_read_b128 v[144:147], v8 offset:12288
    s_waitcnt lgkmcnt(8)
    v_mfma_f32_32x32x16_bf16 v[60:75], v[152:155], v[148:151], v[60:75]
    s_barrier
    ds_read_b128 v[148:151], v11 offset:16384
    ds_read_b128 v[152:155], v8 offset:16384
    s_waitcnt lgkmcnt(8)
    v_mfma_f32_32x32x16_bf16 v[60:75], v[160:163], v[156:159], v[60:75]
    ds_read_b128 v[156:159], v11 offset:20480
    ds_read_b128 v[160:163], v8 offset:20480
    s_waitcnt lgkmcnt(8)
    v_mfma_f32_32x32x16_bf16 v[60:75], v[128:131], v[124:127], v[60:75]
    ds_read_b128 v[124:127], v11 offset:24576
    ds_read_b128 v[128:131], v8 offset:24576
    s_waitcnt lgkmcnt(8)
    v_mfma_f32_32x32x16_bf16 v[60:75], v[136:139], v[132:135], v[60:75]
    ds_read_b128 v[132:135], v11 offset:28672
    ds_read_b128 v[136:139], v8 offset:28672
    s_waitcnt lgkmcnt(8)
    v_mfma_f32_32x32x16_bf16 v[60:75], v[144:147], v[140:143], v[60:75]
    s_barrier
    ds_read_b128 v[140:143], v11 offset:32768
    ds_read_b128 v[144:147], v8 offset:32768
    s_waitcnt lgkmcnt(8)
    v_mfma_f32_32x32x16_bf16 v[60:75], v[152:155], v[148:151], v[60:75]
    ds_read_b128 v[148:151], v11 offset:36864
    ds_read_b128 v[152:155], v8 offset:36864
    s_waitcnt lgkmcnt(8)
    v_mfma_f32_32x32x16_bf16 v[60:75], v[160:163], v[156:159], v[60:75]
    ds_read_b128 v[156:159], v11 offset:40960
    ds_read_b128 v[160:163], v8 offset:40960
    s_waitcnt lgkmcnt(8)
    v_mfma_f32_32x32x16_bf16 v[60:75], v[128:131], v[124:127], v[60:75]
    ds_read_b128 v[124:127], v11 offset:45056
    ds_read_b128 v[128:131], v8 offset:45056
    s_waitcnt lgkmcnt(8)
    v_mfma_f32_32x32x16_bf16 v[60:75], v[136:139], v[132:135], v[60:75]
    s_barrier
    ds_read_b128 v[132:135], v11 offset:49152
    ds_read_b128 v[136:139], v8 offset:49152
    s_waitcnt lgkmcnt(8)
    v_mfma_f32_32x32x16_bf16 v[60:75], v[144:147], v[140:143], v[60:75]
    ds_read_b128 v[140:143], v11 offset:53248
    ds_read_b128 v[144:147], v8 offset:53248
    s_waitcnt lgkmcnt(8)
    v_mfma_f32_32x32x16_bf16 v[60:75], v[152:155], v[148:151], v[60:75]
    ds_read_b128 v[148:151], v11 offset:57344
    ds_read_b128 v[152:155], v8 offset:57344
    s_waitcnt lgkmcnt(8)
    v_mfma_f32_32x32x16_bf16 v[60:75], v[160:163], v[156:159], v[60:75]
    ds_read_b128 v[156:159], v11 offset:61440
    ds_read_b128 v[160:163], v8 offset:61440
    s_waitcnt lgkmcnt(8)
    v_mfma_f32_32x32x16_bf16 v[60:75], v[128:131], v[124:127], v[60:75]
    s_barrier
    ds_read_b128 v[124:127], v12 offset:0
    ds_read_b128 v[128:131], v9 offset:0
    s_waitcnt lgkmcnt(8)
    v_mfma_f32_32x32x16_bf16 v[60:75], v[136:139], v[132:135], v[60:75]
    ds_read_b128 v[132:135], v12 offset:4096
    ds_read_b128 v[136:139], v9 offset:4096
    s_waitcnt lgkmcnt(8)
    v_mfma_f32_32x32x16_bf16 v[60:75], v[144:147], v[140:143], v[60:75]
    ds_read_b128 v[140:143], v12 offset:8192
    ds_read_b128 v[144:147], v9 offset:8192
    s_waitcnt lgkmcnt(8)
    v_mfma_f32_32x32x16_bf16 v[60:75], v[152:155], v[148:151], v[60:75]
    ds_read_b128 v[148:151], v12 offset:12288
    ds_read_b128 v[152:155], v9 offset:12288
    s_waitcnt lgkmcnt(8)
    v_mfma_f32_32x32x16_bf16 v[60:75], v[160:163], v[156:159], v[60:75]
    s_barrier
    ds_read_b128 v[156:159], v12 offset:16384
    ds_read_b128 v[160:163], v9 offset:16384
    s_waitcnt lgkmcnt(8)
    v_mfma_f32_32x32x16_bf16 v[60:75], v[128:131], v[124:127], v[60:75]
    ds_read_b128 v[124:127], v12 offset:20480
    ds_read_b128 v[128:131], v9 offset:20480
    s_waitcnt lgkmcnt(8)
    v_mfma_f32_32x32x16_bf16 v[60:75], v[136:139], v[132:135], v[60:75]
    ds_read_b128 v[132:135], v12 offset:24576
    ds_read_b128 v[136:139], v9 offset:24576
    s_waitcnt lgkmcnt(8)
    v_mfma_f32_32x32x16_bf16 v[60:75], v[144:147], v[140:143], v[60:75]
    ds_read_b128 v[140:143], v12 offset:28672
    ds_read_b128 v[144:147], v9 offset:28672
    s_waitcnt lgkmcnt(8)
    v_mfma_f32_32x32x16_bf16 v[60:75], v[152:155], v[148:151], v[60:75]
    s_barrier
    ds_read_b128 v[148:151], v12 offset:32768
    ds_read_b128 v[152:155], v9 offset:32768
    s_waitcnt lgkmcnt(8)
    v_mfma_f32_32x32x16_bf16 v[60:75], v[160:163], v[156:159], v[60:75]
    ds_read_b128 v[156:159], v12 offset:36864
    ds_read_b128 v[160:163], v9 offset:36864
    s_waitcnt lgkmcnt(8)
    v_mfma_f32_32x32x16_bf16 v[60:75], v[128:131], v[124:127], v[60:75]
    ds_read_b128 v[124:127], v12 offset:40960
    ds_read_b128 v[128:131], v9 offset:40960
    s_waitcnt lgkmcnt(8)
    v_mfma_f32_32x32x16_bf16 v[60:75], v[136:139], v[132:135], v[60:75]
    ds_read_b128 v[132:135], v12 offset:45056
    ds_read_b128 v[136:139], v9 offset:45056
    s_waitcnt lgkmcnt(8)
    v_mfma_f32_32x32x16_bf16 v[60:75], v[144:147], v[140:143], v[60:75]
    s_barrier
    ds_read_b128 v[140:143], v12 offset:49152
    ds_read_b128 v[144:147], v9 offset:49152
    s_waitcnt lgkmcnt(8)
    v_mfma_f32_32x32x16_bf16 v[60:75], v[152:155], v[148:151], v[60:75]
    ds_read_b128 v[148:151], v12 offset:53248
    ds_read_b128 v[152:155], v9 offset:53248
    s_waitcnt lgkmcnt(8)
    v_mfma_f32_32x32x16_bf16 v[60:75], v[160:163], v[156:159], v[60:75]
    ds_read_b128 v[156:159], v12 offset:57344
    ds_read_b128 v[160:163], v9 offset:57344
    s_waitcnt lgkmcnt(8)
    v_mfma_f32_32x32x16_bf16 v[60:75], v[128:131], v[124:127], v[60:75]
    ds_read_b128 v[124:127], v12 offset:61440
    ds_read_b128 v[128:131], v9 offset:61440
    s_waitcnt lgkmcnt(8)
    v_mfma_f32_32x32x16_bf16 v[60:75], v[136:139], v[132:135], v[60:75]
    s_barrier
    ds_read_b128 v[132:135], v11 offset:0
    ds_read_b128 v[136:139], v8 offset:0
    s_waitcnt lgkmcnt(8)
    v_mfma_f32_32x32x16_bf16 v[60:75], v[144:147], v[140:143], v[60:75]
    ds_read_b128 v[140:143], v11 offset:4096
    ds_read_b128 v[144:147], v8 offset:4096
    s_waitcnt lgkmcnt(8)
    v_mfma_f32_32x32x16_bf16 v[60:75], v[152:155], v[148:151], v[60:75]
    ds_read_b128 v[148:151], v11 offset:8192
    ds_read_b128 v[152:155], v8 offset:8192
    s_waitcnt lgkmcnt(8)
    v_mfma_f32_32x32x16_bf16 v[60:75], v[160:163], v[156:159], v[60:75]
    ds_read_b128 v[156:159], v11 offset:12288
    ds_read_b128 v[160:163], v8 offset:12288
    s_waitcnt lgkmcnt(8)
    v_mfma_f32_32x32x16_bf16 v[60:75], v[128:131], v[124:127], v[60:75]
    s_barrier
    ds_read_b128 v[124:127], v11 offset:16384
    ds_read_b128 v[128:131], v8 offset:16384
    s_waitcnt lgkmcnt(8)
    v_mfma_f32_32x32x16_bf16 v[60:75], v[136:139], v[132:135], v[60:75]
    ds_read_b128 v[132:135], v11 offset:20480
    ds_read_b128 v[136:139], v8 offset:20480
    s_waitcnt lgkmcnt(8)
    v_mfma_f32_32x32x16_bf16 v[60:75], v[144:147], v[140:143], v[60:75]
    ds_read_b128 v[140:143], v11 offset:24576
    ds_read_b128 v[144:147], v8 offset:24576
    s_waitcnt lgkmcnt(8)
    v_mfma_f32_32x32x16_bf16 v[60:75], v[152:155], v[148:151], v[60:75]
    ds_read_b128 v[148:151], v11 offset:28672
    ds_read_b128 v[152:155], v8 offset:28672
    s_waitcnt lgkmcnt(8)
    v_mfma_f32_32x32x16_bf16 v[60:75], v[160:163], v[156:159], v[60:75]
    s_barrier
    ds_read_b128 v[156:159], v11 offset:32768
    ds_read_b128 v[160:163], v8 offset:32768
    s_waitcnt lgkmcnt(8)
    v_mfma_f32_32x32x16_bf16 v[60:75], v[128:131], v[124:127], v[60:75]
    ds_read_b128 v[124:127], v11 offset:36864
    ds_read_b128 v[128:131], v8 offset:36864
    s_waitcnt lgkmcnt(8)
    v_mfma_f32_32x32x16_bf16 v[60:75], v[136:139], v[132:135], v[60:75]
    ds_read_b128 v[132:135], v11 offset:40960
    ds_read_b128 v[136:139], v8 offset:40960
    s_waitcnt lgkmcnt(8)
    v_mfma_f32_32x32x16_bf16 v[60:75], v[144:147], v[140:143], v[60:75]
    ds_read_b128 v[140:143], v11 offset:45056
    ds_read_b128 v[144:147], v8 offset:45056
    s_waitcnt lgkmcnt(8)
    v_mfma_f32_32x32x16_bf16 v[60:75], v[152:155], v[148:151], v[60:75]
    s_barrier
    ds_read_b128 v[148:151], v11 offset:49152
    ds_read_b128 v[152:155], v8 offset:49152
    s_waitcnt lgkmcnt(8)
    v_mfma_f32_32x32x16_bf16 v[60:75], v[160:163], v[156:159], v[60:75]
    ds_read_b128 v[156:159], v11 offset:53248
    ds_read_b128 v[160:163], v8 offset:53248
    s_waitcnt lgkmcnt(8)
    v_mfma_f32_32x32x16_bf16 v[60:75], v[128:131], v[124:127], v[60:75]
    ds_read_b128 v[124:127], v11 offset:57344
    ds_read_b128 v[128:131], v8 offset:57344
    s_waitcnt lgkmcnt(8)
    v_mfma_f32_32x32x16_bf16 v[60:75], v[136:139], v[132:135], v[60:75]
    ds_read_b128 v[132:135], v11 offset:61440
    ds_read_b128 v[136:139], v8 offset:61440
    s_waitcnt lgkmcnt(8)
    v_mfma_f32_32x32x16_bf16 v[60:75], v[144:147], v[140:143], v[60:75]
    s_waitcnt lgkmcnt(6)
    v_mfma_f32_32x32x16_bf16 v[60:75], v[152:155], v[148:151], v[60:75]
    s_waitcnt lgkmcnt(4)
    v_mfma_f32_32x32x16_bf16 v[60:75], v[160:163], v[156:159], v[60:75]
    s_waitcnt lgkmcnt(2)
    v_mfma_f32_32x32x16_bf16 v[60:75], v[128:131], v[124:127], v[60:75]
    s_waitcnt lgkmcnt(0)
    v_mfma_f32_32x32x16_bf16 v[60:75], v[136:139], v[132:135], v[60:75]
    s_barrier
    s_nop 15
    v_pk_add_f32 v[44:45], v[44:45], v[60:61]
    v_pk_add_f32 v[46:47], v[46:47], v[62:63]
    v_pk_add_f32 v[48:49], v[48:49], v[64:65]
    v_pk_add_f32 v[50:51], v[50:51], v[66:67]
    v_pk_add_f32 v[52:53], v[52:53], v[68:69]
    v_pk_add_f32 v[54:55], v[54:55], v[70:71]
    v_pk_add_f32 v[56:57], v[56:57], v[72:73]
    v_pk_add_f32 v[58:59], v[58:59], v[74:75]
    v_pk_add_f32 v[28:29], v[28:29], v[44:45]
    v_pk_add_f32 v[30:31], v[30:31], v[46:47]
    v_pk_add_f32 v[32:33], v[32:33], v[48:49]
    v_pk_add_f32 v[34:35], v[34:35], v[50:51]
    v_pk_add_f32 v[36:37], v[36:37], v[52:53]
    v_pk_add_f32 v[38:39], v[38:39], v[54:55]
    v_pk_add_f32 v[40:41], v[40:41], v[56:57]
    v_pk_add_f32 v[42:43], v[42:43], v[58:59]
    s_mul_i32 s32, s28, 32768
    s_lshl_b32 s33, s45, 10
    s_add_u32 s32, s32, s33
    s_add_u32 s32, s32, 2097152
    v_cvt_pk_bf16_f32 v236, v28, v29
    v_cvt_pk_bf16_f32 v237, v30, v31
    v_cvt_pk_bf16_f32 v238, v32, v33
    v_cvt_pk_bf16_f32 v239, v34, v35
    v_cvt_pk_bf16_f32 v240, v36, v37
    v_cvt_pk_bf16_f32 v241, v38, v39
    v_cvt_pk_bf16_f32 v242, v40, v41
    v_cvt_pk_bf16_f32 v243, v42, v43
    s_cmp_eq_u32 s29, 1
    s_cbranch_scc1 L_chain0_kernel_sf69
    buffer_store_dwordx4 v[236:239], v14, s[12:15], s32 offen offset:0 sc1
    buffer_store_dwordx4 v[240:243], v14, s[12:15], s32 offen offset:1024 sc1
    s_branch L_chain0_kernel_sd70
L_chain0_kernel_sf69:
    buffer_store_dwordx4 v[236:239], v14, s[12:15], s32 offen offset:0
    buffer_store_dwordx4 v[240:243], v14, s[12:15], s32 offen offset:1024
L_chain0_kernel_sd70:
    v_pk_add_f32 v[2:3], v[28:29], v[30:31]
    v_pk_mul_f32 v[4:5], v[28:29], v[28:29]
    v_pk_fma_f32 v[4:5], v[30:31], v[30:31], v[4:5]
    v_pk_add_f32 v[2:3], v[2:3], v[32:33]
    v_pk_fma_f32 v[4:5], v[32:33], v[32:33], v[4:5]
    v_pk_add_f32 v[2:3], v[2:3], v[34:35]
    v_pk_fma_f32 v[4:5], v[34:35], v[34:35], v[4:5]
    v_pk_add_f32 v[2:3], v[2:3], v[36:37]
    v_pk_fma_f32 v[4:5], v[36:37], v[36:37], v[4:5]
    v_pk_add_f32 v[2:3], v[2:3], v[38:39]
    v_pk_fma_f32 v[4:5], v[38:39], v[38:39], v[4:5]
    v_pk_add_f32 v[2:3], v[2:3], v[40:41]
    v_pk_fma_f32 v[4:5], v[40:41], v[40:41], v[4:5]
    v_pk_add_f32 v[2:3], v[2:3], v[42:43]
    v_pk_fma_f32 v[4:5], v[42:43], v[42:43], v[4:5]
    v_add_f32 v2, v2, v3
    v_add_f32 v3, v4, v5
    s_nop 1
    v_permlane32_swap_b32 v2, v3
    s_nop 1
    v_add_f32 v2, v2, v3
    s_lshl_b32 s34, s28, 12
    s_lshl_b32 s35, s44, 8
    s_add_u32 s34, s34, s35
    s_add_u32 s34, s34, 20709376
    v_lshlrev_b32 v4, 2, v0
    s_cmp_eq_u32 s29, 1
    s_cbranch_scc1 L_chain0_kernel_sf71
    buffer_store_dword v2, v4, s[12:15], s34 offen sc1
    s_branch L_chain0_kernel_sd72
L_chain0_kernel_sf71:
    buffer_store_dword v2, v4, s[12:15], s34 offen
L_chain0_kernel_sd72:
    s_waitcnt vmcnt(0)
    s_barrier
    s_cmp_lg_u32 s22, 0
    s_cbranch_scc1 L_chain0_kernel_ya73
    s_mov_b64 s[40:41], exec
    s_cmp_eq_u32 s29, 1
    s_cbranch_scc0 L_chain0_kernel_yb74
    s_mov_b32 s30, 1
    s_atomic_add s30, s[48:49], 0xe000
    s_branch L_chain0_kernel_yc75
L_chain0_kernel_yb74:
    s_add_u32 s30, s50, 57344
    s_mov_b64 exec, 1
    v_mov_b32 v2, s30
    v_mov_b32 v3, 1
    buffer_atomic_add v3, v2, s[12:15], 0 offen sc1
L_chain0_kernel_yc75:
    s_mov_b64 exec, s[40:41]
L_chain0_kernel_ya73:
    s_cmp_lg_u32 s22, 0
    s_cbranch_scc1 L_chain0_kernel_yk76
    s_mov_b64 s[40:41], exec
    s_cmp_eq_u32 s29, 1
    s_cbranch_scc0 L_chain0_kernel_ys77
    s_mov_b32 s47, 0
L_chain0_kernel_yl79:
    s_mov_b32 s31, 0
    s_atomic_add s31, s[48:49], 0xe000 glc
    s_add_u32 s47, s47, 1
    s_cmp_gt_u32 s47, 262144
    s_cbranch_scc1 L_chain0_kernel_ye80
    s_waitcnt lgkmcnt(0)
    s_cmp_ge_u32 s31, 8
    s_cbranch_scc0 L_chain0_kernel_yl79
L_chain0_kernel_ye80:
    s_waitcnt lgkmcnt(0)
    s_branch L_chain0_kernel_yd78
L_chain0_kernel_ys77:
    s_add_u32 s30, s50, 57344
    s_mov_b64 exec, 1
    v_mov_b32 v2, s30
    v_mov_b32 v3, 8
    s_mov_b32 s47, 0
L_chain0_kernel_pl81:
    buffer_load_dword v4, v2, s[12:15], 0 offen sc1
    s_add_u32 s47, s47, 1
    s_cmp_gt_u32 s47, 262144
    s_cbranch_scc1 L_chain0_kernel_pd82
    s_waitcnt vmcnt(0)
    v_cmp_ge_u32 vcc, v4, v3
    s_nop 1
    s_cmp_eq_u32 vcc_lo, 1
    s_cbranch_scc0 L_chain0_kernel_pl81
L_chain0_kernel_pd82:
    s_waitcnt vmcnt(0)
L_chain0_kernel_yd78:
    s_mov_b64 exec, s[40:41]
L_chain0_kernel_yk76:
    s_barrier
    s_mul_i32 s30, s24, 1024
    s_add_u32 s30, s30, 2048
    v_lshlrev_b32 v11, 4, v0
    v_add_u32 v8, s30, v11
    s_lshl_b32 s30, s23, 10
    v_add_u32 v11, s30, v11
    v_add_u32 v9, 65536, v8
    v_add_u32 v12, 65536, v11
    s_barrier
    ds_read_b128 v[124:127], v11 offset:0
    ds_read_b128 v[128:131], v8 offset:0
    ds_read_b128 v[132:135], v8 offset:2048
    ds_read_b128 v[136:139], v8 offset:4096
    ds_read_b128 v[140:143], v11 offset:8192
    ds_read_b128 v[144:147], v8 offset:8192
    ds_read_b128 v[148:151], v8 offset:10240
    ds_read_b128 v[152:155], v8 offset:12288
    ds_read_b128 v[156:159], v11 offset:16384
    ds_read_b128 v[160:163], v8 offset:16384
    ds_read_b128 v[164:167], v8 offset:18432
    ds_read_b128 v[168:171], v8 offset:20480
    s_waitcnt lgkmcnt(0)
    s_lshl_b32 s30, s23, 12
    s_add_u32 s30, s30, 149504
    v_lshlrev_b32 v2, 2, v0
    v_add_u32 v2, s30, v2
    ds_read2st64_b32 v[188:189], v2 offset0:0 offset1:1
    ds_read2st64_b32 v[190:191], v2 offset0:2 offset1:3
    ds_read2st64_b32 v[192:193], v2 offset0:4 offset1:5
    ds_read2st64_b32 v[194:195], v2 offset0:6 offset1:7
    ds_read2st64_b32 v[196:197], v2 offset0:8 offset1:9
    ds_read2st64_b32 v[198:199], v2 offset0:10 offset1:11
    ds_read2st64_b32 v[200:201], v2 offset0:12 offset1:13
    ds_read2st64_b32 v[202:203], v2 offset0:14 offset1:15
    s_lshl_b32 s33, s24, 7
    s_add_u32 s33, s33, 148480
    v_lshrrev_b32 v3, 5, v0
    v_lshlrev_b32 v3, 4, v3
    v_add_u32 v15, s33, v3
    v_and_b32 v4, 31, v0
    v_lshlrev_b32 v4, 2, v4
    v_add_u32 v4, s33, v4
    s_waitcnt lgkmcnt(0)
    ds_read_b128 v[204:207], v15 offset:0
    ds_read_b128 v[208:211], v15 offset:32
    ds_read_b128 v[212:215], v15 offset:64
    ds_read_b128 v[216:219], v15 offset:96
    ds_read_b128 v[220:223], v15 offset:256
    ds_read_b128 v[224:227], v15 offset:288
    ds_read_b128 v[228:231], v15 offset:320
    ds_read_b128 v[232:235], v15 offset:352
    ds_read_b32 v244, v4 offset:512
    s_waitcnt lgkmcnt(0)
    s_barrier
    ds_read_b128 v[172:175], v11 offset:24576
    ds_read_b128 v[176:179], v8 offset:24576
    ds_read_b128 v[180:183], v8 offset:26624
    ds_read_b128 v[184:187], v8 offset:28672
    v_mfma_f32_32x32x16_bf16 v[60:75], v[128:131], v[124:127], 0
    v_mfma_f32_32x32x16_bf16 v[76:91], v[132:135], v[124:127], 0
    v_mfma_f32_32x32x16_bf16 v[92:107], v[124:127], v[136:139], 0
    ds_read_b128 v[124:127], v11 offset:32768
    ds_read_b128 v[128:131], v8 offset:32768
    ds_read_b128 v[132:135], v8 offset:34816
    ds_read_b128 v[136:139], v8 offset:36864
    v_mfma_f32_32x32x16_bf16 v[60:75], v[144:147], v[140:143], v[60:75]
    v_mfma_f32_32x32x16_bf16 v[76:91], v[148:151], v[140:143], v[76:91]
    v_mfma_f32_32x32x16_bf16 v[92:107], v[140:143], v[152:155], v[92:107]
    ds_read_b128 v[140:143], v11 offset:40960
    ds_read_b128 v[144:147], v8 offset:40960
    ds_read_b128 v[148:151], v8 offset:43008
    ds_read_b128 v[152:155], v8 offset:45056
    v_mfma_f32_32x32x16_bf16 v[60:75], v[160:163], v[156:159], v[60:75]
    v_mfma_f32_32x32x16_bf16 v[76:91], v[164:167], v[156:159], v[76:91]
    v_mfma_f32_32x32x16_bf16 v[92:107], v[156:159], v[168:171], v[92:107]
    ds_read_b128 v[156:159], v11 offset:49152
    ds_read_b128 v[160:163], v8 offset:49152
    ds_read_b128 v[164:167], v8 offset:51200
    ds_read_b128 v[168:171], v8 offset:53248
    s_waitcnt lgkmcnt(12)
    v_mfma_f32_32x32x16_bf16 v[60:75], v[176:179], v[172:175], v[60:75]
    v_mfma_f32_32x32x16_bf16 v[76:91], v[180:183], v[172:175], v[76:91]
    v_mfma_f32_32x32x16_bf16 v[92:107], v[172:175], v[184:187], v[92:107]
    s_barrier
    ds_read_b128 v[172:175], v11 offset:57344
    ds_read_b128 v[176:179], v8 offset:57344
    ds_read_b128 v[180:183], v8 offset:59392
    ds_read_b128 v[184:187], v8 offset:61440
    s_waitcnt lgkmcnt(12)
    v_mfma_f32_32x32x16_bf16 v[60:75], v[128:131], v[124:127], v[60:75]
    v_mfma_f32_32x32x16_bf16 v[76:91], v[132:135], v[124:127], v[76:91]
    v_mfma_f32_32x32x16_bf16 v[92:107], v[124:127], v[136:139], v[92:107]
    ds_read_b128 v[124:127], v12 offset:0
    ds_read_b128 v[128:131], v9 offset:0
    ds_read_b128 v[132:135], v9 offset:2048
    ds_read_b128 v[136:139], v9 offset:4096
    s_waitcnt lgkmcnt(12)
    v_mfma_f32_32x32x16_bf16 v[60:75], v[144:147], v[140:143], v[60:75]
    v_mfma_f32_32x32x16_bf16 v[76:91], v[148:151], v[140:143], v[76:91]
    v_mfma_f32_32x32x16_bf16 v[92:107], v[140:143], v[152:155], v[92:107]
    ds_read_b128 v[140:143], v12 offset:8192
    ds_read_b128 v[144:147], v9 offset:8192
    ds_read_b128 v[148:151], v9 offset:10240
    ds_read_b128 v[152:155], v9 offset:12288
    s_waitcnt lgkmcnt(12)
    v_mfma_f32_32x32x16_bf16 v[60:75], v[160:163], v[156:159], v[60:75]
    v_mfma_f32_32x32x16_bf16 v[76:91], v[164:167], v[156:159], v[76:91]
    v_mfma_f32_32x32x16_bf16 v[92:107], v[156:159], v[168:171], v[92:107]
    ds_read_b128 v[156:159], v12 offset:16384
    ds_read_b128 v[160:163], v9 offset:16384
    ds_read_b128 v[164:167], v9 offset:18432
    ds_read_b128 v[168:171], v9 offset:20480
    s_waitcnt lgkmcnt(12)
    v_mfma_f32_32x32x16_bf16 v[60:75], v[176:179], v[172:175], v[60:75]
    v_mfma_f32_32x32x16_bf16 v[76:91], v[180:183], v[172:175], v[76:91]
    v_mfma_f32_32x32x16_bf16 v[92:107], v[172:175], v[184:187], v[92:107]
    s_barrier
    ds_read_b128 v[172:175], v12 offset:24576
    ds_read_b128 v[176:179], v9 offset:24576
    ds_read_b128 v[180:183], v9 offset:26624
    ds_read_b128 v[184:187], v9 offset:28672
    s_waitcnt lgkmcnt(12)
    v_mfma_f32_32x32x16_bf16 v[60:75], v[128:131], v[124:127], v[60:75]
    v_mfma_f32_32x32x16_bf16 v[76:91], v[132:135], v[124:127], v[76:91]
    v_mfma_f32_32x32x16_bf16 v[92:107], v[124:127], v[136:139], v[92:107]
    ds_read_b128 v[124:127], v12 offset:32768
    ds_read_b128 v[128:131], v9 offset:32768
    ds_read_b128 v[132:135], v9 offset:34816
    ds_read_b128 v[136:139], v9 offset:36864
    s_waitcnt lgkmcnt(12)
    v_mfma_f32_32x32x16_bf16 v[60:75], v[144:147], v[140:143], v[60:75]
    v_mfma_f32_32x32x16_bf16 v[76:91], v[148:151], v[140:143], v[76:91]
    v_mfma_f32_32x32x16_bf16 v[92:107], v[140:143], v[152:155], v[92:107]
    ds_read_b128 v[140:143], v12 offset:40960
    ds_read_b128 v[144:147], v9 offset:40960
    ds_read_b128 v[148:151], v9 offset:43008
    ds_read_b128 v[152:155], v9 offset:45056
    s_waitcnt lgkmcnt(12)
    v_mfma_f32_32x32x16_bf16 v[60:75], v[160:163], v[156:159], v[60:75]
    v_mfma_f32_32x32x16_bf16 v[76:91], v[164:167], v[156:159], v[76:91]
    v_mfma_f32_32x32x16_bf16 v[92:107], v[156:159], v[168:171], v[92:107]
    ds_read_b128 v[156:159], v12 offset:49152
    ds_read_b128 v[160:163], v9 offset:49152
    ds_read_b128 v[164:167], v9 offset:51200
    ds_read_b128 v[168:171], v9 offset:53248
    s_waitcnt lgkmcnt(12)
    v_mfma_f32_32x32x16_bf16 v[60:75], v[176:179], v[172:175], v[60:75]
    v_mfma_f32_32x32x16_bf16 v[76:91], v[180:183], v[172:175], v[76:91]
    v_mfma_f32_32x32x16_bf16 v[92:107], v[172:175], v[184:187], v[92:107]
    s_barrier
    ds_read_b128 v[172:175], v12 offset:57344
    ds_read_b128 v[176:179], v9 offset:57344
    ds_read_b128 v[180:183], v9 offset:59392
    ds_read_b128 v[184:187], v9 offset:61440
    s_waitcnt lgkmcnt(12)
    v_mfma_f32_32x32x16_bf16 v[60:75], v[128:131], v[124:127], v[60:75]
    v_mfma_f32_32x32x16_bf16 v[76:91], v[132:135], v[124:127], v[76:91]
    v_mfma_f32_32x32x16_bf16 v[92:107], v[124:127], v[136:139], v[92:107]
    ds_read_b128 v[124:127], v11 offset:0
    ds_read_b128 v[128:131], v8 offset:0
    ds_read_b128 v[132:135], v8 offset:2048
    ds_read_b128 v[136:139], v8 offset:4096
    s_waitcnt lgkmcnt(12)
    v_mfma_f32_32x32x16_bf16 v[60:75], v[144:147], v[140:143], v[60:75]
    v_mfma_f32_32x32x16_bf16 v[76:91], v[148:151], v[140:143], v[76:91]
    v_mfma_f32_32x32x16_bf16 v[92:107], v[140:143], v[152:155], v[92:107]
    ds_read_b128 v[140:143], v11 offset:8192
    ds_read_b128 v[144:147], v8 offset:8192
    ds_read_b128 v[148:151], v8 offset:10240
    ds_read_b128 v[152:155], v8 offset:12288
    s_waitcnt lgkmcnt(12)
    v_mfma_f32_32x32x16_bf16 v[60:75], v[160:163], v[156:159], v[60:75]
    v_mfma_f32_32x32x16_bf16 v[76:91], v[164:167], v[156:159], v[76:91]
    v_mfma_f32_32x32x16_bf16 v[92:107], v[156:159], v[168:171], v[92:107]
    ds_read_b128 v[156:159], v11 offset:16384
    ds_read_b128 v[160:163], v8 offset:16384
    ds_read_b128 v[164:167], v8 offset:18432
    ds_read_b128 v[168:171], v8 offset:20480
    s_waitcnt lgkmcnt(12)
    v_mfma_f32_32x32x16_bf16 v[60:75], v[176:179], v[172:175], v[60:75]
    v_mfma_f32_32x32x16_bf16 v[76:91], v[180:183], v[172:175], v[76:91]
    v_mfma_f32_32x32x16_bf16 v[92:107], v[172:175], v[184:187], v[92:107]
    s_barrier
    ds_read_b128 v[172:175], v11 offset:24576
    ds_read_b128 v[176:179], v8 offset:24576
    ds_read_b128 v[180:183], v8 offset:26624
    ds_read_b128 v[184:187], v8 offset:28672
    s_waitcnt lgkmcnt(12)
    v_mfma_f32_32x32x16_bf16 v[60:75], v[128:131], v[124:127], v[60:75]
    v_mfma_f32_32x32x16_bf16 v[76:91], v[132:135], v[124:127], v[76:91]
    v_mfma_f32_32x32x16_bf16 v[92:107], v[124:127], v[136:139], v[92:107]
    ds_read_b128 v[124:127], v11 offset:32768
    ds_read_b128 v[128:131], v8 offset:32768
    ds_read_b128 v[132:135], v8 offset:34816
    ds_read_b128 v[136:139], v8 offset:36864
    s_waitcnt lgkmcnt(12)
    v_mfma_f32_32x32x16_bf16 v[60:75], v[144:147], v[140:143], v[60:75]
    v_mfma_f32_32x32x16_bf16 v[76:91], v[148:151], v[140:143], v[76:91]
    v_mfma_f32_32x32x16_bf16 v[92:107], v[140:143], v[152:155], v[92:107]
    ds_read_b128 v[140:143], v11 offset:40960
    ds_read_b128 v[144:147], v8 offset:40960
    ds_read_b128 v[148:151], v8 offset:43008
    ds_read_b128 v[152:155], v8 offset:45056
    s_waitcnt lgkmcnt(12)
    v_mfma_f32_32x32x16_bf16 v[60:75], v[160:163], v[156:159], v[60:75]
    v_mfma_f32_32x32x16_bf16 v[76:91], v[164:167], v[156:159], v[76:91]
    v_mfma_f32_32x32x16_bf16 v[92:107], v[156:159], v[168:171], v[92:107]
    ds_read_b128 v[156:159], v11 offset:49152
    ds_read_b128 v[160:163], v8 offset:49152
    ds_read_b128 v[164:167], v8 offset:51200
    ds_read_b128 v[168:171], v8 offset:53248
    s_waitcnt lgkmcnt(12)
    v_mfma_f32_32x32x16_bf16 v[60:75], v[176:179], v[172:175], v[60:75]
    v_mfma_f32_32x32x16_bf16 v[76:91], v[180:183], v[172:175], v[76:91]
    v_mfma_f32_32x32x16_bf16 v[92:107], v[172:175], v[184:187], v[92:107]
    s_barrier
    ds_read_b128 v[172:175], v11 offset:57344
    ds_read_b128 v[176:179], v8 offset:57344
    ds_read_b128 v[180:183], v8 offset:59392
    ds_read_b128 v[184:187], v8 offset:61440
    s_waitcnt lgkmcnt(12)
    v_mfma_f32_32x32x16_bf16 v[60:75], v[128:131], v[124:127], v[60:75]
    v_mfma_f32_32x32x16_bf16 v[76:91], v[132:135], v[124:127], v[76:91]
    v_mfma_f32_32x32x16_bf16 v[92:107], v[124:127], v[136:139], v[92:107]
    ds_read_b128 v[124:127], v12 offset:0
    ds_read_b128 v[128:131], v9 offset:0
    ds_read_b128 v[132:135], v9 offset:2048
    ds_read_b128 v[136:139], v9 offset:4096
    s_waitcnt lgkmcnt(12)
    v_mfma_f32_32x32x16_bf16 v[60:75], v[144:147], v[140:143], v[60:75]
    v_mfma_f32_32x32x16_bf16 v[76:91], v[148:151], v[140:143], v[76:91]
    v_mfma_f32_32x32x16_bf16 v[92:107], v[140:143], v[152:155], v[92:107]
    ds_read_b128 v[140:143], v12 offset:8192
    ds_read_b128 v[144:147], v9 offset:8192
    ds_read_b128 v[148:151], v9 offset:10240
    ds_read_b128 v[152:155], v9 offset:12288
    s_waitcnt lgkmcnt(12)
    v_mfma_f32_32x32x16_bf16 v[60:75], v[160:163], v[156:159], v[60:75]
    v_mfma_f32_32x32x16_bf16 v[76:91], v[164:167], v[156:159], v[76:91]
    v_mfma_f32_32x32x16_bf16 v[92:107], v[156:159], v[168:171], v[92:107]
    ds_read_b128 v[156:159], v12 offset:16384
    ds_read_b128 v[160:163], v9 offset:16384
    ds_read_b128 v[164:167], v9 offset:18432
    ds_read_b128 v[168:171], v9 offset:20480
    s_waitcnt lgkmcnt(12)
    v_mfma_f32_32x32x16_bf16 v[60:75], v[176:179], v[172:175], v[60:75]
    v_mfma_f32_32x32x16_bf16 v[76:91], v[180:183], v[172:175], v[76:91]
    v_mfma_f32_32x32x16_bf16 v[92:107], v[172:175], v[184:187], v[92:107]
    s_barrier
    ds_read_b128 v[172:175], v12 offset:24576
    ds_read_b128 v[176:179], v9 offset:24576
    ds_read_b128 v[180:183], v9 offset:26624
    ds_read_b128 v[184:187], v9 offset:28672
    s_waitcnt lgkmcnt(12)
    v_mfma_f32_32x32x16_bf16 v[60:75], v[128:131], v[124:127], v[60:75]
    v_mfma_f32_32x32x16_bf16 v[76:91], v[132:135], v[124:127], v[76:91]
    v_mfma_f32_32x32x16_bf16 v[92:107], v[124:127], v[136:139], v[92:107]
    ds_read_b128 v[124:127], v12 offset:32768
    ds_read_b128 v[128:131], v9 offset:32768
    ds_read_b128 v[132:135], v9 offset:34816
    ds_read_b128 v[136:139], v9 offset:36864
    s_waitcnt lgkmcnt(12)
    v_mfma_f32_32x32x16_bf16 v[60:75], v[144:147], v[140:143], v[60:75]
    v_mfma_f32_32x32x16_bf16 v[76:91], v[148:151], v[140:143], v[76:91]
    v_mfma_f32_32x32x16_bf16 v[92:107], v[140:143], v[152:155], v[92:107]
    ds_read_b128 v[140:143], v12 offset:40960
    ds_read_b128 v[144:147], v9 offset:40960
    ds_read_b128 v[148:151], v9 offset:43008
    ds_read_b128 v[152:155], v9 offset:45056
    s_waitcnt lgkmcnt(12)
    v_mfma_f32_32x32x16_bf16 v[60:75], v[160:163], v[156:159], v[60:75]
    v_mfma_f32_32x32x16_bf16 v[76:91], v[164:167], v[156:159], v[76:91]
    v_mfma_f32_32x32x16_bf16 v[92:107], v[156:159], v[168:171], v[92:107]
    ds_read_b128 v[156:159], v12 offset:49152
    ds_read_b128 v[160:163], v9 offset:49152
    ds_read_b128 v[164:167], v9 offset:51200
    ds_read_b128 v[168:171], v9 offset:53248
    s_waitcnt lgkmcnt(12)
    v_mfma_f32_32x32x16_bf16 v[60:75], v[176:179], v[172:175], v[60:75]
    v_mfma_f32_32x32x16_bf16 v[76:91], v[180:183], v[172:175], v[76:91]
    v_mfma_f32_32x32x16_bf16 v[92:107], v[172:175], v[184:187], v[92:107]
    ds_read_b128 v[172:175], v12 offset:57344
    ds_read_b128 v[176:179], v9 offset:57344
    ds_read_b128 v[180:183], v9 offset:59392
    ds_read_b128 v[184:187], v9 offset:61440
    s_waitcnt lgkmcnt(12)
    v_mfma_f32_32x32x16_bf16 v[60:75], v[128:131], v[124:127], v[60:75]
    v_mfma_f32_32x32x16_bf16 v[76:91], v[132:135], v[124:127], v[76:91]
    v_mfma_f32_32x32x16_bf16 v[92:107], v[124:127], v[136:139], v[92:107]
    s_waitcnt lgkmcnt(8)
    v_mfma_f32_32x32x16_bf16 v[60:75], v[144:147], v[140:143], v[60:75]
    v_mfma_f32_32x32x16_bf16 v[76:91], v[148:151], v[140:143], v[76:91]
    v_mfma_f32_32x32x16_bf16 v[92:107], v[140:143], v[152:155], v[92:107]
    s_waitcnt lgkmcnt(4)
    v_mfma_f32_32x32x16_bf16 v[60:75], v[160:163], v[156:159], v[60:75]
    v_mfma_f32_32x32x16_bf16 v[76:91], v[164:167], v[156:159], v[76:91]
    v_mfma_f32_32x32x16_bf16 v[92:107], v[156:159], v[168:171], v[92:107]
    s_waitcnt lgkmcnt(0)
    v_mfma_f32_32x32x16_bf16 v[60:75], v[176:179], v[172:175], v[60:75]
    v_mfma_f32_32x32x16_bf16 v[76:91], v[180:183], v[172:175], v[76:91]
    v_mfma_f32_32x32x16_bf16 v[92:107], v[172:175], v[184:187], v[92:107]
    v_add_f32 v188, v188, v196
    v_add_f32 v189, v189, v197
    v_add_f32 v190, v190, v198
    v_add_f32 v191, v191, v199
    v_add_f32 v192, v192, v200
    v_add_f32 v193, v193, v201
    v_add_f32 v194, v194, v202
    v_add_f32 v195, v195, v203
    v_add_f32 v188, v188, v192
    v_add_f32 v189, v189, v193
    v_add_f32 v190, v190, v194
    v_add_f32 v191, v191, v195
    v_add_f32 v188, v188, v190
    v_add_f32 v189, v189, v191
    v_add_f32 v188, v188, v189
    v_mov_b32 v189, v188
    s_nop 1
    v_permlane32_swap_b32 v188, v189
    s_nop 1
    v_mul_f32 v24, 0x3b000000, v188
    v_mul_f32 v25, 0x3b000000, v189
    v_fma_f32 v25, -v24, v24, v25
    v_max_f32 v25, 0, v25
    v_add_f32 v18, 0x3727c5ac, v25
    v_rsq_f32 v18, v18
    s_nop 0
    v_mul_f32_e64 v19, -v24, v18
    v_mul_f32 v20, 0x3eb8aa3b, v18
    v_mul_f32 v21, 0x3eb8aa3b, v19
    s_lshl_b32 s30, s22, 8
    s_add_u32 s30, s30, 147456
    v_and_b32 v2, 31, v0
    v_lshlrev_b32 v2, 2, v2
    v_add_u32 v2, s30, v2
    ds_write_b32 v2, v18
    ds_write_b32 v2, v19 offset:128
    v_lshrrev_b32 v3, 5, v0
    v_lshlrev_b32 v3, 4, v3
    v_add_u32 v3, s30, v3
    s_waitcnt lgkmcnt(0)
    ds_read_b128 v[140:143], v3 offset:0
    ds_read_b128 v[156:159], v3 offset:128
    ds_read_b128 v[144:147], v3 offset:32
    ds_read_b128 v[160:163], v3 offset:160
    ds_read_b128 v[148:151], v3 offset:64
    ds_read_b128 v[164:167], v3 offset:192
    ds_read_b128 v[152:155], v3 offset:96
    ds_read_b128 v[168:171], v3 offset:224
    s_lshl_b32 s30, s44, 17
    s_lshl_b32 s31, s28, 10
    s_add_u32 s32, s30, s31
    v_lshlrev_b32 v14, 4, v0
    v_pk_mul_f32 v[204:205], v[204:205], v[20:21] op_sel:[0,1] op_sel_hi:[1,1]
    v_pk_mul_f32 v[206:207], v[206:207], v[20:21] op_sel:[0,1] op_sel_hi:[1,1]
    v_pk_mul_f32 v[208:209], v[208:209], v[20:21] op_sel:[0,1] op_sel_hi:[1,1]
    v_pk_mul_f32 v[210:211], v[210:211], v[20:21] op_sel:[0,1] op_sel_hi:[1,1]
    v_pk_mul_f32 v[212:213], v[212:213], v[20:21] op_sel:[0,1] op_sel_hi:[1,1]
    v_pk_mul_f32 v[214:215], v[214:215], v[20:21] op_sel:[0,1] op_sel_hi:[1,1]
    v_pk_mul_f32 v[216:217], v[216:217], v[20:21] op_sel:[0,1] op_sel_hi:[1,1]
    v_pk_mul_f32 v[218:219], v[218:219], v[20:21] op_sel:[0,1] op_sel_hi:[1,1]
    v_pk_fma_f32 v[60:61], v[60:61], v[20:21], v[204:205] op_sel:[0,0,0] op_sel_hi:[1,0,1]
    v_pk_fma_f32 v[62:63], v[62:63], v[20:21], v[206:207] op_sel:[0,0,0] op_sel_hi:[1,0,1]
    v_pk_fma_f32 v[64:65], v[64:65], v[20:21], v[208:209] op_sel:[0,0,0] op_sel_hi:[1,0,1]
    v_pk_fma_f32 v[66:67], v[66:67], v[20:21], v[210:211] op_sel:[0,0,0] op_sel_hi:[1,0,1]
    v_pk_fma_f32 v[68:69], v[68:69], v[20:21], v[212:213] op_sel:[0,0,0] op_sel_hi:[1,0,1]
    v_pk_fma_f32 v[70:71], v[70:71], v[20:21], v[214:215] op_sel:[0,0,0] op_sel_hi:[1,0,1]
    v_pk_fma_f32 v[72:73], v[72:73], v[20:21], v[216:217] op_sel:[0,0,0] op_sel_hi:[1,0,1]
    v_pk_fma_f32 v[74:75], v[74:75], v[20:21], v[218:219] op_sel:[0,0,0] op_sel_hi:[1,0,1]
    v_cvt_pk_bf16_f32 v236, v60, v61
    v_cvt_pk_bf16_f32 v237, v62, v63
    v_cvt_pk_bf16_f32 v238, v64, v65
    v_cvt_pk_bf16_f32 v239, v66, v67
    v_cvt_pk_bf16_f32 v240, v68, v69
    v_cvt_pk_bf16_f32 v241, v70, v71
    v_cvt_pk_bf16_f32 v242, v72, v73
    v_cvt_pk_bf16_f32 v243, v74, v75
    s_add_u32 s34, s32, 6291456
    s_add_u32 s35, s32, 6356992
    buffer_store_dwordx4 v[236:239], v14, s[12:15], s34 offen sc1
    buffer_store_dwordx4 v[240:243], v14, s[12:15], s35 offen sc1
    s_nop 1
    v_pk_mul_f32 v[220:221], v[220:221], v[18:19] op_sel:[0,1] op_sel_hi:[1,1]
    v_pk_mul_f32 v[222:223], v[222:223], v[18:19] op_sel:[0,1] op_sel_hi:[1,1]
    v_pk_mul_f32 v[224:225], v[224:225], v[18:19] op_sel:[0,1] op_sel_hi:[1,1]
    v_pk_mul_f32 v[226:227], v[226:227], v[18:19] op_sel:[0,1] op_sel_hi:[1,1]
    v_pk_mul_f32 v[228:229], v[228:229], v[18:19] op_sel:[0,1] op_sel_hi:[1,1]
    v_pk_mul_f32 v[230:231], v[230:231], v[18:19] op_sel:[0,1] op_sel_hi:[1,1]
    v_pk_mul_f32 v[232:233], v[232:233], v[18:19] op_sel:[0,1] op_sel_hi:[1,1]
    v_pk_mul_f32 v[234:235], v[234:235], v[18:19] op_sel:[0,1] op_sel_hi:[1,1]
    v_pk_fma_f32 v[76:77], v[76:77], v[18:19], v[220:221] op_sel:[0,0,0] op_sel_hi:[1,0,1]
    v_pk_fma_f32 v[78:79], v[78:79], v[18:19], v[222:223] op_sel:[0,0,0] op_sel_hi:[1,0,1]
    v_pk_fma_f32 v[80:81], v[80:81], v[18:19], v[224:225] op_sel:[0,0,0] op_sel_hi:[1,0,1]
    v_pk_fma_f32 v[82:83], v[82:83], v[18:19], v[226:227] op_sel:[0,0,0] op_sel_hi:[1,0,1]
    v_pk_fma_f32 v[84:85], v[84:85], v[18:19], v[228:229] op_sel:[0,0,0] op_sel_hi:[1,0,1]
    v_pk_fma_f32 v[86:87], v[86:87], v[18:19], v[230:231] op_sel:[0,0,0] op_sel_hi:[1,0,1]
    v_pk_fma_f32 v[88:89], v[88:89], v[18:19], v[232:233] op_sel:[0,0,0] op_sel_hi:[1,0,1]
    v_pk_fma_f32 v[90:91], v[90:91], v[18:19], v[234:235] op_sel:[0,0,0] op_sel_hi:[1,0,1]
    v_cvt_pk_bf16_f32 v236, v76, v77
    v_cvt_pk_bf16_f32 v237, v78, v79
    v_cvt_pk_bf16_f32 v238, v80, v81
    v_cvt_pk_bf16_f32 v239, v82, v83
    v_cvt_pk_bf16_f32 v240, v84, v85
    v_cvt_pk_bf16_f32 v241, v86, v87
    v_cvt_pk_bf16_f32 v242, v88, v89
    v_cvt_pk_bf16_f32 v243, v90, v91
    s_add_u32 s34, s32, 8388608
    s_add_u32 s35, s32, 8454144
    buffer_store_dwordx4 v[236:239], v14, s[12:15], s34 offen sc1
    buffer_store_dwordx4 v[240:243], v14, s[12:15], s35 offen sc1
    s_nop 1
    v_pk_mul_f32 v[2:3], v[76:77], v[76:77]
    v_pk_mul_f32 v[4:5], v[84:85], v[84:85]
    v_pk_fma_f32 v[2:3], v[78:79], v[78:79], v[2:3]
    v_pk_fma_f32 v[4:5], v[86:87], v[86:87], v[4:5]
    v_pk_fma_f32 v[2:3], v[80:81], v[80:81], v[2:3]
    v_pk_fma_f32 v[4:5], v[88:89], v[88:89], v[4:5]
    v_pk_fma_f32 v[2:3], v[82:83], v[82:83], v[2:3]
    v_pk_fma_f32 v[4:5], v[90:91], v[90:91], v[4:5]
    v_add_f32 v2, v2, v3
    v_add_f32 v3, v4, v5
    s_nop 1
    v_permlane32_swap_b32 v2, v3
    s_nop 1
    v_add_f32 v2, v2, v3
    s_nop 1
    v_max_f32_dpp v2, v2, v2 row_ror:8 row_mask:0xf bank_mask:0xf
    s_nop 1
    v_max_f32_dpp v2, v2, v2 row_ror:4 row_mask:0xf bank_mask:0xf
    s_nop 1
    v_max_f32_dpp v2, v2, v2 row_ror:2 row_mask:0xf bank_mask:0xf
    s_nop 1
    v_max_f32_dpp v2, v2, v2 row_ror:1 row_mask:0xf bank_mask:0xf
    v_mov_b32 v3, v2
    s_nop 1
    v_permlane16_swap_b32 v2, v3
    s_nop 1
    v_max_f32 v2, v2, v3
    s_lshl_b32 s30, s44, 9
    s_lshl_b32 s31, s28, 2
    s_add_u32 s30, s30, s31
    s_add_u32 s30, s30, 8192
    v_lshrrev_b32 v3, 5, v0
    v_lshlrev_b32 v3, 8, v3
    s_mov_b64 s[40:41], exec
    s_mov_b32 exec_lo, 1
    s_mov_b32 exec_hi, 1
    buffer_store_dword v2, v3, s[12:15], s30 offen
    s_mov_b64 exec, s[40:41]
    s_waitcnt lgkmcnt(0)
    v_pk_mul_f32 v[156:157], v[156:157], v[244:245] op_sel:[0,0] op_sel_hi:[1,0]
    v_pk_mul_f32 v[158:159], v[158:159], v[244:245] op_sel:[0,0] op_sel_hi:[1,0]
    v_pk_mul_f32 v[160:161], v[160:161], v[244:245] op_sel:[0,0] op_sel_hi:[1,0]
    v_pk_mul_f32 v[162:163], v[162:163], v[244:245] op_sel:[0,0] op_sel_hi:[1,0]
    v_pk_mul_f32 v[164:165], v[164:165], v[244:245] op_sel:[0,0] op_sel_hi:[1,0]
    v_pk_mul_f32 v[166:167], v[166:167], v[244:245] op_sel:[0,0] op_sel_hi:[1,0]
    v_pk_mul_f32 v[168:169], v[168:169], v[244:245] op_sel:[0,0] op_sel_hi:[1,0]
    v_pk_mul_f32 v[170:171], v[170:171], v[244:245] op_sel:[0,0] op_sel_hi:[1,0]
    v_pk_fma_f32 v[92:93], v[92:93], v[140:141], v[156:157]
    v_pk_fma_f32 v[94:95], v[94:95], v[142:143], v[158:159]
    v_pk_fma_f32 v[96:97], v[96:97], v[144:145], v[160:161]
    v_pk_fma_f32 v[98:99], v[98:99], v[146:147], v[162:163]
    v_pk_fma_f32 v[100:101], v[100:101], v[148:149], v[164:165]
    v_pk_fma_f32 v[102:103], v[102:103], v[150:151], v[166:167]
    v_pk_fma_f32 v[104:105], v[104:105], v[152:153], v[168:169]
    v_pk_fma_f32 v[106:107], v[106:107], v[154:155], v[170:171]
    v_cvt_pk_bf16_f32 v236, v92, v93
    v_cvt_pk_bf16_f32 v237, v94, v95
    v_cvt_pk_bf16_f32 v238, v96, v97
    v_cvt_pk_bf16_f32 v239, v98, v99
    v_cvt_pk_bf16_f32 v240, v100, v101
    v_cvt_pk_bf16_f32 v241, v102, v103
    v_cvt_pk_bf16_f32 v242, v104, v105
    v_cvt_pk_bf16_f32 v243, v106, v107
    s_nop 1
    v_permlane32_swap_b32 v236, v238
    v_permlane32_swap_b32 v237, v239
    v_permlane32_swap_b32 v240, v242
    v_permlane32_swap_b32 v241, v243
    v_bfe_u32 v2, v0, 4, 1
    v_lshlrev_b32 v2, 16, v2
    v_lshrrev_b32 v3, 5, v0
    v_lshl_add_u32 v2, v3, 8, v2
    v_and_b32 v3, 15, v0
    v_lshl_add_u32 v2, v3, 4, v2
    s_add_u32 s30, s32, 10485760
    buffer_store_dwordx4 v[236:239], v2, s[12:15], s30 offen sc1
    buffer_store_dwordx4 v[240:243], v2, s[12:15], s30 offen offset:512 sc1
    s_endpgm
L_chain0_kernel_ld:
    s_and_b32 s52, s20, 7
    s_sub_u32 s30, s20, 28
    s_cmp_ge_u32 s20, 28
    s_cselect_b32 s53, s30, s20
    s_mul_i32 s30, s21, 65536
    s_lshl_b32 s31, s25, 10
    s_add_u32 s30, s30, s31
    s_add_u32 s30, s30, 26738688
    v_lshlrev_b32 v2, 4, v0
    v_add_u32 v2, s30, v2
    s_mul_i32 s27, s25, 4096
    s_lshl_b32 s30, s20, 1
    s_mul_i32 s30, s30, 32768
    s_lshl_b32 s31, s25, 10
    s_add_u32 s30, s30, s31
    s_add_u32 s30, s30, 2097152
    v_lshlrev_b32 v4, 4, v0
    v_add_u32 v4, s30, v4
    v_add_u32 v5, 32768, v4
    s_mov_b32 s54, 0
    s_add_u32 m0, s27, 0
    s_nop 0
    buffer_load_dwordx4 v4, s[12:15], s54 offen lds
    s_add_u32 m0, s27, 1024
    s_nop 0
    buffer_load_dwordx4 v5, s[12:15], s54 offen lds
    s_mov_b32 s54, 0
    s_add_u32 m0, s27, 2048
    s_add_u32 s26, s54, 0
    buffer_load_dwordx4 v2, s[12:15], s26 offen lds
    s_add_u32 m0, s27, 3072
    s_add_u32 s26, s54, 32768
    buffer_load_dwordx4 v2, s[12:15], s26 offen lds
    s_mov_b32 s54, 4096
    s_add_u32 m0, s27, 16384
    s_nop 0
    buffer_load_dwordx4 v4, s[12:15], s54 offen lds
    s_add_u32 m0, s27, 17408
    s_nop 0
    buffer_load_dwordx4 v5, s[12:15], s54 offen lds
    s_mov_b32 s54, 4096
    s_add_u32 m0, s27, 18432
    s_add_u32 s26, s54, 0
    buffer_load_dwordx4 v2, s[12:15], s26 offen lds
    s_add_u32 m0, s27, 19456
    s_add_u32 s26, s54, 32768
    buffer_load_dwordx4 v2, s[12:15], s26 offen lds
    s_mov_b32 s54, 8192
    s_add_u32 m0, s27, 32768
    s_nop 0
    buffer_load_dwordx4 v4, s[12:15], s54 offen lds
    s_add_u32 m0, s27, 33792
    s_nop 0
    buffer_load_dwordx4 v5, s[12:15], s54 offen lds
    s_mov_b32 s54, 8192
    s_add_u32 m0, s27, 34816
    s_add_u32 s26, s54, 0
    buffer_load_dwordx4 v2, s[12:15], s26 offen lds
    s_add_u32 m0, s27, 35840
    s_add_u32 s26, s54, 32768
    buffer_load_dwordx4 v2, s[12:15], s26 offen lds
    s_mov_b32 s54, 12288
    s_add_u32 m0, s27, 49152
    s_nop 0
    buffer_load_dwordx4 v4, s[12:15], s54 offen lds
    s_add_u32 m0, s27, 50176
    s_nop 0
    buffer_load_dwordx4 v5, s[12:15], s54 offen lds
    s_mov_b32 s54, 12288
    s_add_u32 m0, s27, 51200
    s_add_u32 s26, s54, 0
    buffer_load_dwordx4 v2, s[12:15], s26 offen lds
    s_add_u32 m0, s27, 52224
    s_add_u32 s26, s54, 32768
    buffer_load_dwordx4 v2, s[12:15], s26 offen lds
    s_mov_b32 s54, 16384
    s_add_u32 m0, s27, 65536
    s_nop 0
    buffer_load_dwordx4 v4, s[12:15], s54 offen lds
    s_add_u32 m0, s27, 66560
    s_nop 0
    buffer_load_dwordx4 v5, s[12:15], s54 offen lds
    s_mov_b32 s54, 16384
    s_add_u32 m0, s27, 67584
    s_add_u32 s26, s54, 0
    buffer_load_dwordx4 v2, s[12:15], s26 offen lds
    s_add_u32 m0, s27, 68608
    s_add_u32 s26, s54, 32768
    buffer_load_dwordx4 v2, s[12:15], s26 offen lds
    s_mov_b32 s54, 20480
    s_add_u32 m0, s27, 81920
    s_nop 0
    buffer_load_dwordx4 v4, s[12:15], s54 offen lds
    s_add_u32 m0, s27, 82944
    s_nop 0
    buffer_load_dwordx4 v5, s[12:15], s54 offen lds
    s_mov_b32 s54, 20480
    s_add_u32 m0, s27, 83968
    s_add_u32 s26, s54, 0
    buffer_load_dwordx4 v2, s[12:15], s26 offen lds
    s_add_u32 m0, s27, 84992
    s_add_u32 s26, s54, 32768
    buffer_load_dwordx4 v2, s[12:15], s26 offen lds
    s_mov_b32 s54, 24576
    s_add_u32 m0, s27, 98304
    s_nop 0
    buffer_load_dwordx4 v4, s[12:15], s54 offen lds
    s_add_u32 m0, s27, 99328
    s_nop 0
    buffer_load_dwordx4 v5, s[12:15], s54 offen lds
    s_mov_b32 s54, 24576
    s_add_u32 m0, s27, 100352
    s_add_u32 s26, s54, 0
    buffer_load_dwordx4 v2, s[12:15], s26 offen lds
    s_add_u32 m0, s27, 101376
    s_add_u32 s26, s54, 32768
    buffer_load_dwordx4 v2, s[12:15], s26 offen lds
    s_mov_b32 s54, 28672
    s_add_u32 m0, s27, 114688
    s_nop 0
    buffer_load_dwordx4 v4, s[12:15], s54 offen lds
    s_add_u32 m0, s27, 115712
    s_nop 0
    buffer_load_dwordx4 v5, s[12:15], s54 offen lds
    s_mov_b32 s54, 28672
    s_add_u32 m0, s27, 116736
    s_add_u32 s26, s54, 0
    buffer_load_dwordx4 v2, s[12:15], s26 offen lds
    s_add_u32 m0, s27, 117760
    s_add_u32 s26, s54, 32768
    buffer_load_dwordx4 v2, s[12:15], s26 offen lds
    s_waitcnt vmcnt(28)
    s_barrier
    s_waitcnt vmcnt(24)
    s_barrier
    s_waitcnt vmcnt(20)
    s_barrier
    s_waitcnt vmcnt(16)
    s_barrier
    s_waitcnt vmcnt(12)
    s_barrier
    s_mul_i32 s30, s21, 65536
    s_lshl_b32 s31, s25, 10
    s_add_u32 s30, s30, s31
    s_add_u32 s30, s30, 27262976
    v_lshlrev_b32 v2, 4, v0
    v_add_u32 v2, s30, v2
    s_mul_i32 s27, s25, 4096
    s_mul_i32 s26, s21, 256
    s_add_u32 s26, s26, 40960
    v_lshlrev_b32 v12, 4, v0
    s_mov_b32 m0, 148480
    s_nop 0
    buffer_load_dwordx4 v12, s[12:15], s26 offen lds
    s_mov_b32 s54, 0
    s_add_u32 m0, s27, 2048
    s_add_u32 s26, s54, 0
    buffer_load_dwordx4 v2, s[12:15], s26 offen lds
    s_add_u32 m0, s27, 3072
    s_add_u32 s26, s54, 32768
    buffer_load_dwordx4 v2, s[12:15], s26 offen lds
    s_mov_b32 s54, 4096
    s_add_u32 m0, s27, 18432
    s_add_u32 s26, s54, 0
    buffer_load_dwordx4 v2, s[12:15], s26 offen lds
    s_add_u32 m0, s27, 19456
    s_add_u32 s26, s54, 32768
    buffer_load_dwordx4 v2, s[12:15], s26 offen lds
    s_mov_b32 s54, 8192
    s_add_u32 m0, s27, 34816
    s_add_u32 s26, s54, 0
    buffer_load_dwordx4 v2, s[12:15], s26 offen lds
    s_add_u32 m0, s27, 35840
    s_add_u32 s26, s54, 32768
    buffer_load_dwordx4 v2, s[12:15], s26 offen lds
    s_waitcnt vmcnt(15)
    s_barrier
    s_mov_b32 s54, 12288
    s_add_u32 m0, s27, 51200
    s_add_u32 s26, s54, 0
    buffer_load_dwordx4 v2, s[12:15], s26 offen lds
    s_add_u32 m0, s27, 52224
    s_add_u32 s26, s54, 32768
    buffer_load_dwordx4 v2, s[12:15], s26 offen lds
    s_waitcnt vmcnt(13)
    s_barrier
    s_mov_b32 s54, 16384
    s_add_u32 m0, s27, 67584
    s_add_u32 s26, s54, 0
    buffer_load_dwordx4 v2, s[12:15], s26 offen lds
    s_add_u32 m0, s27, 68608
    s_add_u32 s26, s54, 32768
    buffer_load_dwordx4 v2, s[12:15], s26 offen lds
    s_waitcnt vmcnt(11)
    s_barrier
    s_mov_b32 s54, 20480
    s_add_u32 m0, s27, 83968
    s_add_u32 s26, s54, 0
    buffer_load_dwordx4 v2, s[12:15], s26 offen lds
    s_add_u32 m0, s27, 84992
    s_add_u32 s26, s54, 32768
    buffer_load_dwordx4 v2, s[12:15], s26 offen lds
    s_barrier
    s_mov_b32 s54, 24576
    s_add_u32 m0, s27, 100352
    s_add_u32 s26, s54, 0
    buffer_load_dwordx4 v2, s[12:15], s26 offen lds
    s_add_u32 m0, s27, 101376
    s_add_u32 s26, s54, 32768
    buffer_load_dwordx4 v2, s[12:15], s26 offen lds
    s_mov_b32 s54, 28672
    s_add_u32 m0, s27, 116736
    s_add_u32 s26, s54, 0
    buffer_load_dwordx4 v2, s[12:15], s26 offen lds
    s_add_u32 m0, s27, 117760
    s_add_u32 s26, s54, 32768
    buffer_load_dwordx4 v2, s[12:15], s26 offen lds
    s_lshl_b32 s30, s20, 1
    s_mul_i32 s30, s30, 32768
    s_lshl_b32 s31, s25, 10
    s_add_u32 s30, s30, s31
    s_add_u32 s30, s30, 22020096
    v_lshlrev_b32 v4, 4, v0
    v_add_u32 v4, s30, v4
    v_add_u32 v5, 32768, v4
    s_barrier
    s_barrier
    s_lshl_b32 s26, s20, 13
    s_lshl_b32 s30, s25, 11
    s_add_u32 s26, s26, s30
    s_add_u32 s26, s26, 20185088
    s_add_u32 m0, s30, 149504
    v_lshlrev_b32 v12, 4, v0
    buffer_load_dwordx4 v12, s[12:15], s26 offen sc1 lds
    buffer_load_dwordx4 v12, s[12:15], s26 offen offset:1024 sc1 lds
    s_mov_b32 s54, 0
    s_add_u32 m0, s27, 0
    s_nop 0
    buffer_load_dwordx4 v4, s[12:15], s54 offen sc1 lds
    s_add_u32 m0, s27, 1024
    s_nop 0
    buffer_load_dwordx4 v5, s[12:15], s54 offen sc1 lds
    s_mov_b32 s54, 4096
    s_add_u32 m0, s27, 16384
    s_nop 0
    buffer_load_dwordx4 v4, s[12:15], s54 offen sc1 lds
    s_add_u32 m0, s27, 17408
    s_nop 0
    buffer_load_dwordx4 v5, s[12:15], s54 offen sc1 lds
    s_mov_b32 s54, 8192
    s_add_u32 m0, s27, 32768
    s_nop 0
    buffer_load_dwordx4 v4, s[12:15], s54 offen sc1 lds
    s_add_u32 m0, s27, 33792
    s_nop 0
    buffer_load_dwordx4 v5, s[12:15], s54 offen sc1 lds
    s_mov_b32 s54, 12288
    s_add_u32 m0, s27, 49152
    s_nop 0
    buffer_load_dwordx4 v4, s[12:15], s54 offen sc1 lds
    s_add_u32 m0, s27, 50176
    s_nop 0
    buffer_load_dwordx4 v5, s[12:15], s54 offen sc1 lds
    s_waitcnt vmcnt(6)
    s_barrier
    s_mov_b32 s54, 16384
    s_add_u32 m0, s27, 65536
    s_nop 0
    buffer_load_dwordx4 v4, s[12:15], s54 offen sc1 lds
    s_add_u32 m0, s27, 66560
    s_nop 0
    buffer_load_dwordx4 v5, s[12:15], s54 offen sc1 lds
    s_mov_b32 s54, 20480
    s_add_u32 m0, s27, 81920
    s_nop 0
    buffer_load_dwordx4 v4, s[12:15], s54 offen sc1 lds
    s_add_u32 m0, s27, 82944
    s_nop 0
    buffer_load_dwordx4 v5, s[12:15], s54 offen sc1 lds
    s_waitcnt vmcnt(8)
    s_barrier
    s_mov_b32 s54, 24576
    s_add_u32 m0, s27, 98304
    s_nop 0
    buffer_load_dwordx4 v4, s[12:15], s54 offen sc1 lds
    s_add_u32 m0, s27, 99328
    s_nop 0
    buffer_load_dwordx4 v5, s[12:15], s54 offen sc1 lds
    s_mov_b32 s54, 28672
    s_add_u32 m0, s27, 114688
    s_nop 0
    buffer_load_dwordx4 v4, s[12:15], s54 offen sc1 lds
    s_add_u32 m0, s27, 115712
    s_nop 0
    buffer_load_dwordx4 v5, s[12:15], s54 offen sc1 lds
    s_waitcnt vmcnt(10)
    s_barrier
    s_mul_i32 s30, s21, 65536
    s_lshl_b32 s31, s25, 10
    s_add_u32 s30, s30, s31
    s_add_u32 s30, s30, 27787264
    v_lshlrev_b32 v2, 4, v0
    v_add_u32 v2, s30, v2
    s_mul_i32 s27, s25, 4096
    s_mov_b32 s54, 0
    s_add_u32 m0, s27, 2048
    s_add_u32 s26, s54, 0
    buffer_load_dwordx4 v2, s[12:15], s26 offen lds
    s_add_u32 m0, s27, 3072
    s_add_u32 s26, s54, 32768
    buffer_load_dwordx4 v2, s[12:15], s26 offen lds
    s_waitcnt vmcnt(10)
    s_barrier
    s_mov_b32 s54, 4096
    s_add_u32 m0, s27, 18432
    s_add_u32 s26, s54, 0
    buffer_load_dwordx4 v2, s[12:15], s26 offen lds
    s_add_u32 m0, s27, 19456
    s_add_u32 s26, s54, 32768
    buffer_load_dwordx4 v2, s[12:15], s26 offen lds
    s_waitcnt vmcnt(10)
    s_barrier
    s_mov_b32 s54, 8192
    s_add_u32 m0, s27, 34816
    s_add_u32 s26, s54, 0
    buffer_load_dwordx4 v2, s[12:15], s26 offen lds
    s_add_u32 m0, s27, 35840
    s_add_u32 s26, s54, 32768
    buffer_load_dwordx4 v2, s[12:15], s26 offen lds
    s_waitcnt vmcnt(10)
    s_barrier
    s_mov_b32 s54, 12288
    s_add_u32 m0, s27, 51200
    s_add_u32 s26, s54, 0
    buffer_load_dwordx4 v2, s[12:15], s26 offen lds
    s_add_u32 m0, s27, 52224
    s_add_u32 s26, s54, 32768
    buffer_load_dwordx4 v2, s[12:15], s26 offen lds
    s_waitcnt vmcnt(10)
    s_barrier
    s_mov_b32 s54, 16384
    s_add_u32 m0, s27, 67584
    s_add_u32 s26, s54, 0
    buffer_load_dwordx4 v2, s[12:15], s26 offen lds
    s_add_u32 m0, s27, 68608
    s_add_u32 s26, s54, 32768
    buffer_load_dwordx4 v2, s[12:15], s26 offen lds
    s_waitcnt vmcnt(10)
    s_barrier
    s_mov_b32 s54, 20480
    s_add_u32 m0, s27, 83968
    s_add_u32 s26, s54, 0
    buffer_load_dwordx4 v2, s[12:15], s26 offen lds
    s_add_u32 m0, s27, 84992
    s_add_u32 s26, s54, 32768
    buffer_load_dwordx4 v2, s[12:15], s26 offen lds
    s_barrier
    s_mov_b32 s54, 24576
    s_add_u32 m0, s27, 100352
    s_add_u32 s26, s54, 0
    buffer_load_dwordx4 v2, s[12:15], s26 offen lds
    s_add_u32 m0, s27, 101376
    s_add_u32 s26, s54, 32768
    buffer_load_dwordx4 v2, s[12:15], s26 offen lds
    s_mov_b32 s54, 28672
    s_add_u32 m0, s27, 116736
    s_add_u32 s26, s54, 0
    buffer_load_dwordx4 v2, s[12:15], s26 offen lds
    s_add_u32 m0, s27, 117760
    s_add_u32 s26, s54, 32768
    buffer_load_dwordx4 v2, s[12:15], s26 offen lds
    v_lshrrev_b32 v13, 5, v0
    v_lshlrev_b32 v13, 9, v13
    s_lshl_b32 s30, s25, 10
    v_add_u32 v13, s30, v13
    s_lshl_b32 s30, s20, 16
    s_add_u32 s30, s30, 2097152
    v_add_u32 v13, s30, v13
    v_and_b32 v12, 31, v0
    v_add_u32 v4, -1, v12
    v_bfe_u32 v14, v4, 5, 1
    v_lshlrev_b32 v14, 15, v14
    v_and_b32 v15, 31, v4
    v_lshl_add_u32 v14, v15, 4, v14
    v_add_u32 v4, v14, v13
    v_add_u32 v5, 31, v12
    v_bfe_u32 v14, v5, 5, 1
    v_lshlrev_b32 v14, 15, v14
    v_and_b32 v15, 31, v5
    v_lshl_add_u32 v14, v15, 4, v14
    v_add_u32 v5, v14, v13
    v_add_u32 v6, 1, v12
    v_bfe_u32 v14, v6, 5, 1
    v_lshlrev_b32 v14, 15, v14
    v_and_b32 v15, 31, v6
    v_lshl_add_u32 v14, v15, 4, v14
    v_add_u32 v6, v14, v13
    v_add_u32 v7, 33, v12
    v_bfe_u32 v14, v7, 5, 1
    v_lshlrev_b32 v14, 15, v14
    v_and_b32 v15, 31, v7
    v_lshl_add_u32 v14, v15, 4, v14
    v_add_u32 v7, v14, v13
    v_add_u32 v8, -2, v12
    v_bfe_u32 v14, v8, 5, 1
    v_lshlrev_b32 v14, 15, v14
    v_and_b32 v15, 31, v8
    v_lshl_add_u32 v14, v15, 4, v14
    v_add_u32 v8, v14, v13
    v_add_u32 v9, 30, v12
    v_bfe_u32 v14, v9, 5, 1
    v_lshlrev_b32 v14, 15, v14
    v_and_b32 v15, 31, v9
    v_lshl_add_u32 v14, v15, 4, v14
    v_add_u32 v9, v14, v13
    v_add_u32 v10, 2, v12
    v_bfe_u32 v14, v10, 5, 1
    v_lshlrev_b32 v14, 15, v14
    v_and_b32 v15, 31, v10
    v_lshl_add_u32 v14, v15, 4, v14
    v_add_u32 v10, v14, v13
    v_add_u32 v11, 34, v12
    v_bfe_u32 v14, v11, 5, 1
    v_lshlrev_b32 v14, 15, v14
    v_and_b32 v15, 31, v11
    v_lshl_add_u32 v14, v15, 4, v14
    v_add_u32 v11, v14, v13
    s_barrier
    s_barrier
    s_mov_b32 s54, 0
    s_add_u32 m0, s27, 0
    s_nop 0
    s_mov_b32 exec_lo, 0xfffffffe
    s_mov_b32 exec_hi, 0xfffffffe
    buffer_load_dwordx4 v4, s[12:15], s54 offen sc1 lds
    s_mov_b64 exec, -1
    s_add_u32 m0, s27, 1024
    s_nop 0
    buffer_load_dwordx4 v5, s[12:15], s54 offen sc1 lds
    s_mov_b32 s54, 4096
    s_add_u32 m0, s27, 16384
    s_nop 0
    s_mov_b32 exec_lo, 0xfffffffe
    s_mov_b32 exec_hi, 0xfffffffe
    buffer_load_dwordx4 v4, s[12:15], s54 offen sc1 lds
    s_mov_b64 exec, -1
    s_add_u32 m0, s27, 17408
    s_nop 0
    buffer_load_dwordx4 v5, s[12:15], s54 offen sc1 lds
    s_mov_b32 s54, 8192
    s_add_u32 m0, s27, 32768
    s_nop 0
    buffer_load_dwordx4 v6, s[12:15], s54 offen sc1 lds
    s_add_u32 m0, s27, 33792
    s_nop 0
    s_mov_b32 exec_lo, 0x7fffffff
    s_mov_b32 exec_hi, 0x7fffffff
    buffer_load_dwordx4 v7, s[12:15], s54 offen sc1 lds
    s_mov_b64 exec, -1
    s_mov_b32 s54, 12288
    s_add_u32 m0, s27, 49152
    s_nop 0
    buffer_load_dwordx4 v6, s[12:15], s54 offen sc1 lds
    s_add_u32 m0, s27, 50176
    s_nop 0
    s_mov_b32 exec_lo, 0x7fffffff
    s_mov_b32 exec_hi, 0x7fffffff
    buffer_load_dwordx4 v7, s[12:15], s54 offen sc1 lds
    s_mov_b64 exec, -1
    s_waitcnt vmcnt(6)
    s_barrier
    s_mov_b32 s54, 16384
    s_add_u32 m0, s27, 65536
    s_nop 0
    s_mov_b32 exec_lo, 0xfffffffc
    s_mov_b32 exec_hi, 0xfffffffc
    buffer_load_dwordx4 v8, s[12:15], s54 offen sc1 lds
    s_mov_b64 exec, -1
    s_add_u32 m0, s27, 66560
    s_nop 0
    buffer_load_dwordx4 v9, s[12:15], s54 offen sc1 lds
    s_mov_b32 s54, 20480
    s_add_u32 m0, s27, 81920
    s_nop 0
    s_mov_b32 exec_lo, 0xfffffffc
    s_mov_b32 exec_hi, 0xfffffffc
    buffer_load_dwordx4 v8, s[12:15], s54 offen sc1 lds
    s_mov_b64 exec, -1
    s_add_u32 m0, s27, 82944
    s_nop 0
    buffer_load_dwordx4 v9, s[12:15], s54 offen sc1 lds
    s_waitcnt vmcnt(8)
    s_barrier
    s_mov_b32 s54, 24576
    s_add_u32 m0, s27, 98304
    s_nop 0
    buffer_load_dwordx4 v10, s[12:15], s54 offen sc1 lds
    s_add_u32 m0, s27, 99328
    s_nop 0
    s_mov_b32 exec_lo, 0x3fffffff
    s_mov_b32 exec_hi, 0x3fffffff
    buffer_load_dwordx4 v11, s[12:15], s54 offen sc1 lds
    s_mov_b64 exec, -1
    s_mov_b32 s54, 28672
    s_add_u32 m0, s27, 114688
    s_nop 0
    buffer_load_dwordx4 v10, s[12:15], s54 offen sc1 lds
    s_add_u32 m0, s27, 115712
    s_nop 0
    s_mov_b32 exec_lo, 0x3fffffff
    s_mov_b32 exec_hi, 0x3fffffff
    buffer_load_dwordx4 v11, s[12:15], s54 offen sc1 lds
    s_mov_b64 exec, -1
    s_waitcnt vmcnt(10)
    s_barrier
    s_waitcnt vmcnt(8)
    s_barrier
    s_waitcnt vmcnt(6)
    s_barrier
    s_waitcnt vmcnt(4)
    s_barrier
    s_waitcnt vmcnt(2)
    s_barrier
    s_waitcnt vmcnt(0)
    s_barrier
    s_barrier
    s_mul_i32 s26, s21, 896
    s_add_u32 s26, s26, 45056
    v_lshlrev_b32 v12, 4, v0
    s_mov_b32 m0, 148480
    s_nop 0
    buffer_load_dwordx4 v12, s[12:15], s26 offen lds
    s_barrier
    s_branch L_chain0_kernel_com
L_chain0_kernel_ldtail:
    s_mul_i32 s30, s21, 229376
    s_lshl_b32 s31, s25, 10
    s_add_u32 s30, s30, s31
    s_add_u32 s30, s30, 30146560
    v_lshlrev_b32 v2, 4, v0
    v_add_u32 v2, s30, v2
    s_mul_i32 s27, s25, 4096
    s_mov_b32 s54, 0
    s_add_u32 m0, s27, 2048
    s_add_u32 s26, s54, 0
    buffer_load_dwordx4 v2, s[12:15], s26 offen lds
    s_add_u32 m0, s27, 3072
    s_add_u32 s26, s54, 114688
    buffer_load_dwordx4 v2, s[12:15], s26 offen lds
    s_mov_b32 s54, 4096
    s_add_u32 m0, s27, 18432
    s_add_u32 s26, s54, 0
    buffer_load_dwordx4 v2, s[12:15], s26 offen lds
    s_add_u32 m0, s27, 19456
    s_add_u32 s26, s54, 114688
    buffer_load_dwordx4 v2, s[12:15], s26 offen lds
    s_mov_b32 s54, 8192
    s_add_u32 m0, s27, 34816
    s_add_u32 s26, s54, 0
    buffer_load_dwordx4 v2, s[12:15], s26 offen lds
    s_add_u32 m0, s27, 35840
    s_add_u32 s26, s54, 114688
    buffer_load_dwordx4 v2, s[12:15], s26 offen lds
    s_mov_b32 s54, 12288
    s_add_u32 m0, s27, 51200
    s_add_u32 s26, s54, 0
    buffer_load_dwordx4 v2, s[12:15], s26 offen lds
    s_add_u32 m0, s27, 52224
    s_add_u32 s26, s54, 114688
    buffer_load_dwordx4 v2, s[12:15], s26 offen lds
    s_mov_b32 s54, 16384
    s_add_u32 m0, s27, 67584
    s_add_u32 s26, s54, 0
    buffer_load_dwordx4 v2, s[12:15], s26 offen lds
    s_add_u32 m0, s27, 68608
    s_add_u32 s26, s54, 114688
    buffer_load_dwordx4 v2, s[12:15], s26 offen lds
    s_mov_b32 s54, 20480
    s_add_u32 m0, s27, 83968
    s_add_u32 s26, s54, 0
    buffer_load_dwordx4 v2, s[12:15], s26 offen lds
    s_add_u32 m0, s27, 84992
    s_add_u32 s26, s54, 114688
    buffer_load_dwordx4 v2, s[12:15], s26 offen lds
    s_mov_b32 s54, 24576
    s_add_u32 m0, s27, 100352
    s_add_u32 s26, s54, 0
    buffer_load_dwordx4 v2, s[12:15], s26 offen lds
    s_add_u32 m0, s27, 101376
    s_add_u32 s26, s54, 114688
    buffer_load_dwordx4 v2, s[12:15], s26 offen lds
    s_mov_b32 s54, 28672
    s_add_u32 m0, s27, 116736
    s_add_u32 s26, s54, 0
    buffer_load_dwordx4 v2, s[12:15], s26 offen lds
    s_add_u32 m0, s27, 117760
    s_add_u32 s26, s54, 114688
    buffer_load_dwordx4 v2, s[12:15], s26 offen lds
    s_lshl_b32 s30, s20, 1
    s_mul_i32 s30, s30, 114688
    s_lshl_b32 s31, s25, 10
    s_add_u32 s30, s30, s31
    s_add_u32 s30, s30, 12582912
    v_lshlrev_b32 v4, 4, v0
    v_add_u32 v4, s30, v4
    v_add_u32 v5, 114688, v4
    s_barrier
    s_mov_b32 s54, 0
    s_add_u32 m0, s27, 0
    s_nop 0
    buffer_load_dwordx4 v4, s[12:15], s54 offen sc1 lds
    s_add_u32 m0, s27, 1024
    s_nop 0
    buffer_load_dwordx4 v5, s[12:15], s54 offen sc1 lds
    s_mov_b32 s54, 4096
    s_add_u32 m0, s27, 16384
    s_nop 0
    buffer_load_dwordx4 v4, s[12:15], s54 offen sc1 lds
    s_add_u32 m0, s27, 17408
    s_nop 0
    buffer_load_dwordx4 v5, s[12:15], s54 offen sc1 lds
    s_mov_b32 s54, 8192
    s_add_u32 m0, s27, 32768
    s_nop 0
    buffer_load_dwordx4 v4, s[12:15], s54 offen sc1 lds
    s_add_u32 m0, s27, 33792
    s_nop 0
    buffer_load_dwordx4 v5, s[12:15], s54 offen sc1 lds
    s_mov_b32 s54, 12288
    s_add_u32 m0, s27, 49152
    s_nop 0
    buffer_load_dwordx4 v4, s[12:15], s54 offen sc1 lds
    s_add_u32 m0, s27, 50176
    s_nop 0
    buffer_load_dwordx4 v5, s[12:15], s54 offen sc1 lds
    s_waitcnt vmcnt(6)
    s_barrier
    s_mov_b32 s54, 16384
    s_add_u32 m0, s27, 65536
    s_nop 0
    buffer_load_dwordx4 v4, s[12:15], s54 offen sc1 lds
    s_add_u32 m0, s27, 66560
    s_nop 0
    buffer_load_dwordx4 v5, s[12:15], s54 offen sc1 lds
    s_mov_b32 s54, 20480
    s_add_u32 m0, s27, 81920
    s_nop 0
    buffer_load_dwordx4 v4, s[12:15], s54 offen sc1 lds
    s_add_u32 m0, s27, 82944
    s_nop 0
    buffer_load_dwordx4 v5, s[12:15], s54 offen sc1 lds
    s_waitcnt vmcnt(8)
    s_barrier
    s_mov_b32 s54, 24576
    s_add_u32 m0, s27, 98304
    s_nop 0
    buffer_load_dwordx4 v4, s[12:15], s54 offen sc1 lds
    s_add_u32 m0, s27, 99328
    s_nop 0
    buffer_load_dwordx4 v5, s[12:15], s54 offen sc1 lds
    s_mov_b32 s54, 28672
    s_add_u32 m0, s27, 114688
    s_nop 0
    buffer_load_dwordx4 v4, s[12:15], s54 offen sc1 lds
    s_add_u32 m0, s27, 115712
    s_nop 0
    buffer_load_dwordx4 v5, s[12:15], s54 offen sc1 lds
    s_waitcnt vmcnt(10)
    s_barrier
    s_mov_b32 s54, 32768
    s_add_u32 m0, s27, 0
    s_nop 0
    buffer_load_dwordx4 v4, s[12:15], s54 offen sc1 lds
    s_add_u32 m0, s27, 1024
    s_nop 0
    buffer_load_dwordx4 v5, s[12:15], s54 offen sc1 lds
    s_mov_b32 s54, 32768
    s_add_u32 m0, s27, 2048
    s_add_u32 s26, s54, 0
    buffer_load_dwordx4 v2, s[12:15], s26 offen lds
    s_add_u32 m0, s27, 3072
    s_add_u32 s26, s54, 114688
    buffer_load_dwordx4 v2, s[12:15], s26 offen lds
    s_waitcnt vmcnt(12)
    s_barrier
    s_mov_b32 s54, 36864
    s_add_u32 m0, s27, 16384
    s_nop 0
    buffer_load_dwordx4 v4, s[12:15], s54 offen sc1 lds
    s_add_u32 m0, s27, 17408
    s_nop 0
    buffer_load_dwordx4 v5, s[12:15], s54 offen sc1 lds
    s_mov_b32 s54, 36864
    s_add_u32 m0, s27, 18432
    s_add_u32 s26, s54, 0
    buffer_load_dwordx4 v2, s[12:15], s26 offen lds
    s_add_u32 m0, s27, 19456
    s_add_u32 s26, s54, 114688
    buffer_load_dwordx4 v2, s[12:15], s26 offen lds
    s_waitcnt vmcnt(14)
    s_barrier
    s_mov_b32 s54, 40960
    s_add_u32 m0, s27, 32768
    s_nop 0
    buffer_load_dwordx4 v4, s[12:15], s54 offen sc1 lds
    s_add_u32 m0, s27, 33792
    s_nop 0
    buffer_load_dwordx4 v5, s[12:15], s54 offen sc1 lds
    s_mov_b32 s54, 40960
    s_add_u32 m0, s27, 34816
    s_add_u32 s26, s54, 0
    buffer_load_dwordx4 v2, s[12:15], s26 offen lds
    s_add_u32 m0, s27, 35840
    s_add_u32 s26, s54, 114688
    buffer_load_dwordx4 v2, s[12:15], s26 offen lds
    s_waitcnt vmcnt(16)
    s_barrier
    s_mov_b32 s54, 45056
    s_add_u32 m0, s27, 49152
    s_nop 0
    buffer_load_dwordx4 v4, s[12:15], s54 offen sc1 lds
    s_add_u32 m0, s27, 50176
    s_nop 0
    buffer_load_dwordx4 v5, s[12:15], s54 offen sc1 lds
    s_mov_b32 s54, 45056
    s_add_u32 m0, s27, 51200
    s_add_u32 s26, s54, 0
    buffer_load_dwordx4 v2, s[12:15], s26 offen lds
    s_add_u32 m0, s27, 52224
    s_add_u32 s26, s54, 114688
    buffer_load_dwordx4 v2, s[12:15], s26 offen lds
    s_waitcnt vmcnt(18)
    s_barrier
    s_mov_b32 s54, 49152
    s_add_u32 m0, s27, 65536
    s_nop 0
    buffer_load_dwordx4 v4, s[12:15], s54 offen sc1 lds
    s_add_u32 m0, s27, 66560
    s_nop 0
    buffer_load_dwordx4 v5, s[12:15], s54 offen sc1 lds
    s_mov_b32 s54, 49152
    s_add_u32 m0, s27, 67584
    s_add_u32 s26, s54, 0
    buffer_load_dwordx4 v2, s[12:15], s26 offen lds
    s_add_u32 m0, s27, 68608
    s_add_u32 s26, s54, 114688
    buffer_load_dwordx4 v2, s[12:15], s26 offen lds
    s_waitcnt vmcnt(20)
    s_barrier
    s_mov_b32 s54, 53248
    s_add_u32 m0, s27, 81920
    s_nop 0
    buffer_load_dwordx4 v4, s[12:15], s54 offen sc1 lds
    s_add_u32 m0, s27, 82944
    s_nop 0
    buffer_load_dwordx4 v5, s[12:15], s54 offen sc1 lds
    s_mov_b32 s54, 53248
    s_add_u32 m0, s27, 83968
    s_add_u32 s26, s54, 0
    buffer_load_dwordx4 v2, s[12:15], s26 offen lds
    s_add_u32 m0, s27, 84992
    s_add_u32 s26, s54, 114688
    buffer_load_dwordx4 v2, s[12:15], s26 offen lds
    s_waitcnt vmcnt(20)
    s_barrier
    s_mov_b32 s54, 57344
    s_add_u32 m0, s27, 98304
    s_nop 0
    buffer_load_dwordx4 v4, s[12:15], s54 offen sc1 lds
    s_add_u32 m0, s27, 99328
    s_nop 0
    buffer_load_dwordx4 v5, s[12:15], s54 offen sc1 lds
    s_mov_b32 s54, 57344
    s_add_u32 m0, s27, 100352
    s_add_u32 s26, s54, 0
    buffer_load_dwordx4 v2, s[12:15], s26 offen lds
    s_add_u32 m0, s27, 101376
    s_add_u32 s26, s54, 114688
    buffer_load_dwordx4 v2, s[12:15], s26 offen lds
    s_waitcnt vmcnt(20)
    s_barrier
    s_mov_b32 s54, 61440
    s_add_u32 m0, s27, 114688
    s_nop 0
    buffer_load_dwordx4 v4, s[12:15], s54 offen sc1 lds
    s_add_u32 m0, s27, 115712
    s_nop 0
    buffer_load_dwordx4 v5, s[12:15], s54 offen sc1 lds
    s_mov_b32 s54, 61440
    s_add_u32 m0, s27, 116736
    s_add_u32 s26, s54, 0
    buffer_load_dwordx4 v2, s[12:15], s26 offen lds
    s_add_u32 m0, s27, 117760
    s_add_u32 s26, s54, 114688
    buffer_load_dwordx4 v2, s[12:15], s26 offen lds
    s_waitcnt vmcnt(20)
    s_barrier
    s_mov_b32 s54, 65536
    s_add_u32 m0, s27, 0
    s_nop 0
    buffer_load_dwordx4 v4, s[12:15], s54 offen sc1 lds
    s_add_u32 m0, s27, 1024
    s_nop 0
    buffer_load_dwordx4 v5, s[12:15], s54 offen sc1 lds
    s_mov_b32 s54, 65536
    s_add_u32 m0, s27, 2048
    s_add_u32 s26, s54, 0
    buffer_load_dwordx4 v2, s[12:15], s26 offen lds
    s_add_u32 m0, s27, 3072
    s_add_u32 s26, s54, 114688
    buffer_load_dwordx4 v2, s[12:15], s26 offen lds
    s_waitcnt vmcnt(20)
    s_barrier
    s_mov_b32 s54, 69632
    s_add_u32 m0, s27, 16384
    s_nop 0
    buffer_load_dwordx4 v4, s[12:15], s54 offen sc1 lds
    s_add_u32 m0, s27, 17408
    s_nop 0
    buffer_load_dwordx4 v5, s[12:15], s54 offen sc1 lds
    s_mov_b32 s54, 69632
    s_add_u32 m0, s27, 18432
    s_add_u32 s26, s54, 0
    buffer_load_dwordx4 v2, s[12:15], s26 offen lds
    s_add_u32 m0, s27, 19456
    s_add_u32 s26, s54, 114688
    buffer_load_dwordx4 v2, s[12:15], s26 offen lds
    s_waitcnt vmcnt(20)
    s_barrier
    s_mov_b32 s54, 73728
    s_add_u32 m0, s27, 32768
    s_nop 0
    buffer_load_dwordx4 v4, s[12:15], s54 offen sc1 lds
    s_add_u32 m0, s27, 33792
    s_nop 0
    buffer_load_dwordx4 v5, s[12:15], s54 offen sc1 lds
    s_mov_b32 s54, 73728
    s_add_u32 m0, s27, 34816
    s_add_u32 s26, s54, 0
    buffer_load_dwordx4 v2, s[12:15], s26 offen lds
    s_add_u32 m0, s27, 35840
    s_add_u32 s26, s54, 114688
    buffer_load_dwordx4 v2, s[12:15], s26 offen lds
    s_waitcnt vmcnt(20)
    s_barrier
    s_mov_b32 s54, 77824
    s_add_u32 m0, s27, 49152
    s_nop 0
    buffer_load_dwordx4 v4, s[12:15], s54 offen sc1 lds
    s_add_u32 m0, s27, 50176
    s_nop 0
    buffer_load_dwordx4 v5, s[12:15], s54 offen sc1 lds
    s_mov_b32 s54, 77824
    s_add_u32 m0, s27, 51200
    s_add_u32 s26, s54, 0
    buffer_load_dwordx4 v2, s[12:15], s26 offen lds
    s_add_u32 m0, s27, 52224
    s_add_u32 s26, s54, 114688
    buffer_load_dwordx4 v2, s[12:15], s26 offen lds
    s_waitcnt vmcnt(20)
    s_barrier
    s_mov_b32 s54, 81920
    s_add_u32 m0, s27, 65536
    s_nop 0
    buffer_load_dwordx4 v4, s[12:15], s54 offen sc1 lds
    s_add_u32 m0, s27, 66560
    s_nop 0
    buffer_load_dwordx4 v5, s[12:15], s54 offen sc1 lds
    s_mov_b32 s54, 81920
    s_add_u32 m0, s27, 67584
    s_add_u32 s26, s54, 0
    buffer_load_dwordx4 v2, s[12:15], s26 offen lds
    s_add_u32 m0, s27, 68608
    s_add_u32 s26, s54, 114688
    buffer_load_dwordx4 v2, s[12:15], s26 offen lds
    s_waitcnt vmcnt(20)
    s_barrier
    s_mov_b32 s54, 86016
    s_add_u32 m0, s27, 81920
    s_nop 0
    buffer_load_dwordx4 v4, s[12:15], s54 offen sc1 lds
    s_add_u32 m0, s27, 82944
    s_nop 0
    buffer_load_dwordx4 v5, s[12:15], s54 offen sc1 lds
    s_mov_b32 s54, 86016
    s_add_u32 m0, s27, 83968
    s_add_u32 s26, s54, 0
    buffer_load_dwordx4 v2, s[12:15], s26 offen lds
    s_add_u32 m0, s27, 84992
    s_add_u32 s26, s54, 114688
    buffer_load_dwordx4 v2, s[12:15], s26 offen lds
    s_waitcnt vmcnt(20)
    s_barrier
    s_mov_b32 s54, 90112
    s_add_u32 m0, s27, 98304
    s_nop 0
    buffer_load_dwordx4 v4, s[12:15], s54 offen sc1 lds
    s_add_u32 m0, s27, 99328
    s_nop 0
    buffer_load_dwordx4 v5, s[12:15], s54 offen sc1 lds
    s_mov_b32 s54, 90112
    s_add_u32 m0, s27, 100352
    s_add_u32 s26, s54, 0
    buffer_load_dwordx4 v2, s[12:15], s26 offen lds
    s_add_u32 m0, s27, 101376
    s_add_u32 s26, s54, 114688
    buffer_load_dwordx4 v2, s[12:15], s26 offen lds
    s_waitcnt vmcnt(20)
    s_barrier
    s_mov_b32 s54, 94208
    s_add_u32 m0, s27, 114688
    s_nop 0
    buffer_load_dwordx4 v4, s[12:15], s54 offen sc1 lds
    s_add_u32 m0, s27, 115712
    s_nop 0
    buffer_load_dwordx4 v5, s[12:15], s54 offen sc1 lds
    s_mov_b32 s54, 94208
    s_add_u32 m0, s27, 116736
    s_add_u32 s26, s54, 0
    buffer_load_dwordx4 v2, s[12:15], s26 offen lds
    s_add_u32 m0, s27, 117760
    s_add_u32 s26, s54, 114688
    buffer_load_dwordx4 v2, s[12:15], s26 offen lds
    s_waitcnt vmcnt(20)
    s_barrier
    s_mov_b32 s54, 98304
    s_add_u32 m0, s27, 0
    s_nop 0
    buffer_load_dwordx4 v4, s[12:15], s54 offen sc1 lds
    s_add_u32 m0, s27, 1024
    s_nop 0
    buffer_load_dwordx4 v5, s[12:15], s54 offen sc1 lds
    s_mov_b32 s54, 98304
    s_add_u32 m0, s27, 2048
    s_add_u32 s26, s54, 0
    buffer_load_dwordx4 v2, s[12:15], s26 offen lds
    s_add_u32 m0, s27, 3072
    s_add_u32 s26, s54, 114688
    buffer_load_dwordx4 v2, s[12:15], s26 offen lds
    s_waitcnt vmcnt(20)
    s_barrier
    s_mov_b32 s54, 102400
    s_add_u32 m0, s27, 16384
    s_nop 0
    buffer_load_dwordx4 v4, s[12:15], s54 offen sc1 lds
    s_add_u32 m0, s27, 17408
    s_nop 0
    buffer_load_dwordx4 v5, s[12:15], s54 offen sc1 lds
    s_mov_b32 s54, 102400
    s_add_u32 m0, s27, 18432
    s_add_u32 s26, s54, 0
    buffer_load_dwordx4 v2, s[12:15], s26 offen lds
    s_add_u32 m0, s27, 19456
    s_add_u32 s26, s54, 114688
    buffer_load_dwordx4 v2, s[12:15], s26 offen lds
    s_waitcnt vmcnt(20)
    s_barrier
    s_mov_b32 s54, 106496
    s_add_u32 m0, s27, 32768
    s_nop 0
    buffer_load_dwordx4 v4, s[12:15], s54 offen sc1 lds
    s_add_u32 m0, s27, 33792
    s_nop 0
    buffer_load_dwordx4 v5, s[12:15], s54 offen sc1 lds
    s_mov_b32 s54, 106496
    s_add_u32 m0, s27, 34816
    s_add_u32 s26, s54, 0
    buffer_load_dwordx4 v2, s[12:15], s26 offen lds
    s_add_u32 m0, s27, 35840
    s_add_u32 s26, s54, 114688
    buffer_load_dwordx4 v2, s[12:15], s26 offen lds
    s_waitcnt vmcnt(20)
    s_barrier
    s_mov_b32 s54, 110592
    s_add_u32 m0, s27, 49152
    s_nop 0
    buffer_load_dwordx4 v4, s[12:15], s54 offen sc1 lds
    s_add_u32 m0, s27, 50176
    s_nop 0
    buffer_load_dwordx4 v5, s[12:15], s54 offen sc1 lds
    s_mov_b32 s54, 110592
    s_add_u32 m0, s27, 51200
    s_add_u32 s26, s54, 0
    buffer_load_dwordx4 v2, s[12:15], s26 offen lds
    s_add_u32 m0, s27, 52224
    s_add_u32 s26, s54, 114688
    buffer_load_dwordx4 v2, s[12:15], s26 offen lds
    s_waitcnt vmcnt(20)
    s_barrier
    s_waitcnt vmcnt(16)
    s_barrier
    s_waitcnt vmcnt(12)
    s_barrier
    s_waitcnt vmcnt(8)
    s_barrier
    s_waitcnt vmcnt(4)
    s_barrier
    s_waitcnt vmcnt(0)
    s_barrier
    s_mul_i32 s30, s21, 65536
    s_lshl_b32 s31, s25, 10
    s_add_u32 s30, s30, s31
    s_add_u32 s30, s30, 25165824
    v_lshlrev_b32 v2, 4, v0
    v_add_u32 v2, s30, v2
    s_mul_i32 s27, s25, 8192
    s_mul_i32 s26, s21, 256
    s_add_u32 s26, s26, 32768
    v_lshrrev_b32 v12, 4, v0
    v_min_u32 v12, 2, v12
    v_lshlrev_b32 v12, 11, v12
    v_and_b32 v13, 15, v0
    v_lshl_add_u32 v12, v13, 4, v12
    s_mov_b32 m0, 148480
    s_nop 0
    buffer_load_dwordx4 v12, s[12:15], s26 offen lds
    s_mov_b32 s54, 0
    s_add_u32 m0, s27, 2048
    s_add_u32 s26, s54, 0
    buffer_load_dwordx4 v2, s[12:15], s26 offen lds
    s_add_u32 m0, s27, 3072
    s_add_u32 s26, s54, 32768
    buffer_load_dwordx4 v2, s[12:15], s26 offen lds
    s_add_u32 m0, s27, 4096
    s_add_u32 s26, s54, 524288
    buffer_load_dwordx4 v2, s[12:15], s26 offen lds
    s_add_u32 m0, s27, 5120
    s_add_u32 s26, s54, 557056
    buffer_load_dwordx4 v2, s[12:15], s26 offen lds
    s_add_u32 m0, s27, 6144
    s_add_u32 s26, s54, 1048576
    buffer_load_dwordx4 v2, s[12:15], s26 offen lds
    s_add_u32 m0, s27, 7168
    s_add_u32 s26, s54, 1081344
    buffer_load_dwordx4 v2, s[12:15], s26 offen lds
    s_barrier
    s_mov_b32 s54, 4096
    s_add_u32 m0, s27, 34816
    s_add_u32 s26, s54, 0
    buffer_load_dwordx4 v2, s[12:15], s26 offen lds
    s_add_u32 m0, s27, 35840
    s_add_u32 s26, s54, 32768
    buffer_load_dwordx4 v2, s[12:15], s26 offen lds
    s_add_u32 m0, s27, 36864
    s_add_u32 s26, s54, 524288
    buffer_load_dwordx4 v2, s[12:15], s26 offen lds
    s_add_u32 m0, s27, 37888
    s_add_u32 s26, s54, 557056
    buffer_load_dwordx4 v2, s[12:15], s26 offen lds
    s_add_u32 m0, s27, 38912
    s_add_u32 s26, s54, 1048576
    buffer_load_dwordx4 v2, s[12:15], s26 offen lds
    s_add_u32 m0, s27, 39936
    s_add_u32 s26, s54, 1081344
    buffer_load_dwordx4 v2, s[12:15], s26 offen lds
    s_lshl_b32 s30, s20, 1
    s_mul_i32 s30, s30, 32768
    s_lshl_b32 s31, s25, 10
    s_add_u32 s30, s30, s31
    s_add_u32 s30, s30, 2097152
    v_lshlrev_b32 v4, 4, v0
    v_add_u32 v4, s30, v4
    v_add_u32 v5, 32768, v4
    s_barrier
    s_mov_b32 s54, 8192
    s_add_u32 m0, s27, 67584
    s_add_u32 s26, s54, 0
    buffer_load_dwordx4 v2, s[12:15], s26 offen lds
    s_add_u32 m0, s27, 68608
    s_add_u32 s26, s54, 32768
    buffer_load_dwordx4 v2, s[12:15], s26 offen lds
    s_add_u32 m0, s27, 69632
    s_add_u32 s26, s54, 524288
    buffer_load_dwordx4 v2, s[12:15], s26 offen lds
    s_add_u32 m0, s27, 70656
    s_add_u32 s26, s54, 557056
    buffer_load_dwordx4 v2, s[12:15], s26 offen lds
    s_add_u32 m0, s27, 71680
    s_add_u32 s26, s54, 1048576
    buffer_load_dwordx4 v2, s[12:15], s26 offen lds
    s_add_u32 m0, s27, 72704
    s_add_u32 s26, s54, 1081344
    buffer_load_dwordx4 v2, s[12:15], s26 offen lds
    s_mov_b32 s54, 12288
    s_add_u32 m0, s27, 100352
    s_add_u32 s26, s54, 0
    buffer_load_dwordx4 v2, s[12:15], s26 offen lds
    s_add_u32 m0, s27, 101376
    s_add_u32 s26, s54, 32768
    buffer_load_dwordx4 v2, s[12:15], s26 offen lds
    s_add_u32 m0, s27, 102400
    s_add_u32 s26, s54, 524288
    buffer_load_dwordx4 v2, s[12:15], s26 offen lds
    s_add_u32 m0, s27, 103424
    s_add_u32 s26, s54, 557056
    buffer_load_dwordx4 v2, s[12:15], s26 offen lds
    s_add_u32 m0, s27, 104448
    s_add_u32 s26, s54, 1048576
    buffer_load_dwordx4 v2, s[12:15], s26 offen lds
    s_add_u32 m0, s27, 105472
    s_add_u32 s26, s54, 1081344
    buffer_load_dwordx4 v2, s[12:15], s26 offen lds
    s_barrier
    s_lshl_b32 s26, s20, 13
    s_lshl_b32 s30, s25, 11
    s_add_u32 s26, s26, s30
    s_add_u32 s26, s26, 20709376
    s_add_u32 m0, s30, 149504
    v_lshlrev_b32 v12, 4, v0
    buffer_load_dwordx4 v12, s[12:15], s26 offen sc1 lds
    buffer_load_dwordx4 v12, s[12:15], s26 offen offset:1024 sc1 lds
    s_mov_b32 s54, 0
    s_add_u32 m0, s27, 0
    s_nop 0
    buffer_load_dwordx4 v4, s[12:15], s54 offen sc1 lds
    s_add_u32 m0, s27, 1024
    s_nop 0
    buffer_load_dwordx4 v5, s[12:15], s54 offen sc1 lds
    s_mov_b32 s54, 4096
    s_add_u32 m0, s27, 32768
    s_nop 0
    buffer_load_dwordx4 v4, s[12:15], s54 offen sc1 lds
    s_add_u32 m0, s27, 33792
    s_nop 0
    buffer_load_dwordx4 v5, s[12:15], s54 offen sc1 lds
    s_mov_b32 s54, 8192
    s_add_u32 m0, s27, 65536
    s_nop 0
    buffer_load_dwordx4 v4, s[12:15], s54 offen sc1 lds
    s_add_u32 m0, s27, 66560
    s_nop 0
    buffer_load_dwordx4 v5, s[12:15], s54 offen sc1 lds
    s_mov_b32 s54, 12288
    s_add_u32 m0, s27, 98304
    s_nop 0
    buffer_load_dwordx4 v4, s[12:15], s54 offen sc1 lds
    s_add_u32 m0, s27, 99328
    s_nop 0
    buffer_load_dwordx4 v5, s[12:15], s54 offen sc1 lds
    s_waitcnt vmcnt(6)
    s_barrier
    s_waitcnt vmcnt(4)
    s_barrier
    s_waitcnt vmcnt(2)
    s_barrier
    s_mov_b32 s54, 16384
    s_add_u32 m0, s27, 0
    s_nop 0
    buffer_load_dwordx4 v4, s[12:15], s54 offen sc1 lds
    s_add_u32 m0, s27, 1024
    s_nop 0
    buffer_load_dwordx4 v5, s[12:15], s54 offen sc1 lds
    s_mov_b32 s54, 16384
    s_add_u32 m0, s27, 2048
    s_add_u32 s26, s54, 0
    buffer_load_dwordx4 v2, s[12:15], s26 offen lds
    s_add_u32 m0, s27, 3072
    s_add_u32 s26, s54, 32768
    buffer_load_dwordx4 v2, s[12:15], s26 offen lds
    s_add_u32 m0, s27, 4096
    s_add_u32 s26, s54, 524288
    buffer_load_dwordx4 v2, s[12:15], s26 offen lds
    s_add_u32 m0, s27, 5120
    s_add_u32 s26, s54, 557056
    buffer_load_dwordx4 v2, s[12:15], s26 offen lds
    s_add_u32 m0, s27, 6144
    s_add_u32 s26, s54, 1048576
    buffer_load_dwordx4 v2, s[12:15], s26 offen lds
    s_add_u32 m0, s27, 7168
    s_add_u32 s26, s54, 1081344
    buffer_load_dwordx4 v2, s[12:15], s26 offen lds
    s_waitcnt vmcnt(8)
    s_barrier
    s_mov_b32 s54, 20480
    s_add_u32 m0, s27, 32768
    s_nop 0
    buffer_load_dwordx4 v4, s[12:15], s54 offen sc1 lds
    s_add_u32 m0, s27, 33792
    s_nop 0
    buffer_load_dwordx4 v5, s[12:15], s54 offen sc1 lds
    s_mov_b32 s54, 20480
    s_add_u32 m0, s27, 34816
    s_add_u32 s26, s54, 0
    buffer_load_dwordx4 v2, s[12:15], s26 offen lds
    s_add_u32 m0, s27, 35840
    s_add_u32 s26, s54, 32768
    buffer_load_dwordx4 v2, s[12:15], s26 offen lds
    s_add_u32 m0, s27, 36864
    s_add_u32 s26, s54, 524288
    buffer_load_dwordx4 v2, s[12:15], s26 offen lds
    s_add_u32 m0, s27, 37888
    s_add_u32 s26, s54, 557056
    buffer_load_dwordx4 v2, s[12:15], s26 offen lds
    s_add_u32 m0, s27, 38912
    s_add_u32 s26, s54, 1048576
    buffer_load_dwordx4 v2, s[12:15], s26 offen lds
    s_add_u32 m0, s27, 39936
    s_add_u32 s26, s54, 1081344
    buffer_load_dwordx4 v2, s[12:15], s26 offen lds
    s_waitcnt vmcnt(8)
    s_barrier
    s_mov_b32 s54, 24576
    s_add_u32 m0, s27, 65536
    s_nop 0
    buffer_load_dwordx4 v4, s[12:15], s54 offen sc1 lds
    s_add_u32 m0, s27, 66560
    s_nop 0
    buffer_load_dwordx4 v5, s[12:15], s54 offen sc1 lds
    s_mov_b32 s54, 24576
    s_add_u32 m0, s27, 67584
    s_add_u32 s26, s54, 0
    buffer_load_dwordx4 v2, s[12:15], s26 offen lds
    s_add_u32 m0, s27, 68608
    s_add_u32 s26, s54, 32768
    buffer_load_dwordx4 v2, s[12:15], s26 offen lds
    s_add_u32 m0, s27, 69632
    s_add_u32 s26, s54, 524288
    buffer_load_dwordx4 v2, s[12:15], s26 offen lds
    s_add_u32 m0, s27, 70656
    s_add_u32 s26, s54, 557056
    buffer_load_dwordx4 v2, s[12:15], s26 offen lds
    s_add_u32 m0, s27, 71680
    s_add_u32 s26, s54, 1048576
    buffer_load_dwordx4 v2, s[12:15], s26 offen lds
    s_add_u32 m0, s27, 72704
    s_add_u32 s26, s54, 1081344
    buffer_load_dwordx4 v2, s[12:15], s26 offen lds
    s_waitcnt vmcnt(8)
    s_barrier
    s_mov_b32 s54, 28672
    s_add_u32 m0, s27, 98304
    s_nop 0
    buffer_load_dwordx4 v4, s[12:15], s54 offen sc1 lds
    s_add_u32 m0, s27, 99328
    s_nop 0
    buffer_load_dwordx4 v5, s[12:15], s54 offen sc1 lds
    s_mov_b32 s54, 28672
    s_add_u32 m0, s27, 100352
    s_add_u32 s26, s54, 0
    buffer_load_dwordx4 v2, s[12:15], s26 offen lds
    s_add_u32 m0, s27, 101376
    s_add_u32 s26, s54, 32768
    buffer_load_dwordx4 v2, s[12:15], s26 offen lds
    s_add_u32 m0, s27, 102400
    s_add_u32 s26, s54, 524288
    buffer_load_dwordx4 v2, s[12:15], s26 offen lds
    s_add_u32 m0, s27, 103424
    s_add_u32 s26, s54, 557056
    buffer_load_dwordx4 v2, s[12:15], s26 offen lds
    s_add_u32 m0, s27, 104448
    s_add_u32 s26, s54, 1048576
    buffer_load_dwordx4 v2, s[12:15], s26 offen lds
    s_add_u32 m0, s27, 105472
    s_add_u32 s26, s54, 1081344
    buffer_load_dwordx4 v2, s[12:15], s26 offen lds
    s_waitcnt vmcnt(8)
    s_barrier
    s_waitcnt vmcnt(0)
    s_barrier
    s_endpgm
L_chain0_kernel_end:
    s_endpgm
.section .rodata,"a"
.p2align 6
.amdhsa_kernel chain0_kernel
  .amdhsa_next_free_vgpr 256
  .amdhsa_next_free_sgpr 64
  .amdhsa_accum_offset 256
  .amdhsa_group_segment_fixed_size 0
  .amdhsa_kernarg_size 88
  .amdhsa_user_sgpr_count 2
  .amdhsa_user_sgpr_kernarg_segment_ptr 1
  .amdhsa_system_sgpr_workgroup_id_x 1
  .amdhsa_float_denorm_mode_32 3
.end_amdhsa_kernel
.text
.text
.globl chain1_kernel
.p2align 8
.type chain1_kernel,@function
chain1_kernel:
    s_cmp_ge_u32 s2, 256
    s_cbranch_scc1 L_chain1_kernel_end
    s_load_dwordx2 s[6:7], s[0:1], 80
    s_load_dwordx2 s[4:5], s[0:1], 64
    v_lshrrev_b32 v1, 6, v0
    v_and_b32 v0, 63, v0
    s_and_b32 s30, s2, 7
    s_lshr_b32 s31, s2, 3
    v_readfirstlane_b32 s22, v1
    s_and_b32 s21, s31, 7
    s_lshr_b32 s31, s31, 3
    s_lshl_b32 s20, s30, 2
    s_add_u32 s20, s20, s31
    s_and_b32 s23, s22, 1
    s_bfe_u32 s24, s22, 0x10001
    s_and_b32 s25, s22, 3
    s_lshl_b32 s28, s20, 1
    s_add_u32 s28, s28, s23
    s_lshl_b32 s50, s20, 8
    s_add_u32 s50, s50, 1114112
    s_mov_b32 s29, 0
    s_waitcnt lgkmcnt(0)
    s_add_u32 s48, s6, s50
    s_addc_u32 s49, s7, 0
    s_mov_b32 s12, s6
    s_mov_b32 s13, s7
    s_mov_b32 s14, 0x2800000
    s_mov_b32 s15, 0x00020000
    s_mov_b32 s16, s4
    s_mov_b32 s17, s5
    s_mov_b32 s18, 0x200000
    s_mov_b32 s19, 0x00020000
    s_cmp_ge_u32 s22, 4
    s_cbranch_scc1 L_chain1_kernel_ld
    s_lshl_b32 s44, s21, 1
    s_add_u32 s44, s44, s24
    s_lshl_b32 s45, s44, 1
    v_lshlrev_b32 v14, 4, v0
    s_mul_i32 s32, s28, 32768
    s_lshl_b32 s33, s45, 10
    s_add_u32 s32, s32, s33
    s_add_u32 s32, s32, 2097152
    buffer_load_dwordx4 v[188:191], v14, s[12:15], s32 offen
    buffer_load_dwordx4 v[192:195], v14, s[12:15], s32 offen offset:1024
    s_cmp_lg_u32 s22, 3
    s_cbranch_scc1 L_chain1_kernel_cp1
    s_lshr_b32 s35, s2, 3
    s_getpc_b64 s[32:33]
L_pc_chain1_kernel:
    s_sub_u32 s32, s32, (L_pc_chain1_kernel - L_code_start)
    s_subb_u32 s33, s33, 0
    s_lshl_b32 s34, s35, 13
    v_lshlrev_b32 v246, 7, v0
    v_add_u32 v246, s34, v246
    v_min_u32 v246, (L_code_end - L_code_start - 4), v246
    global_load_dword v247, v246, s[32:33]
L_chain1_kernel_cp1:
    s_cmp_lg_u32 s22, 0
    s_cbranch_scc1 L_chain1_kernel_hs2
    s_getreg_b32 s34, hwreg(HW_REG_XCC_ID, 0, 3)
    s_lshl_b32 s34, s34, 2
    s_lshl_b32 s34, 1, s34
    s_mov_b64 s[40:41], exec
    s_mov_b64 exec, 1
    v_mov_b32 v2, s50
    v_mov_b32 v3, s34
    buffer_atomic_add v3, v2, s[12:15], 0 offen sc1
    s_mov_b64 exec, s[40:41]
L_chain1_kernel_hs2:
    s_mul_i32 s30, s24, 1024
    s_add_u32 s30, s30, 2048
    v_lshlrev_b32 v11, 4, v0
    v_add_u32 v8, s30, v11
    s_lshl_b32 s30, s23, 10
    v_add_u32 v11, s30, v11
    v_add_u32 v9, 65536, v8
    v_add_u32 v12, 65536, v11
    s_barrier
    ds_read_b128 v[124:127], v11 offset:0
    ds_read_b128 v[128:131], v8 offset:0
    ds_read_b128 v[132:135], v11 offset:4096
    ds_read_b128 v[136:139], v8 offset:4096
    ds_read_b128 v[140:143], v11 offset:8192
    ds_read_b128 v[144:147], v8 offset:8192
    ds_read_b128 v[148:151], v11 offset:12288
    ds_read_b128 v[152:155], v8 offset:12288
    s_barrier
    ds_read_b128 v[156:159], v11 offset:16384
    ds_read_b128 v[160:163], v8 offset:16384
    s_waitcnt lgkmcnt(8)
    v_mfma_f32_32x32x16_bf16 v[60:75], v[128:131], v[124:127], 0
    ds_read_b128 v[124:127], v11 offset:20480
    ds_read_b128 v[128:131], v8 offset:20480
    s_waitcnt lgkmcnt(8)
    v_mfma_f32_32x32x16_bf16 v[60:75], v[136:139], v[132:135], v[60:75]
    ds_read_b128 v[132:135], v11 offset:24576
    ds_read_b128 v[136:139], v8 offset:24576
    s_waitcnt lgkmcnt(8)
    v_mfma_f32_32x32x16_bf16 v[60:75], v[144:147], v[140:143], v[60:75]
    ds_read_b128 v[140:143], v11 offset:28672
    ds_read_b128 v[144:147], v8 offset:28672
    s_waitcnt lgkmcnt(8)
    v_mfma_f32_32x32x16_bf16 v[60:75], v[152:155], v[148:151], v[60:75]
    s_barrier
    v_mov_b32 v245, s50
    buffer_load_dword v244, v245, s[12:15], 0 offen sc1
    ds_read_b128 v[148:151], v11 offset:32768
    ds_read_b128 v[152:155], v8 offset:32768
    s_waitcnt lgkmcnt(8)
    v_mfma_f32_32x32x16_bf16 v[60:75], v[160:163], v[156:159], v[60:75]
    ds_read_b128 v[156:159], v11 offset:36864
    ds_read_b128 v[160:163], v8 offset:36864
    s_waitcnt lgkmcnt(8)
    v_mfma_f32_32x32x16_bf16 v[60:75], v[128:131], v[124:127], v[60:75]
    ds_read_b128 v[124:127], v11 offset:40960
    ds_read_b128 v[128:131], v8 offset:40960
    s_waitcnt lgkmcnt(8)
    v_mfma_f32_32x32x16_bf16 v[60:75], v[136:139], v[132:135], v[60:75]
    ds_read_b128 v[132:135], v11 offset:45056
    ds_read_b128 v[136:139], v8 offset:45056
    s_waitcnt lgkmcnt(8)
    v_mfma_f32_32x32x16_bf16 v[60:75], v[144:147], v[140:143], v[60:75]
    s_barrier
    ds_read_b128 v[140:143], v11 offset:49152
    ds_read_b128 v[144:147], v8 offset:49152
    s_waitcnt lgkmcnt(8)
    v_mfma_f32_32x32x16_bf16 v[60:75], v[152:155], v[148:151], v[60:75]
    ds_read_b128 v[148:151], v11 offset:53248
    ds_read_b128 v[152:155], v8 offset:53248
    s_waitcnt lgkmcnt(8)
    v_mfma_f32_32x32x16_bf16 v[60:75], v[160:163], v[156:159], v[60:75]
    ds_read_b128 v[156:159], v11 offset:57344
    ds_read_b128 v[160:163], v8 offset:57344
    s_waitcnt lgkmcnt(8)
    v_mfma_f32_32x32x16_bf16 v[60:75], v[128:131], v[124:127], v[60:75]
    ds_read_b128 v[124:127], v11 offset:61440
    ds_read_b128 v[128:131], v8 offset:61440
    s_waitcnt lgkmcnt(8)
    v_mfma_f32_32x32x16_bf16 v[60:75], v[136:139], v[132:135], v[60:75]
    s_barrier
    ds_read_b128 v[132:135], v12 offset:0
    ds_read_b128 v[136:139], v9 offset:0
    s_waitcnt lgkmcnt(8)
    v_mfma_f32_32x32x16_bf16 v[60:75], v[144:147], v[140:143], v[60:75]
    ds_read_b128 v[140:143], v12 offset:4096
    ds_read_b128 v[144:147], v9 offset:4096
    s_waitcnt lgkmcnt(8)
    v_mfma_f32_32x32x16_bf16 v[60:75], v[152:155], v[148:151], v[60:75]
    ds_read_b128 v[148:151], v12 offset:8192
    ds_read_b128 v[152:155], v9 offset:8192
    s_waitcnt lgkmcnt(8)
    v_mfma_f32_32x32x16_bf16 v[60:75], v[160:163], v[156:159], v[60:75]
    ds_read_b128 v[156:159], v12 offset:12288
    ds_read_b128 v[160:163], v9 offset:12288
    s_waitcnt lgkmcnt(8)
    v_mfma_f32_32x32x16_bf16 v[60:75], v[128:131], v[124:127], v[60:75]
    s_barrier
    ds_read_b128 v[124:127], v12 offset:16384
    ds_read_b128 v[128:131], v9 offset:16384
    s_waitcnt lgkmcnt(8)
    v_mfma_f32_32x32x16_bf16 v[60:75], v[136:139], v[132:135], v[60:75]
    ds_read_b128 v[132:135], v12 offset:20480
    ds_read_b128 v[136:139], v9 offset:20480
    s_waitcnt lgkmcnt(8)
    v_mfma_f32_32x32x16_bf16 v[60:75], v[144:147], v[140:143], v[60:75]
    ds_read_b128 v[140:143], v12 offset:24576
    ds_read_b128 v[144:147], v9 offset:24576
    s_waitcnt lgkmcnt(8)
    v_mfma_f32_32x32x16_bf16 v[60:75], v[152:155], v[148:151], v[60:75]
    ds_read_b128 v[148:151], v12 offset:28672
    ds_read_b128 v[152:155], v9 offset:28672
    s_waitcnt lgkmcnt(8)
    v_mfma_f32_32x32x16_bf16 v[60:75], v[160:163], v[156:159], v[60:75]
    s_barrier
    ds_read_b128 v[156:159], v12 offset:32768
    ds_read_b128 v[160:163], v9 offset:32768
    s_waitcnt lgkmcnt(8)
    v_mfma_f32_32x32x16_bf16 v[60:75], v[128:131], v[124:127], v[60:75]
    ds_read_b128 v[124:127], v12 offset:36864
    ds_read_b128 v[128:131], v9 offset:36864
    s_waitcnt lgkmcnt(8)
    v_mfma_f32_32x32x16_bf16 v[60:75], v[136:139], v[132:135], v[60:75]
    ds_read_b128 v[132:135], v12 offset:40960
    ds_read_b128 v[136:139], v9 offset:40960
    s_waitcnt lgkmcnt(8)
    v_mfma_f32_32x32x16_bf16 v[60:75], v[144:147], v[140:143], v[60:75]
    ds_read_b128 v[140:143], v12 offset:45056
    ds_read_b128 v[144:147], v9 offset:45056
    s_waitcnt lgkmcnt(8)
    v_mfma_f32_32x32x16_bf16 v[60:75], v[152:155], v[148:151], v[60:75]
    s_barrier
    s_waitcnt vmcnt(0)
    s_getreg_b32 s34, hwreg(HW_REG_XCC_ID, 0, 3)
    s_lshl_b32 s34, s34, 2
    s_lshl_b32 s34, 8, s34
    s_mov_b32 s47, 0
    s_branch L_chain1_kernel_hc5
L_chain1_kernel_hl3:
    buffer_load_dword v244, v245, s[12:15], 0 offen sc1
    s_waitcnt vmcnt(0)
L_chain1_kernel_hc5:
    v_readfirstlane_b32 s36, v244
    s_add_u32 s47, s47, 1
    s_cmp_gt_u32 s47, 262144
    s_cbranch_scc1 L_chain1_kernel_hd4
    s_and_b32 s37, s36, 0x0f0f0f0f
    s_lshr_b32 s38, s36, 4
    s_and_b32 s38, s38, 0x0f0f0f0f
    s_add_u32 s37, s37, s38
    s_mul_i32 s37, s37, 0x01010101
    s_lshr_b32 s37, s37, 24
    s_cmp_lt_u32 s37, 8
    s_cbranch_scc1 L_chain1_kernel_hl3
L_chain1_kernel_hd4:
    s_cmp_eq_u32 s36, s34
    s_cselect_b32 s29, 1, 0
    v_lshlrev_b32 v28, 16, v188
    v_and_b32 v29, 0xffff0000, v188
    v_lshlrev_b32 v30, 16, v189
    v_and_b32 v31, 0xffff0000, v189
    v_lshlrev_b32 v32, 16, v190
    v_and_b32 v33, 0xffff0000, v190
    v_lshlrev_b32 v34, 16, v191
    v_and_b32 v35, 0xffff0000, v191
    v_lshlrev_b32 v36, 16, v192
    v_and_b32 v37, 0xffff0000, v192
    v_lshlrev_b32 v38, 16, v193
    v_and_b32 v39, 0xffff0000, v193
    v_lshlrev_b32 v40, 16, v194
    v_and_b32 v41, 0xffff0000, v194
    v_lshlrev_b32 v42, 16, v195
    v_and_b32 v43, 0xffff0000, v195
    ds_read_b128 v[148:151], v12 offset:49152
    ds_read_b128 v[152:155], v9 offset:49152
    s_waitcnt lgkmcnt(8)
    v_mfma_f32_32x32x16_bf16 v[60:75], v[160:163], v[156:159], v[60:75]
    ds_read_b128 v[156:159], v12 offset:53248
    ds_read_b128 v[160:163], v9 offset:53248
    s_waitcnt lgkmcnt(8)
    v_mfma_f32_32x32x16_bf16 v[60:75], v[128:131], v[124:127], v[60:75]
    ds_read_b128 v[124:127], v12 offset:57344
    ds_read_b128 v[128:131], v9 offset:57344
    s_waitcnt lgkmcnt(8)
    v_mfma_f32_32x32x16_bf16 v[60:75], v[136:139], v[132:135], v[60:75]
    ds_read_b128 v[132:135], v12 offset:61440
    ds_read_b128 v[136:139], v9 offset:61440
    s_waitcnt lgkmcnt(8)
    v_mfma_f32_32x32x16_bf16 v[60:75], v[144:147], v[140:143], v[60:75]
    s_waitcnt lgkmcnt(6)
    v_mfma_f32_32x32x16_bf16 v[60:75], v[152:155], v[148:151], v[60:75]
    s_waitcnt lgkmcnt(4)
    v_mfma_f32_32x32x16_bf16 v[60:75], v[160:163], v[156:159], v[60:75]
    s_waitcnt lgkmcnt(2)
    v_mfma_f32_32x32x16_bf16 v[60:75], v[128:131], v[124:127], v[60:75]
    s_waitcnt lgkmcnt(0)
    v_mfma_f32_32x32x16_bf16 v[60:75], v[136:139], v[132:135], v[60:75]
    s_barrier
    s_mul_i32 s32, s28, 32768
    s_lshl_b32 s33, s45, 10
    s_add_u32 s32, s32, s33
    s_add_u32 s32, s32, 2097152
    s_nop 7
    v_pk_add_f32 v[28:29], v[28:29], v[60:61]
    v_pk_add_f32 v[30:31], v[30:31], v[62:63]
    v_pk_add_f32 v[32:33], v[32:33], v[64:65]
    v_pk_add_f32 v[34:35], v[34:35], v[66:67]
    v_pk_add_f32 v[36:37], v[36:37], v[68:69]
    v_pk_add_f32 v[38:39], v[38:39], v[70:71]
    v_pk_add_f32 v[40:41], v[40:41], v[72:73]
    v_pk_add_f32 v[42:43], v[42:43], v[74:75]
    v_cvt_pk_bf16_f32 v236, v28, v29
    v_cvt_pk_bf16_f32 v237, v30, v31
    v_cvt_pk_bf16_f32 v238, v32, v33
    v_cvt_pk_bf16_f32 v239, v34, v35
    v_cvt_pk_bf16_f32 v240, v36, v37
    v_cvt_pk_bf16_f32 v241, v38, v39
    v_cvt_pk_bf16_f32 v242, v40, v41
    v_cvt_pk_bf16_f32 v243, v42, v43
    s_cmp_eq_u32 s29, 1
    s_cbranch_scc1 L_chain1_kernel_sf6
    buffer_store_dwordx4 v[236:239], v14, s[12:15], s32 offen offset:0 sc1
    buffer_store_dwordx4 v[240:243], v14, s[12:15], s32 offen offset:1024 sc1
    s_branch L_chain1_kernel_sd7
L_chain1_kernel_sf6:
    buffer_store_dwordx4 v[236:239], v14, s[12:15], s32 offen offset:0
    buffer_store_dwordx4 v[240:243], v14, s[12:15], s32 offen offset:1024
L_chain1_kernel_sd7:
    v_pk_add_f32 v[2:3], v[28:29], v[30:31]
    v_pk_mul_f32 v[4:5], v[28:29], v[28:29]
    v_pk_fma_f32 v[4:5], v[30:31], v[30:31], v[4:5]
    v_pk_add_f32 v[2:3], v[2:3], v[32:33]
    v_pk_fma_f32 v[4:5], v[32:33], v[32:33], v[4:5]
    v_pk_add_f32 v[2:3], v[2:3], v[34:35]
    v_pk_fma_f32 v[4:5], v[34:35], v[34:35], v[4:5]
    v_pk_add_f32 v[2:3], v[2:3], v[36:37]
    v_pk_fma_f32 v[4:5], v[36:37], v[36:37], v[4:5]
    v_pk_add_f32 v[2:3], v[2:3], v[38:39]
    v_pk_fma_f32 v[4:5], v[38:39], v[38:39], v[4:5]
    v_pk_add_f32 v[2:3], v[2:3], v[40:41]
    v_pk_fma_f32 v[4:5], v[40:41], v[40:41], v[4:5]
    v_pk_add_f32 v[2:3], v[2:3], v[42:43]
    v_pk_fma_f32 v[4:5], v[42:43], v[42:43], v[4:5]
    v_add_f32 v2, v2, v3
    v_add_f32 v3, v4, v5
    s_nop 1
    v_permlane32_swap_b32 v2, v3
    s_nop 1
    v_add_f32 v2, v2, v3
    s_lshl_b32 s34, s28, 12
    s_lshl_b32 s35, s44, 8
    s_add_u32 s34, s34, s35
    s_add_u32 s34, s34, 20185088
    v_lshlrev_b32 v4, 2, v0
    s_cmp_eq_u32 s29, 1
    s_cbranch_scc1 L_chain1_kernel_sf8
    buffer_store_dword v2, v4, s[12:15], s34 offen sc1
    s_branch L_chain1_kernel_sd9
L_chain1_kernel_sf8:
    buffer_store_dword v2, v4, s[12:15], s34 offen
L_chain1_kernel_sd9:
    s_waitcnt vmcnt(0)
    s_barrier
    s_cmp_lg_u32 s22, 0
    s_cbranch_scc1 L_chain1_kernel_ya10
    s_mov_b64 s[40:41], exec
    s_cmp_eq_u32 s29, 1
    s_cbranch_scc0 L_chain1_kernel_yb11
    s_mov_b32 s30, 1
    s_atomic_add s30, s[48:49], 0x2000
    s_branch L_chain1_kernel_yc12
L_chain1_kernel_yb11:
    s_add_u32 s30, s50, 8192
    s_mov_b64 exec, 1
    v_mov_b32 v2, s30
    v_mov_b32 v3, 1
    buffer_atomic_add v3, v2, s[12:15], 0 offen sc1
L_chain1_kernel_yc12:
    s_mov_b64 exec, s[40:41]
L_chain1_kernel_ya10:
    s_cmp_lg_u32 s22, 0
    s_cbranch_scc1 L_chain1_kernel_yk13
    s_mov_b64 s[40:41], exec
    s_cmp_eq_u32 s29, 1
    s_cbranch_scc0 L_chain1_kernel_ys14
    s_mov_b32 s47, 0
L_chain1_kernel_yl16:
    s_mov_b32 s31, 0
    s_atomic_add s31, s[48:49], 0x2000 glc
    s_add_u32 s47, s47, 1
    s_cmp_gt_u32 s47, 262144
    s_cbranch_scc1 L_chain1_kernel_ye17
    s_waitcnt lgkmcnt(0)
    s_cmp_ge_u32 s31, 8
    s_cbranch_scc0 L_chain1_kernel_yl16
L_chain1_kernel_ye17:
    s_waitcnt lgkmcnt(0)
    s_branch L_chain1_kernel_yd15
L_chain1_kernel_ys14:
    s_add_u32 s30, s50, 8192
    s_mov_b64 exec, 1
    v_mov_b32 v2, s30
    v_mov_b32 v3, 8
    s_mov_b32 s47, 0
L_chain1_kernel_pl18:
    buffer_load_dword v4, v2, s[12:15], 0 offen sc1
    s_add_u32 s47, s47, 1
    s_cmp_gt_u32 s47, 262144
    s_cbranch_scc1 L_chain1_kernel_pd19
    s_waitcnt vmcnt(0)
    v_cmp_ge_u32 vcc, v4, v3
    s_nop 1
    s_cmp_eq_u32 vcc_lo, 1
    s_cbranch_scc0 L_chain1_kernel_pl18
L_chain1_kernel_pd19:
    s_waitcnt vmcnt(0)
L_chain1_kernel_yd15:
    s_mov_b64 exec, s[40:41]
L_chain1_kernel_yk13:
    s_barrier
    s_mul_i32 s30, s24, 1024
    s_add_u32 s30, s30, 2048
    v_lshlrev_b32 v11, 4, v0
    v_add_u32 v8, s30, v11
    s_lshl_b32 s30, s23, 10
    v_add_u32 v11, s30, v11
    v_add_u32 v9, 65536, v8
    v_add_u32 v12, 65536, v11
    s_barrier
    ds_read_b128 v[124:127], v11 offset:0
    ds_read_b128 v[128:131], v8 offset:0
    ds_read_b128 v[132:135], v11 offset:4096
    ds_read_b128 v[136:139], v8 offset:4096
    ds_read_b128 v[140:143], v11 offset:8192
    ds_read_b128 v[144:147], v8 offset:8192
    ds_read_b128 v[148:151], v11 offset:12288
    ds_read_b128 v[152:155], v8 offset:12288
    s_waitcnt lgkmcnt(0)
    s_lshl_b32 s30, s23, 12
    s_add_u32 s30, s30, 149504
    v_lshlrev_b32 v2, 2, v0
    v_add_u32 v2, s30, v2
    ds_read2st64_b32 v[188:189], v2 offset0:0 offset1:1
    ds_read2st64_b32 v[190:191], v2 offset0:2 offset1:3
    ds_read2st64_b32 v[192:193], v2 offset0:4 offset1:5
    ds_read2st64_b32 v[194:195], v2 offset0:6 offset1:7
    ds_read2st64_b32 v[196:197], v2 offset0:8 offset1:9
    ds_read2st64_b32 v[198:199], v2 offset0:10 offset1:11
    ds_read2st64_b32 v[200:201], v2 offset0:12 offset1:13
    ds_read2st64_b32 v[202:203], v2 offset0:14 offset1:15
    s_lshl_b32 s33, s24, 7
    s_add_u32 s33, s33, 148480
    v_lshrrev_b32 v3, 5, v0
    v_lshlrev_b32 v3, 4, v3
    v_add_u32 v15, s33, v3
    ds_read_b128 v[204:207], v15 offset:0
    ds_read_b128 v[208:211], v15 offset:32
    ds_read_b128 v[212:215], v15 offset:64
    ds_read_b128 v[216:219], v15 offset:96
    s_waitcnt lgkmcnt(0)
    v_add_f32 v188, v188, v196
    v_add_f32 v189, v189, v197
    v_add_f32 v190, v190, v198
    v_add_f32 v191, v191, v199
    v_add_f32 v192, v192, v200
    v_add_f32 v193, v193, v201
    v_add_f32 v194, v194, v202
    v_add_f32 v195, v195, v203
    v_add_f32 v188, v188, v192
    v_add_f32 v189, v189, v193
    v_add_f32 v190, v190, v194
    v_add_f32 v191, v191, v195
    v_add_f32 v188, v188, v190
    v_add_f32 v189, v189, v191
    v_add_f32 v188, v188, v189
    v_mov_b32 v189, v188
    s_nop 1
    v_permlane32_swap_b32 v188, v189
    s_nop 1
    v_mul_f32 v16, 0x3b000000, v188
    v_mul_f32 v25, 0x3b000000, v189
    v_fma_f32 v25, -v16, v16, v25
    v_max_f32 v25, 0, v25
    v_add_f32 v17, 0x3727c5ac, v25
    v_rsq_f32 v17, v17
    s_nop 0
    v_mul_f32 v27, v17, v17
    v_mul_f32 v27, v27, v25
    v_add_f32 v27, 0x3727c5ac, v27
    v_rsq_f32 v27, v27
    s_nop 0
    v_mul_f32 v18, v17, v27
    v_mul_f32_e64 v19, -v16, v18
    v_mov_b32 v22, 0xc0135761
    v_mov_b32 v23, 0xbdd2d3e8
    v_pk_mul_f32 v[204:205], v[204:205], v[18:19] op_sel:[0,1] op_sel_hi:[1,1]
    v_pk_mul_f32 v[206:207], v[206:207], v[18:19] op_sel:[0,1] op_sel_hi:[1,1]
    v_pk_mul_f32 v[208:209], v[208:209], v[18:19] op_sel:[0,1] op_sel_hi:[1,1]
    v_pk_mul_f32 v[210:211], v[210:211], v[18:19] op_sel:[0,1] op_sel_hi:[1,1]
    v_pk_mul_f32 v[212:213], v[212:213], v[18:19] op_sel:[0,1] op_sel_hi:[1,1]
    v_pk_mul_f32 v[214:215], v[214:215], v[18:19] op_sel:[0,1] op_sel_hi:[1,1]
    v_pk_mul_f32 v[216:217], v[216:217], v[18:19] op_sel:[0,1] op_sel_hi:[1,1]
    v_pk_mul_f32 v[218:219], v[218:219], v[18:19] op_sel:[0,1] op_sel_hi:[1,1]
    s_barrier
    ds_read_b128 v[156:159], v11 offset:16384
    ds_read_b128 v[160:163], v8 offset:16384
    v_mfma_f32_32x32x16_bf16 v[60:75], v[128:131], v[124:127], 0
    ds_read_b128 v[124:127], v11 offset:20480
    ds_read_b128 v[128:131], v8 offset:20480
    v_mfma_f32_32x32x16_bf16 v[60:75], v[136:139], v[132:135], v[60:75]
    ds_read_b128 v[132:135], v11 offset:24576
    ds_read_b128 v[136:139], v8 offset:24576
    v_mfma_f32_32x32x16_bf16 v[60:75], v[144:147], v[140:143], v[60:75]
    ds_read_b128 v[140:143], v11 offset:28672
    ds_read_b128 v[144:147], v8 offset:28672
    v_mfma_f32_32x32x16_bf16 v[60:75], v[152:155], v[148:151], v[60:75]
    s_barrier
    ds_read_b128 v[148:151], v11 offset:32768
    ds_read_b128 v[152:155], v8 offset:32768
    s_waitcnt lgkmcnt(8)
    v_mfma_f32_32x32x16_bf16 v[60:75], v[160:163], v[156:159], v[60:75]
    ds_read_b128 v[156:159], v11 offset:36864
    ds_read_b128 v[160:163], v8 offset:36864
    s_waitcnt lgkmcnt(8)
    v_mfma_f32_32x32x16_bf16 v[60:75], v[128:131], v[124:127], v[60:75]
    ds_read_b128 v[124:127], v11 offset:40960
    ds_read_b128 v[128:131], v8 offset:40960
    s_waitcnt lgkmcnt(8)
    v_mfma_f32_32x32x16_bf16 v[60:75], v[136:139], v[132:135], v[60:75]
    ds_read_b128 v[132:135], v11 offset:45056
    ds_read_b128 v[136:139], v8 offset:45056
    s_waitcnt lgkmcnt(8)
    v_mfma_f32_32x32x16_bf16 v[60:75], v[144:147], v[140:143], v[60:75]
    s_barrier
    ds_read_b128 v[140:143], v11 offset:49152
    ds_read_b128 v[144:147], v8 offset:49152
    s_waitcnt lgkmcnt(8)
    v_mfma_f32_32x32x16_bf16 v[60:75], v[152:155], v[148:151], v[60:75]
    ds_read_b128 v[148:151], v11 offset:53248
    ds_read_b128 v[152:155], v8 offset:53248
    s_waitcnt lgkmcnt(8)
    v_mfma_f32_32x32x16_bf16 v[60:75], v[160:163], v[156:159], v[60:75]
    ds_read_b128 v[156:159], v11 offset:57344
    ds_read_b128 v[160:163], v8 offset:57344
    s_waitcnt lgkmcnt(8)
    v_mfma_f32_32x32x16_bf16 v[60:75], v[128:131], v[124:127], v[60:75]
    ds_read_b128 v[124:127], v11 offset:61440
    ds_read_b128 v[128:131], v8 offset:61440
    s_waitcnt lgkmcnt(8)
    v_mfma_f32_32x32x16_bf16 v[60:75], v[136:139], v[132:135], v[60:75]
    s_barrier
    ds_read_b128 v[132:135], v12 offset:0
    ds_read_b128 v[136:139], v9 offset:0
    s_waitcnt lgkmcnt(8)
    v_mfma_f32_32x32x16_bf16 v[60:75], v[144:147], v[140:143], v[60:75]
    ds_read_b128 v[140:143], v12 offset:4096
    ds_read_b128 v[144:147], v9 offset:4096
    s_waitcnt lgkmcnt(8)
    v_mfma_f32_32x32x16_bf16 v[60:75], v[152:155], v[148:151], v[60:75]
    ds_read_b128 v[148:151], v12 offset:8192
    ds_read_b128 v[152:155], v9 offset:8192
    s_waitcnt lgkmcnt(8)
    v_mfma_f32_32x32x16_bf16 v[60:75], v[160:163], v[156:159], v[60:75]
    ds_read_b128 v[156:159], v12 offset:12288
    ds_read_b128 v[160:163], v9 offset:12288
    s_waitcnt lgkmcnt(8)
    v_mfma_f32_32x32x16_bf16 v[60:75], v[128:131], v[124:127], v[60:75]
    s_barrier
    ds_read_b128 v[124:127], v12 offset:16384
    ds_read_b128 v[128:131], v9 offset:16384
    s_waitcnt lgkmcnt(8)
    v_mfma_f32_32x32x16_bf16 v[60:75], v[136:139], v[132:135], v[60:75]
    ds_read_b128 v[132:135], v12 offset:20480
    ds_read_b128 v[136:139], v9 offset:20480
    s_waitcnt lgkmcnt(8)
    v_mfma_f32_32x32x16_bf16 v[60:75], v[144:147], v[140:143], v[60:75]
    ds_read_b128 v[140:143], v12 offset:24576
    ds_read_b128 v[144:147], v9 offset:24576
    s_waitcnt lgkmcnt(8)
    v_mfma_f32_32x32x16_bf16 v[60:75], v[152:155], v[148:151], v[60:75]
    ds_read_b128 v[148:151], v12 offset:28672
    ds_read_b128 v[152:155], v9 offset:28672
    s_waitcnt lgkmcnt(8)
    v_mfma_f32_32x32x16_bf16 v[60:75], v[160:163], v[156:159], v[60:75]
    s_barrier
    ds_read_b128 v[156:159], v12 offset:32768
    ds_read_b128 v[160:163], v9 offset:32768
    s_waitcnt lgkmcnt(8)
    v_mfma_f32_32x32x16_bf16 v[60:75], v[128:131], v[124:127], v[60:75]
    ds_read_b128 v[124:127], v12 offset:36864
    ds_read_b128 v[128:131], v9 offset:36864
    s_waitcnt lgkmcnt(8)
    v_mfma_f32_32x32x16_bf16 v[60:75], v[136:139], v[132:135], v[60:75]
    ds_read_b128 v[132:135], v12 offset:40960
    ds_read_b128 v[136:139], v9 offset:40960
    s_waitcnt lgkmcnt(8)
    v_mfma_f32_32x32x16_bf16 v[60:75], v[144:147], v[140:143], v[60:75]
    ds_read_b128 v[140:143], v12 offset:45056
    ds_read_b128 v[144:147], v9 offset:45056
    s_waitcnt lgkmcnt(8)
    v_mfma_f32_32x32x16_bf16 v[60:75], v[152:155], v[148:151], v[60:75]
    s_barrier
    ds_read_b128 v[148:151], v12 offset:49152
    ds_read_b128 v[152:155], v9 offset:49152
    s_waitcnt lgkmcnt(8)
    v_mfma_f32_32x32x16_bf16 v[60:75], v[160:163], v[156:159], v[60:75]
    ds_read_b128 v[156:159], v12 offset:53248
    ds_read_b128 v[160:163], v9 offset:53248
    s_waitcnt lgkmcnt(8)
    v_mfma_f32_32x32x16_bf16 v[60:75], v[128:131], v[124:127], v[60:75]
    ds_read_b128 v[124:127], v12 offset:57344
    ds_read_b128 v[128:131], v9 offset:57344
    s_waitcnt lgkmcnt(8)
    v_mfma_f32_32x32x16_bf16 v[60:75], v[136:139], v[132:135], v[60:75]
    ds_read_b128 v[132:135], v12 offset:61440
    ds_read_b128 v[136:139], v9 offset:61440
    s_waitcnt lgkmcnt(8)
    v_mfma_f32_32x32x16_bf16 v[60:75], v[144:147], v[140:143], v[60:75]
    s_waitcnt lgkmcnt(6)
    v_mfma_f32_32x32x16_bf16 v[60:75], v[152:155], v[148:151], v[60:75]
    s_waitcnt lgkmcnt(4)
    v_mfma_f32_32x32x16_bf16 v[60:75], v[160:163], v[156:159], v[60:75]
    s_waitcnt lgkmcnt(2)
    v_mfma_f32_32x32x16_bf16 v[60:75], v[128:131], v[124:127], v[60:75]
    s_waitcnt lgkmcnt(0)
    v_mfma_f32_32x32x16_bf16 v[60:75], v[136:139], v[132:135], v[60:75]
    s_barrier
    s_mul_i32 s32, s28, 32768
    s_lshl_b32 s33, s45, 10
    s_add_u32 s32, s32, s33
    s_add_u32 s32, s32, 4194304
    s_nop 7
    v_pk_fma_f32 v[60:61], v[60:61], v[18:19], v[204:205] op_sel:[0,0,0] op_sel_hi:[1,0,1]
    v_pk_fma_f32 v[62:63], v[62:63], v[18:19], v[206:207] op_sel:[0,0,0] op_sel_hi:[1,0,1]
    v_pk_fma_f32 v[64:65], v[64:65], v[18:19], v[208:209] op_sel:[0,0,0] op_sel_hi:[1,0,1]
    v_pk_fma_f32 v[66:67], v[66:67], v[18:19], v[210:211] op_sel:[0,0,0] op_sel_hi:[1,0,1]
    v_pk_fma_f32 v[68:69], v[68:69], v[18:19], v[212:213] op_sel:[0,0,0] op_sel_hi:[1,0,1]
    v_pk_fma_f32 v[70:71], v[70:71], v[18:19], v[214:215] op_sel:[0,0,0] op_sel_hi:[1,0,1]
    v_pk_fma_f32 v[72:73], v[72:73], v[18:19], v[216:217] op_sel:[0,0,0] op_sel_hi:[1,0,1]
    v_pk_fma_f32 v[74:75], v[74:75], v[18:19], v[218:219] op_sel:[0,0,0] op_sel_hi:[1,0,1]
    v_pk_mul_f32 v[124:125], v[60:61], v[60:61]
    v_pk_mul_f32 v[126:127], v[62:63], v[62:63]
    v_pk_mul_f32 v[128:129], v[64:65], v[64:65]
    v_pk_mul_f32 v[130:131], v[66:67], v[66:67]
    v_pk_mul_f32 v[132:133], v[68:69], v[68:69]
    v_pk_mul_f32 v[134:135], v[70:71], v[70:71]
    v_pk_mul_f32 v[136:137], v[72:73], v[72:73]
    v_pk_mul_f32 v[138:139], v[74:75], v[74:75]
    v_pk_fma_f32 v[124:125], v[124:125], v[22:23], v[22:23] op_sel:[0,1,0] op_sel_hi:[1,1,0]
    v_pk_fma_f32 v[126:127], v[126:127], v[22:23], v[22:23] op_sel:[0,1,0] op_sel_hi:[1,1,0]
    v_pk_fma_f32 v[128:129], v[128:129], v[22:23], v[22:23] op_sel:[0,1,0] op_sel_hi:[1,1,0]
    v_pk_fma_f32 v[130:131], v[130:131], v[22:23], v[22:23] op_sel:[0,1,0] op_sel_hi:[1,1,0]
    v_pk_fma_f32 v[132:133], v[132:133], v[22:23], v[22:23] op_sel:[0,1,0] op_sel_hi:[1,1,0]
    v_pk_fma_f32 v[134:135], v[134:135], v[22:23], v[22:23] op_sel:[0,1,0] op_sel_hi:[1,1,0]
    v_pk_fma_f32 v[136:137], v[136:137], v[22:23], v[22:23] op_sel:[0,1,0] op_sel_hi:[1,1,0]
    v_pk_fma_f32 v[138:139], v[138:139], v[22:23], v[22:23] op_sel:[0,1,0] op_sel_hi:[1,1,0]
    v_pk_mul_f32 v[124:125], v[124:125], v[60:61]
    v_pk_mul_f32 v[126:127], v[126:127], v[62:63]
    v_pk_mul_f32 v[128:129], v[128:129], v[64:65]
    v_pk_mul_f32 v[130:131], v[130:131], v[66:67]
    v_pk_mul_f32 v[132:133], v[132:133], v[68:69]
    v_pk_mul_f32 v[134:135], v[134:135], v[70:71]
    v_pk_mul_f32 v[136:137], v[136:137], v[72:73]
    v_pk_mul_f32 v[138:139], v[138:139], v[74:75]
    v_exp_f32 v124, v124
    v_exp_f32 v125, v125
    v_exp_f32 v126, v126
    v_exp_f32 v127, v127
    v_exp_f32 v128, v128
    v_exp_f32 v129, v129
    v_exp_f32 v130, v130
    v_exp_f32 v131, v131
    v_exp_f32 v132, v132
    v_exp_f32 v133, v133
    v_exp_f32 v134, v134
    v_exp_f32 v135, v135
    v_exp_f32 v136, v136
    v_exp_f32 v137, v137
    v_exp_f32 v138, v138
    v_exp_f32 v139, v139
    v_pk_add_f32 v[124:125], v[124:125], 1.0 op_sel_hi:[1,0]
    v_pk_add_f32 v[126:127], v[126:127], 1.0 op_sel_hi:[1,0]
    v_pk_add_f32 v[128:129], v[128:129], 1.0 op_sel_hi:[1,0]
    v_pk_add_f32 v[130:131], v[130:131], 1.0 op_sel_hi:[1,0]
    v_pk_add_f32 v[132:133], v[132:133], 1.0 op_sel_hi:[1,0]
    v_pk_add_f32 v[134:135], v[134:135], 1.0 op_sel_hi:[1,0]
    v_pk_add_f32 v[136:137], v[136:137], 1.0 op_sel_hi:[1,0]
    v_pk_add_f32 v[138:139], v[138:139], 1.0 op_sel_hi:[1,0]
    v_rcp_f32 v124, v124
    v_rcp_f32 v125, v125
    v_rcp_f32 v126, v126
    v_rcp_f32 v127, v127
    v_rcp_f32 v128, v128
    v_rcp_f32 v129, v129
    v_rcp_f32 v130, v130
    v_rcp_f32 v131, v131
    v_rcp_f32 v132, v132
    v_rcp_f32 v133, v133
    v_rcp_f32 v134, v134
    v_rcp_f32 v135, v135
    v_rcp_f32 v136, v136
    v_rcp_f32 v137, v137
    v_rcp_f32 v138, v138
    v_rcp_f32 v139, v139
    v_pk_mul_f32 v[60:61], v[60:61], v[124:125]
    v_pk_mul_f32 v[62:63], v[62:63], v[126:127]
    v_pk_mul_f32 v[64:65], v[64:65], v[128:129]
    v_pk_mul_f32 v[66:67], v[66:67], v[130:131]
    v_pk_mul_f32 v[68:69], v[68:69], v[132:133]
    v_pk_mul_f32 v[70:71], v[70:71], v[134:135]
    v_pk_mul_f32 v[72:73], v[72:73], v[136:137]
    v_pk_mul_f32 v[74:75], v[74:75], v[138:139]
    v_cvt_pk_bf16_f32 v236, v60, v61
    v_cvt_pk_bf16_f32 v237, v62, v63
    v_cvt_pk_bf16_f32 v238, v64, v65
    v_cvt_pk_bf16_f32 v239, v66, v67
    v_cvt_pk_bf16_f32 v240, v68, v69
    v_cvt_pk_bf16_f32 v241, v70, v71
    v_cvt_pk_bf16_f32 v242, v72, v73
    v_cvt_pk_bf16_f32 v243, v74, v75
    s_cmp_eq_u32 s29, 1
    s_cbranch_scc1 L_chain1_kernel_sf20
    buffer_store_dwordx4 v[236:239], v14, s[12:15], s32 offen offset:0 sc1
    buffer_store_dwordx4 v[240:243], v14, s[12:15], s32 offen offset:1024 sc1
    s_branch L_chain1_kernel_sd21
L_chain1_kernel_sf20:
    buffer_store_dwordx4 v[236:239], v14, s[12:15], s32 offen offset:0
    buffer_store_dwordx4 v[240:243], v14, s[12:15], s32 offen offset:1024
L_chain1_kernel_sd21:
    s_bfe_u32 s34, s21, 0x10001
    s_xor_b32 s35, s34, 1
    s_cmp_lg_u32 s35, s23
    s_cbranch_scc1 L_chain1_kernel_nh22
    s_mul_i32 s35, s35, 30
    v_and_b32 v2, 31, v0
    v_subrev_u32 v2, s35, v2
    v_cmp_gt_u32 vcc, 2, v2
    v_lshlrev_b32 v2, 4, v2
    v_lshrrev_b32 v3, 5, v0
    v_lshl_add_u32 v2, v3, 5, v2
    s_lshl_b32 s36, s20, 11
    s_lshl_b32 s37, s45, 6
    s_add_u32 s36, s36, s37
    s_add_u32 s36, s36, 21037056
    s_and_saveexec_b64 s[40:41], vcc
    buffer_store_dwordx4 v[236:239], v2, s[12:15], s36 offen sc1
    buffer_store_dwordx4 v[240:243], v2, s[12:15], s36 offen offset:64 sc1
    s_mov_b64 exec, s[40:41]
    s_waitcnt vmcnt(2)
    s_branch L_chain1_kernel_hd23
L_chain1_kernel_nh22:
    s_waitcnt vmcnt(0)
L_chain1_kernel_hd23:
    s_barrier
    s_cmp_lg_u32 s22, 1
    s_cbranch_scc1 L_chain1_kernel_w124
    v_lshrrev_b32 v2, 2, v0
    v_add_u32 v2, 0, v2
    v_bfe_u32 v3, v0, 1, 1
    v_and_b32 v4, 1, v0
    v_bfe_u32 v5, v2, 3, 1
    v_lshlrev_b32 v6, 12, v5
    s_lshl_b32 s30, s20, 11
    s_add_u32 s30, s30, 21035008
    v_add_u32 v6, s30, v6
    v_lshl_add_u32 v6, v2, 6, v6
    v_lshl_add_u32 v6, v3, 5, v6
    v_lshl_add_u32 v196, v4, 4, v6
    v_lshrrev_b32 v6, 2, v2
    v_lshlrev_b32 v6, 14, v6
    v_and_b32 v7, 3, v2
    v_lshl_add_u32 v6, v7, 12, v6
    v_lshl_add_u32 v6, v5, 10, v6
    v_lshl_add_u32 v6, v3, 9, v6
    v_mul_u32_u24 v7, 31, v5
    v_lshl_add_u32 v198, v7, 4, v6
    v_xor_b32 v200, v4, v5
    s_cmp_eq_u32 s20, 0
    s_cselect_b32 s30, 1, 0
    s_cmp_eq_u32 s20, 31
    s_cselect_b32 s31, 1, 0
    v_mov_b32 v6, s30
    v_mov_b32 v7, s31
    v_cmp_eq_u32 vcc, 1, v5
    s_nop 1
    v_cndmask_b32 v6, v6, v7, vcc
    v_lshlrev_b32 v6, v6, v200
    v_mov_b32 v200, v6
    v_lshrrev_b32 v2, 2, v0
    v_add_u32 v2, 16, v2
    v_bfe_u32 v3, v0, 1, 1
    v_and_b32 v4, 1, v0
    v_bfe_u32 v5, v2, 3, 1
    v_lshlrev_b32 v6, 12, v5
    s_lshl_b32 s30, s20, 11
    s_add_u32 s30, s30, 21035008
    v_add_u32 v6, s30, v6
    v_lshl_add_u32 v6, v2, 6, v6
    v_lshl_add_u32 v6, v3, 5, v6
    v_lshl_add_u32 v197, v4, 4, v6
    v_lshrrev_b32 v6, 2, v2
    v_lshlrev_b32 v6, 14, v6
    v_and_b32 v7, 3, v2
    v_lshl_add_u32 v6, v7, 12, v6
    v_lshl_add_u32 v6, v5, 10, v6
    v_lshl_add_u32 v6, v3, 9, v6
    v_mul_u32_u24 v7, 30, v5
    v_add_u32 v7, v7, v4
    v_lshl_add_u32 v199, v7, 4, v6
    v_mov_b32 v201, 1
    s_cmp_eq_u32 s20, 0
    s_cselect_b32 s30, 1, 0
    s_cmp_eq_u32 s20, 31
    s_cselect_b32 s31, 1, 0
    v_mov_b32 v6, s30
    v_mov_b32 v7, s31
    v_cmp_eq_u32 vcc, 1, v5
    s_nop 1
    v_cndmask_b32 v6, v6, v7, vcc
    v_lshlrev_b32 v6, v6, v201
    v_mov_b32 v201, v6
    buffer_load_dwordx4 v[188:191], v196, s[12:15], 0 offen sc1
    buffer_load_dwordx4 v[192:195], v197, s[12:15], 0 offen sc1
L_chain1_kernel_w124:
    s_cmp_lg_u32 s22, 0
    s_cbranch_scc1 L_chain1_kernel_ya25
    s_mov_b64 s[40:41], exec
    s_cmp_eq_u32 s29, 1
    s_cbranch_scc0 L_chain1_kernel_yb26
    s_mov_b32 s30, 1
    s_atomic_add s30, s[48:49], 0x4000
    s_branch L_chain1_kernel_yc27
L_chain1_kernel_yb26:
    s_add_u32 s30, s50, 16384
    s_mov_b64 exec, 1
    v_mov_b32 v2, s30
    v_mov_b32 v3, 1
    buffer_atomic_add v3, v2, s[12:15], 0 offen sc1
L_chain1_kernel_yc27:
    s_mov_b64 exec, s[40:41]
L_chain1_kernel_ya25:
    s_cmp_lg_u32 s22, 0
    s_cbranch_scc1 L_chain1_kernel_yk28
    s_mov_b64 s[40:41], exec
    s_cmp_eq_u32 s29, 1
    s_cbranch_scc0 L_chain1_kernel_ys29
    s_mov_b32 s47, 0
L_chain1_kernel_yl31:
    s_mov_b32 s31, 0
    s_atomic_add s31, s[48:49], 0x4000 glc
    s_add_u32 s47, s47, 1
    s_cmp_gt_u32 s47, 262144
    s_cbranch_scc1 L_chain1_kernel_ye32
    s_waitcnt lgkmcnt(0)
    s_cmp_ge_u32 s31, 8
    s_cbranch_scc0 L_chain1_kernel_yl31
L_chain1_kernel_ye32:
    s_waitcnt lgkmcnt(0)
    s_branch L_chain1_kernel_yd30
L_chain1_kernel_ys29:
    s_add_u32 s30, s50, 16384
    s_mov_b64 exec, 1
    v_mov_b32 v2, s30
    v_mov_b32 v3, 8
    s_mov_b32 s47, 0
L_chain1_kernel_pl33:
    buffer_load_dword v4, v2, s[12:15], 0 offen sc1
    s_add_u32 s47, s47, 1
    s_cmp_gt_u32 s47, 262144
    s_cbranch_scc1 L_chain1_kernel_pd34
    s_waitcnt vmcnt(0)
    v_cmp_ge_u32 vcc, v4, v3
    s_nop 1
    s_cmp_eq_u32 vcc_lo, 1
    s_cbranch_scc0 L_chain1_kernel_pl33
L_chain1_kernel_pd34:
    s_waitcnt vmcnt(0)
L_chain1_kernel_yd30:
    s_mov_b64 exec, s[40:41]
L_chain1_kernel_yk28:
    s_barrier
    v_mov_b32 v18, v17
    v_mul_f32_e64 v19, -v16, v17
    v_pk_fma_f32 v[44:45], v[28:29], v[18:19], v[18:19] op_sel:[0,0,1] op_sel_hi:[1,0,1]
    v_pk_fma_f32 v[46:47], v[30:31], v[18:19], v[18:19] op_sel:[0,0,1] op_sel_hi:[1,0,1]
    v_pk_fma_f32 v[48:49], v[32:33], v[18:19], v[18:19] op_sel:[0,0,1] op_sel_hi:[1,0,1]
    v_pk_fma_f32 v[50:51], v[34:35], v[18:19], v[18:19] op_sel:[0,0,1] op_sel_hi:[1,0,1]
    v_pk_fma_f32 v[52:53], v[36:37], v[18:19], v[18:19] op_sel:[0,0,1] op_sel_hi:[1,0,1]
    v_pk_fma_f32 v[54:55], v[38:39], v[18:19], v[18:19] op_sel:[0,0,1] op_sel_hi:[1,0,1]
    v_pk_fma_f32 v[56:57], v[40:41], v[18:19], v[18:19] op_sel:[0,0,1] op_sel_hi:[1,0,1]
    v_pk_fma_f32 v[58:59], v[42:43], v[18:19], v[18:19] op_sel:[0,0,1] op_sel_hi:[1,0,1]
    s_cmp_lg_u32 s22, 1
    s_cbranch_scc1 L_chain1_kernel_w135
    s_mov_b32 s47, 0
    s_branch L_chain1_kernel_hp36c
L_chain1_kernel_hp36:
    buffer_load_dwordx4 v[188:191], v196, s[12:15], 0 offen sc1
    buffer_load_dwordx4 v[192:195], v197, s[12:15], 0 offen sc1
    s_add_u32 s47, s47, 1
    s_cmp_gt_u32 s47, 262144
    s_cbranch_scc1 L_chain1_kernel_hq37
L_chain1_kernel_hp36c:
    s_waitcnt vmcnt(0)
    v_max3_u32 v2, v188, v189, v190
    v_max_u32 v2, v2, v191
    v_cmp_eq_u32 vcc, -1, v2
    v_cmp_eq_u32 s[32:33], 1, v200
    s_nop 1
    s_and_b64 s[34:35], vcc, s[32:33]
    v_max3_u32 v2, v192, v193, v194
    v_max_u32 v2, v2, v195
    v_cmp_eq_u32 vcc, -1, v2
    v_cmp_eq_u32 s[32:33], 1, v201
    s_nop 1
    s_and_b64 s[36:37], vcc, s[32:33]
    s_or_b64 s[34:35], s[34:35], s[36:37]
    s_cmp_eq_u64 s[34:35], 0
    s_cbranch_scc0 L_chain1_kernel_hp36
L_chain1_kernel_hq37:
    s_waitcnt vmcnt(0)
    v_cmp_eq_u32 vcc, 2, v200
    s_nop 1
    v_cndmask_b32_e64 v188, v188, 0, vcc
    v_cndmask_b32_e64 v189, v189, 0, vcc
    v_cndmask_b32_e64 v190, v190, 0, vcc
    v_cndmask_b32_e64 v191, v191, 0, vcc
    v_cmp_lt_u32 vcc, 0, v200
    s_and_saveexec_b64 s[40:41], vcc
    ds_write_b128 v198, v[188:191]
    s_mov_b64 exec, s[40:41]
    v_cmp_eq_u32 vcc, 2, v201
    s_nop 1
    v_cndmask_b32_e64 v192, v192, 0, vcc
    v_cndmask_b32_e64 v193, v193, 0, vcc
    v_cndmask_b32_e64 v194, v194, 0, vcc
    v_cndmask_b32_e64 v195, v195, 0, vcc
    v_cmp_lt_u32 vcc, 0, v201
    s_and_saveexec_b64 s[40:41], vcc
    ds_write_b128 v199, v[192:195]
    s_mov_b64 exec, s[40:41]
    s_waitcnt lgkmcnt(0)
L_chain1_kernel_w135:
    s_mul_i32 s30, s24, 1024
    s_add_u32 s30, s30, 2048
    v_lshlrev_b32 v11, 4, v0
    v_add_u32 v8, s30, v11
    s_lshl_b32 s30, s23, 10
    v_add_u32 v11, s30, v11
    v_add_u32 v9, 65536, v8
    v_add_u32 v12, 65536, v11
    s_barrier
    ds_read_b128 v[124:127], v11 offset:0
    ds_read_b128 v[128:131], v8 offset:0
    ds_read_b128 v[132:135], v11 offset:4096
    ds_read_b128 v[136:139], v8 offset:4096
    ds_read_b128 v[140:143], v11 offset:8192
    ds_read_b128 v[144:147], v8 offset:8192
    ds_read_b128 v[148:151], v11 offset:12288
    ds_read_b128 v[152:155], v8 offset:12288
    s_barrier
    ds_read_b128 v[156:159], v11 offset:16384
    ds_read_b128 v[160:163], v8 offset:16384
    s_waitcnt lgkmcnt(8)
    v_mfma_f32_32x32x16_bf16 v[60:75], v[128:131], v[124:127], 0
    ds_read_b128 v[124:127], v11 offset:20480
    ds_read_b128 v[128:131], v8 offset:20480
    s_waitcnt lgkmcnt(8)
    v_mfma_f32_32x32x16_bf16 v[60:75], v[136:139], v[132:135], v[60:75]
    ds_read_b128 v[132:135], v11 offset:24576
    ds_read_b128 v[136:139], v8 offset:24576
    s_waitcnt lgkmcnt(8)
    v_mfma_f32_32x32x16_bf16 v[60:75], v[144:147], v[140:143], v[60:75]
    ds_read_b128 v[140:143], v11 offset:28672
    ds_read_b128 v[144:147], v8 offset:28672
    s_waitcnt lgkmcnt(8)
    v_mfma_f32_32x32x16_bf16 v[60:75], v[152:155], v[148:151], v[60:75]
    s_barrier
    ds_read_b128 v[148:151], v11 offset:32768
    ds_read_b128 v[152:155], v8 offset:32768
    s_waitcnt lgkmcnt(8)
    v_mfma_f32_32x32x16_bf16 v[60:75], v[160:163], v[156:159], v[60:75]
    ds_read_b128 v[156:159], v11 offset:36864
    ds_read_b128 v[160:163], v8 offset:36864
    s_waitcnt lgkmcnt(8)
    v_mfma_f32_32x32x16_bf16 v[60:75], v[128:131], v[124:127], v[60:75]
    ds_read_b128 v[124:127], v11 offset:40960
    ds_read_b128 v[128:131], v8 offset:40960
    s_waitcnt lgkmcnt(8)
    v_mfma_f32_32x32x16_bf16 v[60:75], v[136:139], v[132:135], v[60:75]
    ds_read_b128 v[132:135], v11 offset:45056
    ds_read_b128 v[136:139], v8 offset:45056
    s_waitcnt lgkmcnt(8)
    v_mfma_f32_32x32x16_bf16 v[60:75], v[144:147], v[140:143], v[60:75]
    s_barrier
    ds_read_b128 v[140:143], v11 offset:49152
    ds_read_b128 v[144:147], v8 offset:49152
    s_waitcnt lgkmcnt(8)
    v_mfma_f32_32x32x16_bf16 v[60:75], v[152:155], v[148:151], v[60:75]
    ds_read_b128 v[148:151], v11 offset:53248
    ds_read_b128 v[152:155], v8 offset:53248
    s_waitcnt lgkmcnt(8)
    v_mfma_f32_32x32x16_bf16 v[60:75], v[160:163], v[156:159], v[60:75]
    ds_read_b128 v[156:159], v11 offset:57344
    ds_read_b128 v[160:163], v8 offset:57344
    s_waitcnt lgkmcnt(8)
    v_mfma_f32_32x32x16_bf16 v[60:75], v[128:131], v[124:127], v[60:75]
    ds_read_b128 v[124:127], v11 offset:61440
    ds_read_b128 v[128:131], v8 offset:61440
    s_waitcnt lgkmcnt(8)
    v_mfma_f32_32x32x16_bf16 v[60:75], v[136:139], v[132:135], v[60:75]
    s_barrier
    ds_read_b128 v[132:135], v12 offset:0
    ds_read_b128 v[136:139], v9 offset:0
    s_waitcnt lgkmcnt(8)
    v_mfma_f32_32x32x16_bf16 v[60:75], v[144:147], v[140:143], v[60:75]
    ds_read_b128 v[140:143], v12 offset:4096
    ds_read_b128 v[144:147], v9 offset:4096
    s_waitcnt lgkmcnt(8)
    v_mfma_f32_32x32x16_bf16 v[60:75], v[152:155], v[148:151], v[60:75]
    ds_read_b128 v[148:151], v12 offset:8192
    ds_read_b128 v[152:155], v9 offset:8192
    s_waitcnt lgkmcnt(8)
    v_mfma_f32_32x32x16_bf16 v[60:75], v[160:163], v[156:159], v[60:75]
    ds_read_b128 v[156:159], v12 offset:12288
    ds_read_b128 v[160:163], v9 offset:12288
    s_waitcnt lgkmcnt(8)
    v_mfma_f32_32x32x16_bf16 v[60:75], v[128:131], v[124:127], v[60:75]
    s_barrier
    ds_read_b128 v[124:127], v12 offset:16384
    ds_read_b128 v[128:131], v9 offset:16384
    s_waitcnt lgkmcnt(8)
    v_mfma_f32_32x32x16_bf16 v[60:75], v[136:139], v[132:135], v[60:75]
    ds_read_b128 v[132:135], v12 offset:20480
    ds_read_b128 v[136:139], v9 offset:20480
    s_waitcnt lgkmcnt(8)
    v_mfma_f32_32x32x16_bf16 v[60:75], v[144:147], v[140:143], v[60:75]
    ds_read_b128 v[140:143], v12 offset:24576
    ds_read_b128 v[144:147], v9 offset:24576
    s_waitcnt lgkmcnt(8)
    v_mfma_f32_32x32x16_bf16 v[60:75], v[152:155], v[148:151], v[60:75]
    ds_read_b128 v[148:151], v12 offset:28672
    ds_read_b128 v[152:155], v9 offset:28672
    s_waitcnt lgkmcnt(8)
    v_mfma_f32_32x32x16_bf16 v[60:75], v[160:163], v[156:159], v[60:75]
    s_barrier
    ds_read_b128 v[156:159], v12 offset:32768
    ds_read_b128 v[160:163], v9 offset:32768
    s_waitcnt lgkmcnt(8)
    v_mfma_f32_32x32x16_bf16 v[60:75], v[128:131], v[124:127], v[60:75]
    ds_read_b128 v[124:127], v12 offset:36864
    ds_read_b128 v[128:131], v9 offset:36864
    s_waitcnt lgkmcnt(8)
    v_mfma_f32_32x32x16_bf16 v[60:75], v[136:139], v[132:135], v[60:75]
    ds_read_b128 v[132:135], v12 offset:40960
    ds_read_b128 v[136:139], v9 offset:40960
    s_waitcnt lgkmcnt(8)
    v_mfma_f32_32x32x16_bf16 v[60:75], v[144:147], v[140:143], v[60:75]
    ds_read_b128 v[140:143], v12 offset:45056
    ds_read_b128 v[144:147], v9 offset:45056
    s_waitcnt lgkmcnt(8)
    v_mfma_f32_32x32x16_bf16 v[60:75], v[152:155], v[148:151], v[60:75]
    s_barrier
    ds_read_b128 v[148:151], v12 offset:49152
    ds_read_b128 v[152:155], v9 offset:49152
    s_waitcnt lgkmcnt(8)
    v_mfma_f32_32x32x16_bf16 v[60:75], v[160:163], v[156:159], v[60:75]
    ds_read_b128 v[156:159], v12 offset:53248
    ds_read_b128 v[160:163], v9 offset:53248
    s_waitcnt lgkmcnt(8)
    v_mfma_f32_32x32x16_bf16 v[60:75], v[128:131], v[124:127], v[60:75]
    ds_read_b128 v[124:127], v12 offset:57344
    ds_read_b128 v[128:131], v9 offset:57344
    s_waitcnt lgkmcnt(8)
    v_mfma_f32_32x32x16_bf16 v[60:75], v[136:139], v[132:135], v[60:75]
    ds_read_b128 v[132:135], v12 offset:61440
    ds_read_b128 v[136:139], v9 offset:61440
    s_waitcnt lgkmcnt(8)
    v_mfma_f32_32x32x16_bf16 v[60:75], v[144:147], v[140:143], v[60:75]
    s_waitcnt lgkmcnt(6)
    v_mfma_f32_32x32x16_bf16 v[60:75], v[152:155], v[148:151], v[60:75]
    s_waitcnt lgkmcnt(4)
    v_mfma_f32_32x32x16_bf16 v[60:75], v[160:163], v[156:159], v[60:75]
    s_waitcnt lgkmcnt(2)
    v_mfma_f32_32x32x16_bf16 v[60:75], v[128:131], v[124:127], v[60:75]
    s_waitcnt lgkmcnt(0)
    v_mfma_f32_32x32x16_bf16 v[60:75], v[136:139], v[132:135], v[60:75]
    s_barrier
    s_mul_i32 s32, s28, 32768
    s_lshl_b32 s33, s45, 10
    s_add_u32 s32, s32, s33
    s_add_u32 s32, s32, 2097152
    s_nop 7
    v_pk_add_f32 v[44:45], v[44:45], v[60:61]
    v_pk_add_f32 v[46:47], v[46:47], v[62:63]
    v_pk_add_f32 v[48:49], v[48:49], v[64:65]
    v_pk_add_f32 v[50:51], v[50:51], v[66:67]
    v_pk_add_f32 v[52:53], v[52:53], v[68:69]
    v_pk_add_f32 v[54:55], v[54:55], v[70:71]
    v_pk_add_f32 v[56:57], v[56:57], v[72:73]
    v_pk_add_f32 v[58:59], v[58:59], v[74:75]
    v_cvt_pk_bf16_f32 v236, v44, v45
    v_cvt_pk_bf16_f32 v237, v46, v47
    v_cvt_pk_bf16_f32 v238, v48, v49
    v_cvt_pk_bf16_f32 v239, v50, v51
    v_cvt_pk_bf16_f32 v240, v52, v53
    v_cvt_pk_bf16_f32 v241, v54, v55
    v_cvt_pk_bf16_f32 v242, v56, v57
    v_cvt_pk_bf16_f32 v243, v58, v59
    s_cmp_eq_u32 s29, 1
    s_cbranch_scc1 L_chain1_kernel_sf38
    buffer_store_dwordx4 v[236:239], v14, s[12:15], s32 offen offset:0 sc1
    buffer_store_dwordx4 v[240:243], v14, s[12:15], s32 offen offset:1024 sc1
    s_branch L_chain1_kernel_sd39
L_chain1_kernel_sf38:
    buffer_store_dwordx4 v[236:239], v14, s[12:15], s32 offen offset:0
    buffer_store_dwordx4 v[240:243], v14, s[12:15], s32 offen offset:1024
L_chain1_kernel_sd39:
    v_pk_add_f32 v[2:3], v[44:45], v[46:47]
    v_pk_mul_f32 v[4:5], v[44:45], v[44:45]
    v_pk_fma_f32 v[4:5], v[46:47], v[46:47], v[4:5]
    v_pk_add_f32 v[2:3], v[2:3], v[48:49]
    v_pk_fma_f32 v[4:5], v[48:49], v[48:49], v[4:5]
    v_pk_add_f32 v[2:3], v[2:3], v[50:51]
    v_pk_fma_f32 v[4:5], v[50:51], v[50:51], v[4:5]
    v_pk_add_f32 v[2:3], v[2:3], v[52:53]
    v_pk_fma_f32 v[4:5], v[52:53], v[52:53], v[4:5]
    v_pk_add_f32 v[2:3], v[2:3], v[54:55]
    v_pk_fma_f32 v[4:5], v[54:55], v[54:55], v[4:5]
    v_pk_add_f32 v[2:3], v[2:3], v[56:57]
    v_pk_fma_f32 v[4:5], v[56:57], v[56:57], v[4:5]
    v_pk_add_f32 v[2:3], v[2:3], v[58:59]
    v_pk_fma_f32 v[4:5], v[58:59], v[58:59], v[4:5]
    v_add_f32 v2, v2, v3
    v_add_f32 v3, v4, v5
    s_nop 1
    v_permlane32_swap_b32 v2, v3
    s_nop 1
    v_add_f32 v2, v2, v3
    s_lshl_b32 s34, s28, 12
    s_lshl_b32 s35, s44, 8
    s_add_u32 s34, s34, s35
    s_add_u32 s34, s34, 20447232
    v_lshlrev_b32 v4, 2, v0
    s_cmp_eq_u32 s29, 1
    s_cbranch_scc1 L_chain1_kernel_sf40
    buffer_store_dword v2, v4, s[12:15], s34 offen sc1
    s_branch L_chain1_kernel_sd41
L_chain1_kernel_sf40:
    buffer_store_dword v2, v4, s[12:15], s34 offen
L_chain1_kernel_sd41:
    s_waitcnt vmcnt(0)
    s_barrier
L_chain1_kernel_com:
    v_lshlrev_b32 v14, 4, v0
    s_min_u32 s52, s22, 6
    s_mul_i32 s53, s21, 7
    s_add_u32 s53, s53, s52
    s_lshl_b32 s53, s53, 15
    s_add_u32 s53, s53, 28311552
    s_cmp_lg_u32 s22, 0
    s_cbranch_scc1 L_chain1_kernel_ya42
    s_mov_b64 s[40:41], exec
    s_cmp_eq_u32 s29, 1
    s_cbranch_scc0 L_chain1_kernel_yb43
    s_mov_b32 s30, 1
    s_atomic_add s30, s[48:49], 0xa000
    s_branch L_chain1_kernel_yc44
L_chain1_kernel_yb43:
    s_add_u32 s30, s50, 40960
    s_mov_b64 exec, 1
    v_mov_b32 v2, s30
    v_mov_b32 v3, 1
    buffer_atomic_add v3, v2, s[12:15], 0 offen sc1
L_chain1_kernel_yc44:
    s_mov_b64 exec, s[40:41]
L_chain1_kernel_ya42:
    s_cmp_eq_u32 s22, 7
    s_cbranch_scc1 L_chain1_kernel_s748
    s_add_u32 s26, s53, 0
    buffer_load_dwordx4 v[92:95], v14, s[12:15], s26 offen
    s_add_u32 s26, s53, 4096
    buffer_load_dwordx4 v[96:99], v14, s[12:15], s26 offen
    s_add_u32 s26, s53, 8192
    buffer_load_dwordx4 v[100:103], v14, s[12:15], s26 offen
    s_add_u32 s26, s53, 12288
    buffer_load_dwordx4 v[104:107], v14, s[12:15], s26 offen
    s_add_u32 s26, s53, 16384
    buffer_load_dwordx4 v[108:111], v14, s[12:15], s26 offen
    s_add_u32 s26, s53, 20480
    buffer_load_dwordx4 v[112:115], v14, s[12:15], s26 offen
    s_add_u32 s26, s53, 24576
    buffer_load_dwordx4 v[116:119], v14, s[12:15], s26 offen
    s_add_u32 s26, s53, 28672
    buffer_load_dwordx4 v[120:123], v14, s[12:15], s26 offen
    s_add_u32 s26, s53, 1024
    buffer_load_dwordx4 v[124:127], v14, s[12:15], s26 offen
    s_add_u32 s26, s53, 5120
    buffer_load_dwordx4 v[128:131], v14, s[12:15], s26 offen
L_chain1_kernel_s748:
    s_cmp_lg_u32 s22, 0
    s_cbranch_scc1 L_chain1_kernel_yk45
    s_mov_b64 s[40:41], exec
    s_cmp_eq_u32 s29, 1
    s_cbranch_scc0 L_chain1_kernel_ys46
    s_mov_b32 s47, 0
L_chain1_kernel_yl49:
    s_mov_b32 s31, 0
    s_atomic_add s31, s[48:49], 0xa000 glc
    s_add_u32 s47, s47, 1
    s_cmp_gt_u32 s47, 262144
    s_cbranch_scc1 L_chain1_kernel_ye50
    s_waitcnt lgkmcnt(0)
    s_cmp_ge_u32 s31, 8
    s_cbranch_scc0 L_chain1_kernel_yl49
L_chain1_kernel_ye50:
    s_waitcnt lgkmcnt(0)
    s_branch L_chain1_kernel_yd47
L_chain1_kernel_ys46:
    s_add_u32 s30, s50, 40960
    s_mov_b64 exec, 1
    v_mov_b32 v2, s30
    v_mov_b32 v3, 8
    s_mov_b32 s47, 0
L_chain1_kernel_pl51:
    buffer_load_dword v4, v2, s[12:15], 0 offen sc1
    s_add_u32 s47, s47, 1
    s_cmp_gt_u32 s47, 262144
    s_cbranch_scc1 L_chain1_kernel_pd52
    s_waitcnt vmcnt(0)
    v_cmp_ge_u32 vcc, v4, v3
    s_nop 1
    s_cmp_eq_u32 vcc_lo, 1
    s_cbranch_scc0 L_chain1_kernel_pl51
L_chain1_kernel_pd52:
    s_waitcnt vmcnt(0)
L_chain1_kernel_yd47:
    s_mov_b64 exec, s[40:41]
L_chain1_kernel_yk45:
    s_barrier
    s_cmp_eq_u32 s22, 7
    s_cbranch_scc1 L_chain1_kernel_w7a
    s_lshl_b32 s30, s20, 13
    s_lshl_b32 s31, s22, 10
    s_add_u32 s30, s30, s31
    s_add_u32 s30, s30, 20447232
    s_add_u32 m0, s31, 149504
    s_nop 0
    buffer_load_dwordx4 v14, s[12:15], s30 offen sc1 lds
    s_lshl_b32 s30, s20, 16
    s_lshl_b32 s31, s22, 12
    s_add_u32 s30, s30, s31
    s_add_u32 s30, s30, 2097152
    s_add_u32 m0, s31, 0
    s_add_u32 s26, s30, 0
    buffer_load_dwordx4 v14, s[12:15], s26 offen sc1 lds
    s_add_u32 m0, s31, 32768
    s_add_u32 s26, s30, 32768
    buffer_load_dwordx4 v14, s[12:15], s26 offen sc1 lds
    s_add_u32 m0, s31, 1024
    s_add_u32 s26, s30, 1024
    buffer_load_dwordx4 v14, s[12:15], s26 offen sc1 lds
    s_add_u32 m0, s31, 33792
    s_add_u32 s26, s30, 33792
    buffer_load_dwordx4 v14, s[12:15], s26 offen sc1 lds
    s_add_u32 m0, s31, 2048
    s_add_u32 s26, s30, 2048
    buffer_load_dwordx4 v14, s[12:15], s26 offen sc1 lds
    s_add_u32 m0, s31, 34816
    s_add_u32 s26, s30, 34816
    buffer_load_dwordx4 v14, s[12:15], s26 offen sc1 lds
    s_add_u32 m0, s31, 3072
    s_add_u32 s26, s30, 3072
    buffer_load_dwordx4 v14, s[12:15], s26 offen sc1 lds
    s_add_u32 m0, s31, 35840
    s_add_u32 s26, s30, 35840
    buffer_load_dwordx4 v14, s[12:15], s26 offen sc1 lds
    s_waitcnt vmcnt(6)
    s_barrier
    ds_read_b128 v[220:223], v14 offset:0
    ds_read_b128 v[224:227], v14 offset:32768
    ds_read_b128 v[228:231], v14 offset:4096
    ds_read_b128 v[232:235], v14 offset:36864
    ds_read_b128 v[236:239], v14 offset:8192
    ds_read_b128 v[240:243], v14 offset:40960
    v_lshlrev_b32 v2, 2, v0
    v_add_u32 v2, 149504, v2
    s_waitcnt lgkmcnt(0)
    ds_read2st64_b32 v[60:61], v2 offset0:0 offset1:1
    ds_read2st64_b32 v[62:63], v2 offset0:2 offset1:3
    ds_read2st64_b32 v[64:65], v2 offset0:4 offset1:5
    ds_read2st64_b32 v[66:67], v2 offset0:6 offset1:7
    ds_read2st64_b32 v[68:69], v2 offset0:8 offset1:9
    ds_read2st64_b32 v[70:71], v2 offset0:10 offset1:11
    ds_read2st64_b32 v[72:73], v2 offset0:12 offset1:13
    ds_read2st64_b32 v[74:75], v2 offset0:14 offset1:15
    s_waitcnt lgkmcnt(0)
    v_add_f32 v60, v60, v68
    v_add_f32 v61, v61, v69
    v_add_f32 v62, v62, v70
    v_add_f32 v63, v63, v71
    v_add_f32 v64, v64, v72
    v_add_f32 v65, v65, v73
    v_add_f32 v66, v66, v74
    v_add_f32 v67, v67, v75
    v_add_f32 v60, v60, v64
    v_add_f32 v61, v61, v65
    v_add_f32 v62, v62, v66
    v_add_f32 v63, v63, v67
    v_add_f32 v60, v60, v62
    v_add_f32 v61, v61, v63
    v_add_f32 v60, v60, v61
    v_mov_b32 v61, v60
    s_nop 1
    v_permlane32_swap_b32 v60, v61
    s_nop 1
    v_mul_f32 v24, 0x3b000000, v60
    v_mul_f32 v25, 0x3b000000, v61
    v_fma_f32 v25, -v24, v24, v25
    v_max_f32 v25, 0, v25
    v_add_f32 v18, 0x3727c5ac, v25
    v_rsq_f32 v18, v18
    s_nop 0
    v_mul_f32_e64 v19, -v24, v18
    v_lshlrev_b32 v2, 2, v0
    v_add_u32 v2, 153600, v2
    s_waitcnt lgkmcnt(0)
    ds_read2st64_b32 v[60:61], v2 offset0:0 offset1:1
    ds_read2st64_b32 v[62:63], v2 offset0:2 offset1:3
    ds_read2st64_b32 v[64:65], v2 offset0:4 offset1:5
    ds_read2st64_b32 v[66:67], v2 offset0:6 offset1:7
    ds_read2st64_b32 v[68:69], v2 offset0:8 offset1:9
    ds_read2st64_b32 v[70:71], v2 offset0:10 offset1:11
    ds_read2st64_b32 v[72:73], v2 offset0:12 offset1:13
    ds_read2st64_b32 v[74:75], v2 offset0:14 offset1:15
    s_waitcnt lgkmcnt(0)
    v_add_f32 v60, v60, v68
    v_add_f32 v61, v61, v69
    v_add_f32 v62, v62, v70
    v_add_f32 v63, v63, v71
    v_add_f32 v64, v64, v72
    v_add_f32 v65, v65, v73
    v_add_f32 v66, v66, v74
    v_add_f32 v67, v67, v75
    v_add_f32 v60, v60, v64
    v_add_f32 v61, v61, v65
    v_add_f32 v62, v62, v66
    v_add_f32 v63, v63, v67
    v_add_f32 v60, v60, v62
    v_add_f32 v61, v61, v63
    v_add_f32 v60, v60, v61
    v_mov_b32 v61, v60
    s_nop 1
    v_permlane32_swap_b32 v60, v61
    s_nop 1
    v_mul_f32 v24, 0x3b000000, v60
    v_mul_f32 v25, 0x3b000000, v61
    v_fma_f32 v25, -v24, v24, v25
    v_max_f32 v25, 0, v25
    v_add_f32 v20, 0x3727c5ac, v25
    v_rsq_f32 v20, v20
    s_nop 0
    v_mul_f32_e64 v21, -v24, v20
    v_mov_b32 v22, 0xc0135761
    v_mov_b32 v23, 0xbdd2d3e8
    s_add_u32 s26, s53, 9216
    buffer_load_dwordx4 v[132:135], v14, s[12:15], s26 offen
    ds_read_b128 v[244:247], v14 offset:12288
    ds_read_b128 v[248:251], v14 offset:45056
    v_mfma_f32_32x32x16_bf16 v[60:75], v[92:95], v[220:223], 0
    v_mfma_f32_32x32x16_bf16 v[76:91], v[92:95], v[224:227], 0
    s_add_u32 s26, s53, 13312
    buffer_load_dwordx4 v[136:139], v14, s[12:15], s26 offen
    ds_read_b128 v[220:223], v14 offset:16384
    ds_read_b128 v[224:227], v14 offset:49152
    v_mfma_f32_32x32x16_bf16 v[60:75], v[96:99], v[228:231], v[60:75]
    v_mfma_f32_32x32x16_bf16 v[76:91], v[96:99], v[232:235], v[76:91]
    s_add_u32 s26, s53, 17408
    buffer_load_dwordx4 v[140:143], v14, s[12:15], s26 offen
    ds_read_b128 v[228:231], v14 offset:20480
    ds_read_b128 v[232:235], v14 offset:53248
    v_mfma_f32_32x32x16_bf16 v[60:75], v[100:103], v[236:239], v[60:75]
    v_mfma_f32_32x32x16_bf16 v[76:91], v[100:103], v[240:243], v[76:91]
    s_add_u32 s26, s53, 21504
    buffer_load_dwordx4 v[144:147], v14, s[12:15], s26 offen
    ds_read_b128 v[236:239], v14 offset:24576
    ds_read_b128 v[240:243], v14 offset:57344
    s_waitcnt lgkmcnt(6)
    v_mfma_f32_32x32x16_bf16 v[60:75], v[104:107], v[244:247], v[60:75]
    v_mfma_f32_32x32x16_bf16 v[76:91], v[104:107], v[248:251], v[76:91]
    s_add_u32 s26, s53, 25600
    buffer_load_dwordx4 v[148:151], v14, s[12:15], s26 offen
    ds_read_b128 v[244:247], v14 offset:28672
    ds_read_b128 v[248:251], v14 offset:61440
    s_waitcnt lgkmcnt(6)
    v_mfma_f32_32x32x16_bf16 v[60:75], v[108:111], v[220:223], v[60:75]
    v_mfma_f32_32x32x16_bf16 v[76:91], v[108:111], v[224:227], v[76:91]
    s_add_u32 s26, s53, 29696
    buffer_load_dwordx4 v[152:155], v14, s[12:15], s26 offen
    s_waitcnt vmcnt(10)
    s_barrier
    ds_read_b128 v[220:223], v14 offset:1024
    ds_read_b128 v[224:227], v14 offset:33792
    s_waitcnt lgkmcnt(6)
    v_mfma_f32_32x32x16_bf16 v[60:75], v[112:115], v[228:231], v[60:75]
    v_mfma_f32_32x32x16_bf16 v[76:91], v[112:115], v[232:235], v[76:91]
    s_add_u32 s26, s53, 2048
    buffer_load_dwordx4 v[156:159], v14, s[12:15], s26 offen
    ds_read_b128 v[228:231], v14 offset:5120
    ds_read_b128 v[232:235], v14 offset:37888
    s_waitcnt lgkmcnt(6)
    v_mfma_f32_32x32x16_bf16 v[60:75], v[116:119], v[236:239], v[60:75]
    v_mfma_f32_32x32x16_bf16 v[76:91], v[116:119], v[240:243], v[76:91]
    s_add_u32 s26, s53, 6144
    buffer_load_dwordx4 v[160:163], v14, s[12:15], s26 offen
    ds_read_b128 v[236:239], v14 offset:9216
    ds_read_b128 v[240:243], v14 offset:41984
    s_waitcnt lgkmcnt(6)
    v_mfma_f32_32x32x16_bf16 v[60:75], v[120:123], v[244:247], v[60:75]
    v_mfma_f32_32x32x16_bf16 v[76:91], v[120:123], v[248:251], v[76:91]
    s_add_u32 s26, s53, 10240
    buffer_load_dwordx4 v[164:167], v14, s[12:15], s26 offen
    ds_read_b128 v[244:247], v14 offset:13312
    ds_read_b128 v[248:251], v14 offset:46080
    s_waitcnt lgkmcnt(6)
    v_mfma_f32_32x32x16_bf16 v[60:75], v[124:127], v[220:223], v[60:75]
    v_mfma_f32_32x32x16_bf16 v[76:91], v[124:127], v[224:227], v[76:91]
    s_add_u32 s26, s53, 14336
    buffer_load_dwordx4 v[168:171], v14, s[12:15], s26 offen
    ds_read_b128 v[220:223], v14 offset:17408
    ds_read_b128 v[224:227], v14 offset:50176
    s_waitcnt lgkmcnt(6)
    v_mfma_f32_32x32x16_bf16 v[60:75], v[128:131], v[228:231], v[60:75]
    v_mfma_f32_32x32x16_bf16 v[76:91], v[128:131], v[232:235], v[76:91]
    s_add_u32 s26, s53, 18432
    buffer_load_dwordx4 v[172:175], v14, s[12:15], s26 offen
    ds_read_b128 v[228:231], v14 offset:21504
    ds_read_b128 v[232:235], v14 offset:54272
    s_waitcnt lgkmcnt(6)
    s_waitcnt vmcnt(10)
    v_mfma_f32_32x32x16_bf16 v[60:75], v[132:135], v[236:239], v[60:75]
    v_mfma_f32_32x32x16_bf16 v[76:91], v[132:135], v[240:243], v[76:91]
    s_add_u32 s26, s53, 22528
    buffer_load_dwordx4 v[176:179], v14, s[12:15], s26 offen
    ds_read_b128 v[236:239], v14 offset:25600
    ds_read_b128 v[240:243], v14 offset:58368
    s_waitcnt lgkmcnt(6)
    s_waitcnt vmcnt(10)
    v_mfma_f32_32x32x16_bf16 v[60:75], v[136:139], v[244:247], v[60:75]
    v_mfma_f32_32x32x16_bf16 v[76:91], v[136:139], v[248:251], v[76:91]
    s_add_u32 s26, s53, 26624
    buffer_load_dwordx4 v[180:183], v14, s[12:15], s26 offen
    ds_read_b128 v[244:247], v14 offset:29696
    ds_read_b128 v[248:251], v14 offset:62464
    s_waitcnt lgkmcnt(6)
    s_waitcnt vmcnt(10)
    v_mfma_f32_32x32x16_bf16 v[60:75], v[140:143], v[220:223], v[60:75]
    v_mfma_f32_32x32x16_bf16 v[76:91], v[140:143], v[224:227], v[76:91]
    s_add_u32 s26, s53, 30720
    buffer_load_dwordx4 v[184:187], v14, s[12:15], s26 offen
    s_barrier
    ds_read_b128 v[220:223], v14 offset:2048
    ds_read_b128 v[224:227], v14 offset:34816
    s_waitcnt lgkmcnt(6)
    s_waitcnt vmcnt(10)
    v_mfma_f32_32x32x16_bf16 v[60:75], v[144:147], v[228:231], v[60:75]
    v_mfma_f32_32x32x16_bf16 v[76:91], v[144:147], v[232:235], v[76:91]
    s_add_u32 s26, s53, 3072
    buffer_load_dwordx4 v[188:191], v14, s[12:15], s26 offen
    ds_read_b128 v[228:231], v14 offset:6144
    ds_read_b128 v[232:235], v14 offset:38912
    s_waitcnt lgkmcnt(6)
    s_waitcnt vmcnt(10)
    v_mfma_f32_32x32x16_bf16 v[60:75], v[148:151], v[236:239], v[60:75]
    v_mfma_f32_32x32x16_bf16 v[76:91], v[148:151], v[240:243], v[76:91]
    s_add_u32 s26, s53, 7168
    buffer_load_dwordx4 v[192:195], v14, s[12:15], s26 offen
    ds_read_b128 v[236:239], v14 offset:10240
    ds_read_b128 v[240:243], v14 offset:43008
    s_waitcnt lgkmcnt(6)
    s_waitcnt vmcnt(10)
    v_mfma_f32_32x32x16_bf16 v[60:75], v[152:155], v[244:247], v[60:75]
    v_mfma_f32_32x32x16_bf16 v[76:91], v[152:155], v[248:251], v[76:91]
    s_add_u32 s26, s53, 11264
    buffer_load_dwordx4 v[196:199], v14, s[12:15], s26 offen
    ds_read_b128 v[244:247], v14 offset:14336
    ds_read_b128 v[248:251], v14 offset:47104
    s_waitcnt lgkmcnt(6)
    s_waitcnt vmcnt(10)
    v_mfma_f32_32x32x16_bf16 v[60:75], v[156:159], v[220:223], v[60:75]
    v_mfma_f32_32x32x16_bf16 v[76:91], v[156:159], v[224:227], v[76:91]
    s_add_u32 s26, s53, 15360
    buffer_load_dwordx4 v[200:203], v14, s[12:15], s26 offen
    ds_read_b128 v[220:223], v14 offset:18432
    ds_read_b128 v[224:227], v14 offset:51200
    s_waitcnt lgkmcnt(6)
    s_waitcnt vmcnt(10)
    v_mfma_f32_32x32x16_bf16 v[60:75], v[160:163], v[228:231], v[60:75]
    v_mfma_f32_32x32x16_bf16 v[76:91], v[160:163], v[232:235], v[76:91]
    s_add_u32 s26, s53, 19456
    buffer_load_dwordx4 v[204:207], v14, s[12:15], s26 offen
    ds_read_b128 v[228:231], v14 offset:22528
    ds_read_b128 v[232:235], v14 offset:55296
    s_waitcnt lgkmcnt(6)
    s_waitcnt vmcnt(10)
    v_mfma_f32_32x32x16_bf16 v[60:75], v[164:167], v[236:239], v[60:75]
    v_mfma_f32_32x32x16_bf16 v[76:91], v[164:167], v[240:243], v[76:91]
    s_add_u32 s26, s53, 23552
    buffer_load_dwordx4 v[208:211], v14, s[12:15], s26 offen
    ds_read_b128 v[236:239], v14 offset:26624
    ds_read_b128 v[240:243], v14 offset:59392
    s_waitcnt lgkmcnt(6)
    s_waitcnt vmcnt(10)
    v_mfma_f32_32x32x16_bf16 v[60:75], v[168:171], v[244:247], v[60:75]
    v_mfma_f32_32x32x16_bf16 v[76:91], v[168:171], v[248:251], v[76:91]
    s_add_u32 s26, s53, 27648
    buffer_load_dwordx4 v[212:215], v14, s[12:15], s26 offen
    ds_read_b128 v[244:247], v14 offset:30720
    ds_read_b128 v[248:251], v14 offset:63488
    s_waitcnt lgkmcnt(6)
    s_waitcnt vmcnt(10)
    v_mfma_f32_32x32x16_bf16 v[60:75], v[172:175], v[220:223], v[60:75]
    v_mfma_f32_32x32x16_bf16 v[76:91], v[172:175], v[224:227], v[76:91]
    s_add_u32 s26, s53, 31744
    buffer_load_dwordx4 v[216:219], v14, s[12:15], s26 offen
    s_barrier
    ds_read_b128 v[220:223], v14 offset:3072
    ds_read_b128 v[224:227], v14 offset:35840
    s_waitcnt lgkmcnt(6)
    s_waitcnt vmcnt(10)
    v_mfma_f32_32x32x16_bf16 v[60:75], v[176:179], v[228:231], v[60:75]
    v_mfma_f32_32x32x16_bf16 v[76:91], v[176:179], v[232:235], v[76:91]
    ds_read_b128 v[228:231], v14 offset:7168
    ds_read_b128 v[232:235], v14 offset:39936
    s_waitcnt lgkmcnt(6)
    s_waitcnt vmcnt(9)
    v_mfma_f32_32x32x16_bf16 v[60:75], v[180:183], v[236:239], v[60:75]
    v_mfma_f32_32x32x16_bf16 v[76:91], v[180:183], v[240:243], v[76:91]
    ds_read_b128 v[236:239], v14 offset:11264
    ds_read_b128 v[240:243], v14 offset:44032
    s_waitcnt lgkmcnt(6)
    s_waitcnt vmcnt(8)
    v_mfma_f32_32x32x16_bf16 v[60:75], v[184:187], v[244:247], v[60:75]
    v_mfma_f32_32x32x16_bf16 v[76:91], v[184:187], v[248:251], v[76:91]
    ds_read_b128 v[244:247], v14 offset:15360
    ds_read_b128 v[248:251], v14 offset:48128
    s_waitcnt lgkmcnt(6)
    s_waitcnt vmcnt(7)
    v_mfma_f32_32x32x16_bf16 v[60:75], v[188:191], v[220:223], v[60:75]
    v_mfma_f32_32x32x16_bf16 v[76:91], v[188:191], v[224:227], v[76:91]
    ds_read_b128 v[220:223], v14 offset:19456
    ds_read_b128 v[224:227], v14 offset:52224
    s_waitcnt lgkmcnt(6)
    s_waitcnt vmcnt(6)
    v_mfma_f32_32x32x16_bf16 v[60:75], v[192:195], v[228:231], v[60:75]
    v_mfma_f32_32x32x16_bf16 v[76:91], v[192:195], v[232:235], v[76:91]
    ds_read_b128 v[228:231], v14 offset:23552
    ds_read_b128 v[232:235], v14 offset:56320
    s_waitcnt lgkmcnt(6)
    s_waitcnt vmcnt(5)
    v_mfma_f32_32x32x16_bf16 v[60:75], v[196:199], v[236:239], v[60:75]
    v_mfma_f32_32x32x16_bf16 v[76:91], v[196:199], v[240:243], v[76:91]
    ds_read_b128 v[236:239], v14 offset:27648
    ds_read_b128 v[240:243], v14 offset:60416
    s_waitcnt lgkmcnt(6)
    s_waitcnt vmcnt(4)
    v_mfma_f32_32x32x16_bf16 v[60:75], v[200:203], v[244:247], v[60:75]
    v_mfma_f32_32x32x16_bf16 v[76:91], v[200:203], v[248:251], v[76:91]
    ds_read_b128 v[244:247], v14 offset:31744
    ds_read_b128 v[248:251], v14 offset:64512
    s_waitcnt lgkmcnt(6)
    s_waitcnt vmcnt(3)
    v_mfma_f32_32x32x16_bf16 v[60:75], v[204:207], v[220:223], v[60:75]
    v_mfma_f32_32x32x16_bf16 v[76:91], v[204:207], v[224:227], v[76:91]
    s_waitcnt lgkmcnt(4)
    s_waitcnt vmcnt(2)
    v_mfma_f32_32x32x16_bf16 v[60:75], v[208:211], v[228:231], v[60:75]
    v_mfma_f32_32x32x16_bf16 v[76:91], v[208:211], v[232:235], v[76:91]
    s_waitcnt lgkmcnt(2)
    s_waitcnt vmcnt(1)
    v_mfma_f32_32x32x16_bf16 v[60:75], v[212:215], v[236:239], v[60:75]
    v_mfma_f32_32x32x16_bf16 v[76:91], v[212:215], v[240:243], v[76:91]
    s_waitcnt lgkmcnt(0)
    s_waitcnt vmcnt(0)
    v_mfma_f32_32x32x16_bf16 v[60:75], v[216:219], v[244:247], v[60:75]
    v_mfma_f32_32x32x16_bf16 v[76:91], v[216:219], v[248:251], v[76:91]
    s_branch L_chain1_kernel_w7b
L_chain1_kernel_w7a:
    s_lshl_b32 s30, s20, 13
    s_lshl_b32 s31, s22, 10
    s_add_u32 s30, s30, s31
    s_add_u32 s30, s30, 20447232
    s_add_u32 m0, s31, 149504
    s_nop 0
    buffer_load_dwordx4 v14, s[12:15], s30 offen sc1 lds
    s_lshl_b32 s30, s20, 16
    s_lshl_b32 s31, s22, 12
    s_add_u32 s30, s30, s31
    s_add_u32 s30, s30, 2097152
    s_add_u32 m0, s31, 0
    s_add_u32 s26, s30, 0
    buffer_load_dwordx4 v14, s[12:15], s26 offen sc1 lds
    s_add_u32 m0, s31, 32768
    s_add_u32 s26, s30, 32768
    buffer_load_dwordx4 v14, s[12:15], s26 offen sc1 lds
    s_add_u32 m0, s31, 1024
    s_add_u32 s26, s30, 1024
    buffer_load_dwordx4 v14, s[12:15], s26 offen sc1 lds
    s_add_u32 m0, s31, 33792
    s_add_u32 s26, s30, 33792
    buffer_load_dwordx4 v14, s[12:15], s26 offen sc1 lds
    s_add_u32 m0, s31, 2048
    s_add_u32 s26, s30, 2048
    buffer_load_dwordx4 v14, s[12:15], s26 offen sc1 lds
    s_add_u32 m0, s31, 34816
    s_add_u32 s26, s30, 34816
    buffer_load_dwordx4 v14, s[12:15], s26 offen sc1 lds
    s_add_u32 m0, s31, 3072
    s_add_u32 s26, s30, 3072
    buffer_load_dwordx4 v14, s[12:15], s26 offen sc1 lds
    s_add_u32 m0, s31, 35840
    s_add_u32 s26, s30, 35840
    buffer_load_dwordx4 v14, s[12:15], s26 offen sc1 lds
    s_waitcnt vmcnt(6)
    s_barrier
    s_waitcnt vmcnt(4)
    s_barrier
    s_waitcnt vmcnt(2)
    s_barrier
    s_waitcnt vmcnt(0)
    s_barrier
L_chain1_kernel_w7b:
    s_barrier
    s_cmp_eq_u32 s22, 7
    s_cbranch_scc1 L_chain1_kernel_ne53
    s_lshl_b32 s30, s22, 7
    s_add_u32 s30, s30, 148480
    v_lshrrev_b32 v3, 5, v0
    v_lshlrev_b32 v3, 4, v3
    v_add_u32 v3, s30, v3
    ds_read_b128 v[92:95], v3 offset:0
    ds_read_b128 v[96:99], v3 offset:32
    ds_read_b128 v[100:103], v3 offset:64
    ds_read_b128 v[104:107], v3 offset:96
    s_mul_i32 s32, s21, 7
    s_add_u32 s32, s32, s22
    s_lshl_b32 s32, s32, 11
    s_mul_i32 s33, s20, 229376
    s_add_u32 s32, s32, s33
    s_add_u32 s32, s32, 12582912
    s_waitcnt lgkmcnt(0)
    v_pk_mul_f32 v[108:109], v[92:93], v[18:19] op_sel:[0,1] op_sel_hi:[1,1]
    v_pk_mul_f32 v[110:111], v[94:95], v[18:19] op_sel:[0,1] op_sel_hi:[1,1]
    v_pk_mul_f32 v[112:113], v[96:97], v[18:19] op_sel:[0,1] op_sel_hi:[1,1]
    v_pk_mul_f32 v[114:115], v[98:99], v[18:19] op_sel:[0,1] op_sel_hi:[1,1]
    v_pk_mul_f32 v[116:117], v[100:101], v[18:19] op_sel:[0,1] op_sel_hi:[1,1]
    v_pk_mul_f32 v[118:119], v[102:103], v[18:19] op_sel:[0,1] op_sel_hi:[1,1]
    v_pk_mul_f32 v[120:121], v[104:105], v[18:19] op_sel:[0,1] op_sel_hi:[1,1]
    v_pk_mul_f32 v[122:123], v[106:107], v[18:19] op_sel:[0,1] op_sel_hi:[1,1]
    v_pk_fma_f32 v[60:61], v[60:61], v[18:19], v[108:109] op_sel:[0,0,0] op_sel_hi:[1,0,1]
    v_pk_fma_f32 v[62:63], v[62:63], v[18:19], v[110:111] op_sel:[0,0,0] op_sel_hi:[1,0,1]
    v_pk_fma_f32 v[64:65], v[64:65], v[18:19], v[112:113] op_sel:[0,0,0] op_sel_hi:[1,0,1]
    v_pk_fma_f32 v[66:67], v[66:67], v[18:19], v[114:115] op_sel:[0,0,0] op_sel_hi:[1,0,1]
    v_pk_fma_f32 v[68:69], v[68:69], v[18:19], v[116:117] op_sel:[0,0,0] op_sel_hi:[1,0,1]
    v_pk_fma_f32 v[70:71], v[70:71], v[18:19], v[118:119] op_sel:[0,0,0] op_sel_hi:[1,0,1]
    v_pk_fma_f32 v[72:73], v[72:73], v[18:19], v[120:121] op_sel:[0,0,0] op_sel_hi:[1,0,1]
    v_pk_fma_f32 v[74:75], v[74:75], v[18:19], v[122:123] op_sel:[0,0,0] op_sel_hi:[1,0,1]
    v_pk_mul_f32 v[108:109], v[60:61], v[60:61]
    v_pk_mul_f32 v[110:111], v[62:63], v[62:63]
    v_pk_mul_f32 v[112:113], v[64:65], v[64:65]
    v_pk_mul_f32 v[114:115], v[66:67], v[66:67]
    v_pk_mul_f32 v[116:117], v[68:69], v[68:69]
    v_pk_mul_f32 v[118:119], v[70:71], v[70:71]
    v_pk_mul_f32 v[120:121], v[72:73], v[72:73]
    v_pk_mul_f32 v[122:123], v[74:75], v[74:75]
    v_pk_fma_f32 v[108:109], v[108:109], v[22:23], v[22:23] op_sel:[0,1,0] op_sel_hi:[1,1,0]
    v_pk_fma_f32 v[110:111], v[110:111], v[22:23], v[22:23] op_sel:[0,1,0] op_sel_hi:[1,1,0]
    v_pk_fma_f32 v[112:113], v[112:113], v[22:23], v[22:23] op_sel:[0,1,0] op_sel_hi:[1,1,0]
    v_pk_fma_f32 v[114:115], v[114:115], v[22:23], v[22:23] op_sel:[0,1,0] op_sel_hi:[1,1,0]
    v_pk_fma_f32 v[116:117], v[116:117], v[22:23], v[22:23] op_sel:[0,1,0] op_sel_hi:[1,1,0]
    v_pk_fma_f32 v[118:119], v[118:119], v[22:23], v[22:23] op_sel:[0,1,0] op_sel_hi:[1,1,0]
    v_pk_fma_f32 v[120:121], v[120:121], v[22:23], v[22:23] op_sel:[0,1,0] op_sel_hi:[1,1,0]
    v_pk_fma_f32 v[122:123], v[122:123], v[22:23], v[22:23] op_sel:[0,1,0] op_sel_hi:[1,1,0]
    v_pk_mul_f32 v[108:109], v[108:109], v[60:61]
    v_pk_mul_f32 v[110:111], v[110:111], v[62:63]
    v_pk_mul_f32 v[112:113], v[112:113], v[64:65]
    v_pk_mul_f32 v[114:115], v[114:115], v[66:67]
    v_pk_mul_f32 v[116:117], v[116:117], v[68:69]
    v_pk_mul_f32 v[118:119], v[118:119], v[70:71]
    v_pk_mul_f32 v[120:121], v[120:121], v[72:73]
    v_pk_mul_f32 v[122:123], v[122:123], v[74:75]
    v_exp_f32 v108, v108
    v_exp_f32 v109, v109
    v_exp_f32 v110, v110
    v_exp_f32 v111, v111
    v_exp_f32 v112, v112
    v_exp_f32 v113, v113
    v_exp_f32 v114, v114
    v_exp_f32 v115, v115
    v_exp_f32 v116, v116
    v_exp_f32 v117, v117
    v_exp_f32 v118, v118
    v_exp_f32 v119, v119
    v_exp_f32 v120, v120
    v_exp_f32 v121, v121
    v_exp_f32 v122, v122
    v_exp_f32 v123, v123
    v_pk_add_f32 v[108:109], v[108:109], 1.0 op_sel_hi:[1,0]
    v_pk_add_f32 v[110:111], v[110:111], 1.0 op_sel_hi:[1,0]
    v_pk_add_f32 v[112:113], v[112:113], 1.0 op_sel_hi:[1,0]
    v_pk_add_f32 v[114:115], v[114:115], 1.0 op_sel_hi:[1,0]
    v_pk_add_f32 v[116:117], v[116:117], 1.0 op_sel_hi:[1,0]
    v_pk_add_f32 v[118:119], v[118:119], 1.0 op_sel_hi:[1,0]
    v_pk_add_f32 v[120:121], v[120:121], 1.0 op_sel_hi:[1,0]
    v_pk_add_f32 v[122:123], v[122:123], 1.0 op_sel_hi:[1,0]
    v_rcp_f32 v108, v108
    v_rcp_f32 v109, v109
    v_rcp_f32 v110, v110
    v_rcp_f32 v111, v111
    v_rcp_f32 v112, v112
    v_rcp_f32 v113, v113
    v_rcp_f32 v114, v114
    v_rcp_f32 v115, v115
    v_rcp_f32 v116, v116
    v_rcp_f32 v117, v117
    v_rcp_f32 v118, v118
    v_rcp_f32 v119, v119
    v_rcp_f32 v120, v120
    v_rcp_f32 v121, v121
    v_rcp_f32 v122, v122
    v_rcp_f32 v123, v123
    v_pk_mul_f32 v[60:61], v[60:61], v[108:109]
    v_pk_mul_f32 v[62:63], v[62:63], v[110:111]
    v_pk_mul_f32 v[64:65], v[64:65], v[112:113]
    v_pk_mul_f32 v[66:67], v[66:67], v[114:115]
    v_pk_mul_f32 v[68:69], v[68:69], v[116:117]
    v_pk_mul_f32 v[70:71], v[70:71], v[118:119]
    v_pk_mul_f32 v[72:73], v[72:73], v[120:121]
    v_pk_mul_f32 v[74:75], v[74:75], v[122:123]
    v_cvt_pk_bf16_f32 v124, v60, v61
    v_cvt_pk_bf16_f32 v125, v62, v63
    v_cvt_pk_bf16_f32 v126, v64, v65
    v_cvt_pk_bf16_f32 v127, v66, v67
    v_cvt_pk_bf16_f32 v128, v68, v69
    v_cvt_pk_bf16_f32 v129, v70, v71
    v_cvt_pk_bf16_f32 v130, v72, v73
    v_cvt_pk_bf16_f32 v131, v74, v75
    s_cmp_eq_u32 s29, 1
    s_cbranch_scc1 L_chain1_kernel_sf55
    buffer_store_dwordx4 v[124:127], v14, s[12:15], s32 offen sc1
    buffer_store_dwordx4 v[128:131], v14, s[12:15], s32 offen offset:1024 sc1
    s_branch L_chain1_kernel_sd56
L_chain1_kernel_sf55:
    buffer_store_dwordx4 v[124:127], v14, s[12:15], s32 offen
    buffer_store_dwordx4 v[128:131], v14, s[12:15], s32 offen offset:1024
L_chain1_kernel_sd56:
    s_add_u32 s32, s32, 114688
    v_pk_mul_f32 v[108:109], v[92:93], v[20:21] op_sel:[0,1] op_sel_hi:[1,1]
    v_pk_mul_f32 v[110:111], v[94:95], v[20:21] op_sel:[0,1] op_sel_hi:[1,1]
    v_pk_mul_f32 v[112:113], v[96:97], v[20:21] op_sel:[0,1] op_sel_hi:[1,1]
    v_pk_mul_f32 v[114:115], v[98:99], v[20:21] op_sel:[0,1] op_sel_hi:[1,1]
    v_pk_mul_f32 v[116:117], v[100:101], v[20:21] op_sel:[0,1] op_sel_hi:[1,1]
    v_pk_mul_f32 v[118:119], v[102:103], v[20:21] op_sel:[0,1] op_sel_hi:[1,1]
    v_pk_mul_f32 v[120:121], v[104:105], v[20:21] op_sel:[0,1] op_sel_hi:[1,1]
    v_pk_mul_f32 v[122:123], v[106:107], v[20:21] op_sel:[0,1] op_sel_hi:[1,1]
    v_pk_fma_f32 v[76:77], v[76:77], v[20:21], v[108:109] op_sel:[0,0,0] op_sel_hi:[1,0,1]
    v_pk_fma_f32 v[78:79], v[78:79], v[20:21], v[110:111] op_sel:[0,0,0] op_sel_hi:[1,0,1]
    v_pk_fma_f32 v[80:81], v[80:81], v[20:21], v[112:113] op_sel:[0,0,0] op_sel_hi:[1,0,1]
    v_pk_fma_f32 v[82:83], v[82:83], v[20:21], v[114:115] op_sel:[0,0,0] op_sel_hi:[1,0,1]
    v_pk_fma_f32 v[84:85], v[84:85], v[20:21], v[116:117] op_sel:[0,0,0] op_sel_hi:[1,0,1]
    v_pk_fma_f32 v[86:87], v[86:87], v[20:21], v[118:119] op_sel:[0,0,0] op_sel_hi:[1,0,1]
    v_pk_fma_f32 v[88:89], v[88:89], v[20:21], v[120:121] op_sel:[0,0,0] op_sel_hi:[1,0,1]
    v_pk_fma_f32 v[90:91], v[90:91], v[20:21], v[122:123] op_sel:[0,0,0] op_sel_hi:[1,0,1]
    v_pk_mul_f32 v[108:109], v[76:77], v[76:77]
    v_pk_mul_f32 v[110:111], v[78:79], v[78:79]
    v_pk_mul_f32 v[112:113], v[80:81], v[80:81]
    v_pk_mul_f32 v[114:115], v[82:83], v[82:83]
    v_pk_mul_f32 v[116:117], v[84:85], v[84:85]
    v_pk_mul_f32 v[118:119], v[86:87], v[86:87]
    v_pk_mul_f32 v[120:121], v[88:89], v[88:89]
    v_pk_mul_f32 v[122:123], v[90:91], v[90:91]
    v_pk_fma_f32 v[108:109], v[108:109], v[22:23], v[22:23] op_sel:[0,1,0] op_sel_hi:[1,1,0]
    v_pk_fma_f32 v[110:111], v[110:111], v[22:23], v[22:23] op_sel:[0,1,0] op_sel_hi:[1,1,0]
    v_pk_fma_f32 v[112:113], v[112:113], v[22:23], v[22:23] op_sel:[0,1,0] op_sel_hi:[1,1,0]
    v_pk_fma_f32 v[114:115], v[114:115], v[22:23], v[22:23] op_sel:[0,1,0] op_sel_hi:[1,1,0]
    v_pk_fma_f32 v[116:117], v[116:117], v[22:23], v[22:23] op_sel:[0,1,0] op_sel_hi:[1,1,0]
    v_pk_fma_f32 v[118:119], v[118:119], v[22:23], v[22:23] op_sel:[0,1,0] op_sel_hi:[1,1,0]
    v_pk_fma_f32 v[120:121], v[120:121], v[22:23], v[22:23] op_sel:[0,1,0] op_sel_hi:[1,1,0]
    v_pk_fma_f32 v[122:123], v[122:123], v[22:23], v[22:23] op_sel:[0,1,0] op_sel_hi:[1,1,0]
    v_pk_mul_f32 v[108:109], v[108:109], v[76:77]
    v_pk_mul_f32 v[110:111], v[110:111], v[78:79]
    v_pk_mul_f32 v[112:113], v[112:113], v[80:81]
    v_pk_mul_f32 v[114:115], v[114:115], v[82:83]
    v_pk_mul_f32 v[116:117], v[116:117], v[84:85]
    v_pk_mul_f32 v[118:119], v[118:119], v[86:87]
    v_pk_mul_f32 v[120:121], v[120:121], v[88:89]
    v_pk_mul_f32 v[122:123], v[122:123], v[90:91]
    v_exp_f32 v108, v108
    v_exp_f32 v109, v109
    v_exp_f32 v110, v110
    v_exp_f32 v111, v111
    v_exp_f32 v112, v112
    v_exp_f32 v113, v113
    v_exp_f32 v114, v114
    v_exp_f32 v115, v115
    v_exp_f32 v116, v116
    v_exp_f32 v117, v117
    v_exp_f32 v118, v118
    v_exp_f32 v119, v119
    v_exp_f32 v120, v120
    v_exp_f32 v121, v121
    v_exp_f32 v122, v122
    v_exp_f32 v123, v123
    v_pk_add_f32 v[108:109], v[108:109], 1.0 op_sel_hi:[1,0]
    v_pk_add_f32 v[110:111], v[110:111], 1.0 op_sel_hi:[1,0]
    v_pk_add_f32 v[112:113], v[112:113], 1.0 op_sel_hi:[1,0]
    v_pk_add_f32 v[114:115], v[114:115], 1.0 op_sel_hi:[1,0]
    v_pk_add_f32 v[116:117], v[116:117], 1.0 op_sel_hi:[1,0]
    v_pk_add_f32 v[118:119], v[118:119], 1.0 op_sel_hi:[1,0]
    v_pk_add_f32 v[120:121], v[120:121], 1.0 op_sel_hi:[1,0]
    v_pk_add_f32 v[122:123], v[122:123], 1.0 op_sel_hi:[1,0]
    v_rcp_f32 v108, v108
    v_rcp_f32 v109, v109
    v_rcp_f32 v110, v110
    v_rcp_f32 v111, v111
    v_rcp_f32 v112, v112
    v_rcp_f32 v113, v113
    v_rcp_f32 v114, v114
    v_rcp_f32 v115, v115
    v_rcp_f32 v116, v116
    v_rcp_f32 v117, v117
    v_rcp_f32 v118, v118
    v_rcp_f32 v119, v119
    v_rcp_f32 v120, v120
    v_rcp_f32 v121, v121
    v_rcp_f32 v122, v122
    v_rcp_f32 v123, v123
    v_pk_mul_f32 v[76:77], v[76:77], v[108:109]
    v_pk_mul_f32 v[78:79], v[78:79], v[110:111]
    v_pk_mul_f32 v[80:81], v[80:81], v[112:113]
    v_pk_mul_f32 v[82:83], v[82:83], v[114:115]
    v_pk_mul_f32 v[84:85], v[84:85], v[116:117]
    v_pk_mul_f32 v[86:87], v[86:87], v[118:119]
    v_pk_mul_f32 v[88:89], v[88:89], v[120:121]
    v_pk_mul_f32 v[90:91], v[90:91], v[122:123]
    v_cvt_pk_bf16_f32 v124, v76, v77
    v_cvt_pk_bf16_f32 v125, v78, v79
    v_cvt_pk_bf16_f32 v126, v80, v81
    v_cvt_pk_bf16_f32 v127, v82, v83
    v_cvt_pk_bf16_f32 v128, v84, v85
    v_cvt_pk_bf16_f32 v129, v86, v87
    v_cvt_pk_bf16_f32 v130, v88, v89
    v_cvt_pk_bf16_f32 v131, v90, v91
    s_cmp_eq_u32 s29, 1
    s_cbranch_scc1 L_chain1_kernel_sf57
    buffer_store_dwordx4 v[124:127], v14, s[12:15], s32 offen sc1
    buffer_store_dwordx4 v[128:131], v14, s[12:15], s32 offen offset:1024 sc1
    s_branch L_chain1_kernel_sd58
L_chain1_kernel_sf57:
    buffer_store_dwordx4 v[124:127], v14, s[12:15], s32 offen
    buffer_store_dwordx4 v[128:131], v14, s[12:15], s32 offen offset:1024
L_chain1_kernel_sd58:
L_chain1_kernel_ne53:
    s_waitcnt vmcnt(0)
    s_barrier
    s_cmp_ge_u32 s22, 4
    s_cbranch_scc1 L_chain1_kernel_ldtail
    s_cmp_lg_u32 s22, 0
    s_cbranch_scc1 L_chain1_kernel_ya59
    s_mov_b64 s[40:41], exec
    s_cmp_eq_u32 s29, 1
    s_cbranch_scc0 L_chain1_kernel_yb60
    s_mov_b32 s30, 1
    s_atomic_add s30, s[48:49], 0xc000
    s_branch L_chain1_kernel_yc61
L_chain1_kernel_yb60:
    s_add_u32 s30, s50, 49152
    s_mov_b64 exec, 1
    v_mov_b32 v2, s30
    v_mov_b32 v3, 1
    buffer_atomic_add v3, v2, s[12:15], 0 offen sc1
L_chain1_kernel_yc61:
    s_mov_b64 exec, s[40:41]
L_chain1_kernel_ya59:
    s_cmp_lg_u32 s22, 0
    s_cbranch_scc1 L_chain1_kernel_yk62
    s_mov_b64 s[40:41], exec
    s_cmp_eq_u32 s29, 1
    s_cbranch_scc0 L_chain1_kernel_ys63
    s_mov_b32 s47, 0
L_chain1_kernel_yl65:
    s_mov_b32 s31, 0
    s_atomic_add s31, s[48:49], 0xc000 glc
    s_add_u32 s47, s47, 1
    s_cmp_gt_u32 s47, 262144
    s_cbranch_scc1 L_chain1_kernel_ye66
    s_waitcnt lgkmcnt(0)
    s_cmp_ge_u32 s31, 8
    s_cbranch_scc0 L_chain1_kernel_yl65
L_chain1_kernel_ye66:
    s_waitcnt lgkmcnt(0)
    s_branch L_chain1_kernel_yd64
L_chain1_kernel_ys63:
    s_add_u32 s30, s50, 49152
    s_mov_b64 exec, 1
    v_mov_b32 v2, s30
    v_mov_b32 v3, 8
    s_mov_b32 s47, 0
L_chain1_kernel_pl67:
    buffer_load_dword v4, v2, s[12:15], 0 offen sc1
    s_add_u32 s47, s47, 1
    s_cmp_gt_u32 s47, 262144
    s_cbranch_scc1 L_chain1_kernel_pd68
    s_waitcnt vmcnt(0)
    v_cmp_ge_u32 vcc, v4, v3
    s_nop 1
    s_cmp_eq_u32 vcc_lo, 1
    s_cbranch_scc0 L_chain1_kernel_pl67
L_chain1_kernel_pd68:
    s_waitcnt vmcnt(0)
L_chain1_kernel_yd64:
    s_mov_b64 exec, s[40:41]
L_chain1_kernel_yk62:
    s_barrier
    s_lshl_b32 s44, s21, 1
    s_add_u32 s44, s44, s24
    s_lshl_b32 s45, s44, 1
    s_mul_i32 s30, s24, 1024
    s_add_u32 s30, s30, 2048
    v_lshlrev_b32 v11, 4, v0
    v_add_u32 v8, s30, v11
    s_lshl_b32 s30, s23, 10
    v_add_u32 v11, s30, v11
    v_add_u32 v9, 65536, v8
    v_add_u32 v12, 65536, v11
    s_barrier
    ds_read_b128 v[124:127], v11 offset:0
    ds_read_b128 v[128:131], v8 offset:0
    ds_read_b128 v[132:135], v11 offset:4096
    ds_read_b128 v[136:139], v8 offset:4096
    ds_read_b128 v[140:143], v11 offset:8192
    ds_read_b128 v[144:147], v8 offset:8192
    ds_read_b128 v[148:151], v11 offset:12288
    ds_read_b128 v[152:155], v8 offset:12288
    s_barrier
    ds_read_b128 v[156:159], v11 offset:16384
    ds_read_b128 v[160:163], v8 offset:16384
    s_waitcnt lgkmcnt(8)
    v_mfma_f32_32x32x16_bf16 v[60:75], v[128:131], v[124:127], 0
    ds_read_b128 v[124:127], v11 offset:20480
    ds_read_b128 v[128:131], v8 offset:20480
    s_waitcnt lgkmcnt(8)
    v_mfma_f32_32x32x16_bf16 v[60:75], v[136:139], v[132:135], v[60:75]
    ds_read_b128 v[132:135], v11 offset:24576
    ds_read_b128 v[136:139], v8 offset:24576
    s_waitcnt lgkmcnt(8)
    v_mfma_f32_32x32x16_bf16 v[60:75], v[144:147], v[140:143], v[60:75]
    ds_read_b128 v[140:143], v11 offset:28672
    ds_read_b128 v[144:147], v8 offset:28672
    s_waitcnt lgkmcnt(8)
    v_mfma_f32_32x32x16_bf16 v[60:75], v[152:155], v[148:151], v[60:75]
    s_barrier
    ds_read_b128 v[148:151], v11 offset:32768
    ds_read_b128 v[152:155], v8 offset:32768
    s_waitcnt lgkmcnt(8)
    v_mfma_f32_32x32x16_bf16 v[60:75], v[160:163], v[156:159], v[60:75]
    ds_read_b128 v[156:159], v11 offset:36864
    ds_read_b128 v[160:163], v8 offset:36864
    s_waitcnt lgkmcnt(8)
    v_mfma_f32_32x32x16_bf16 v[60:75], v[128:131], v[124:127], v[60:75]
    ds_read_b128 v[124:127], v11 offset:40960
    ds_read_b128 v[128:131], v8 offset:40960
    s_waitcnt lgkmcnt(8)
    v_mfma_f32_32x32x16_bf16 v[60:75], v[136:139], v[132:135], v[60:75]
    ds_read_b128 v[132:135], v11 offset:45056
    ds_read_b128 v[136:139], v8 offset:45056
    s_waitcnt lgkmcnt(8)
    v_mfma_f32_32x32x16_bf16 v[60:75], v[144:147], v[140:143], v[60:75]
    s_barrier
    ds_read_b128 v[140:143], v11 offset:49152
    ds_read_b128 v[144:147], v8 offset:49152
    s_waitcnt lgkmcnt(8)
    v_mfma_f32_32x32x16_bf16 v[60:75], v[152:155], v[148:151], v[60:75]
    ds_read_b128 v[148:151], v11 offset:53248
    ds_read_b128 v[152:155], v8 offset:53248
    s_waitcnt lgkmcnt(8)
    v_mfma_f32_32x32x16_bf16 v[60:75], v[160:163], v[156:159], v[60:75]
    ds_read_b128 v[156:159], v11 offset:57344
    ds_read_b128 v[160:163], v8 offset:57344
    s_waitcnt lgkmcnt(8)
    v_mfma_f32_32x32x16_bf16 v[60:75], v[128:131], v[124:127], v[60:75]
    ds_read_b128 v[124:127], v11 offset:61440
    ds_read_b128 v[128:131], v8 offset:61440
    s_waitcnt lgkmcnt(8)
    v_mfma_f32_32x32x16_bf16 v[60:75], v[136:139], v[132:135], v[60:75]
    s_barrier
    ds_read_b128 v[132:135], v12 offset:0
    ds_read_b128 v[136:139], v9 offset:0
    s_waitcnt lgkmcnt(8)
    v_mfma_f32_32x32x16_bf16 v[60:75], v[144:147], v[140:143], v[60:75]
    ds_read_b128 v[140:143], v12 offset:4096
    ds_read_b128 v[144:147], v9 offset:4096
    s_waitcnt lgkmcnt(8)
    v_mfma_f32_32x32x16_bf16 v[60:75], v[152:155], v[148:151], v[60:75]
    ds_read_b128 v[148:151], v12 offset:8192
    ds_read_b128 v[152:155], v9 offset:8192
    s_waitcnt lgkmcnt(8)
    v_mfma_f32_32x32x16_bf16 v[60:75], v[160:163], v[156:159], v[60:75]
    ds_read_b128 v[156:159], v12 offset:12288
    ds_read_b128 v[160:163], v9 offset:12288
    s_waitcnt lgkmcnt(8)
    v_mfma_f32_32x32x16_bf16 v[60:75], v[128:131], v[124:127], v[60:75]
    s_barrier
    ds_read_b128 v[124:127], v12 offset:16384
    ds_read_b128 v[128:131], v9 offset:16384
    s_waitcnt lgkmcnt(8)
    v_mfma_f32_32x32x16_bf16 v[60:75], v[136:139], v[132:135], v[60:75]
    ds_read_b128 v[132:135], v12 offset:20480
    ds_read_b128 v[136:139], v9 offset:20480
    s_waitcnt lgkmcnt(8)
    v_mfma_f32_32x32x16_bf16 v[60:75], v[144:147], v[140:143], v[60:75]
    ds_read_b128 v[140:143], v12 offset:24576
    ds_read_b128 v[144:147], v9 offset:24576
    s_waitcnt lgkmcnt(8)
    v_mfma_f32_32x32x16_bf16 v[60:75], v[152:155], v[148:151], v[60:75]
    ds_read_b128 v[148:151], v12 offset:28672
    ds_read_b128 v[152:155], v9 offset:28672
    s_waitcnt lgkmcnt(8)
    v_mfma_f32_32x32x16_bf16 v[60:75], v[160:163], v[156:159], v[60:75]
    s_barrier
    ds_read_b128 v[156:159], v12 offset:32768
    ds_read_b128 v[160:163], v9 offset:32768
    s_waitcnt lgkmcnt(8)
    v_mfma_f32_32x32x16_bf16 v[60:75], v[128:131], v[124:127], v[60:75]
    ds_read_b128 v[124:127], v12 offset:36864
    ds_read_b128 v[128:131], v9 offset:36864
    s_waitcnt lgkmcnt(8)
    v_mfma_f32_32x32x16_bf16 v[60:75], v[136:139], v[132:135], v[60:75]
    ds_read_b128 v[132:135], v12 offset:40960
    ds_read_b128 v[136:139], v9 offset:40960
    s_waitcnt lgkmcnt(8)
    v_mfma_f32_32x32x16_bf16 v[60:75], v[144:147], v[140:143], v[60:75]
    ds_read_b128 v[140:143], v12 offset:45056
    ds_read_b128 v[144:147], v9 offset:45056
    s_waitcnt lgkmcnt(8)
    v_mfma_f32_32x32x16_bf16 v[60:75], v[152:155], v[148:151], v[60:75]
    s_barrier
    ds_read_b128 v[148:151], v12 offset:49152
    ds_read_b128 v[152:155], v9 offset:49152
    s_waitcnt lgkmcnt(8)
    v_mfma_f32_32x32x16_bf16 v[60:75], v[160:163], v[156:159], v[60:75]
    ds_read_b128 v[156:159], v12 offset:53248
    ds_read_b128 v[160:163], v9 offset:53248
    s_waitcnt lgkmcnt(8)
    v_mfma_f32_32x32x16_bf16 v[60:75], v[128:131], v[124:127], v[60:75]
    ds_read_b128 v[124:127], v12 offset:57344
    ds_read_b128 v[128:131], v9 offset:57344
    s_waitcnt lgkmcnt(8)
    v_mfma_f32_32x32x16_bf16 v[60:75], v[136:139], v[132:135], v[60:75]
    ds_read_b128 v[132:135], v12 offset:61440
    ds_read_b128 v[136:139], v9 offset:61440
    s_waitcnt lgkmcnt(8)
    v_mfma_f32_32x32x16_bf16 v[60:75], v[144:147], v[140:143], v[60:75]
    s_barrier
    ds_read_b128 v[140:143], v11 offset:0
    ds_read_b128 v[144:147], v8 offset:0
    s_waitcnt lgkmcnt(8)
    v_mfma_f32_32x32x16_bf16 v[60:75], v[152:155], v[148:151], v[60:75]
    ds_read_b128 v[148:151], v11 offset:4096
    ds_read_b128 v[152:155], v8 offset:4096
    s_waitcnt lgkmcnt(8)
    v_mfma_f32_32x32x16_bf16 v[60:75], v[160:163], v[156:159], v[60:75]
    ds_read_b128 v[156:159], v11 offset:8192
    ds_read_b128 v[160:163], v8 offset:8192
    s_waitcnt lgkmcnt(8)
    v_mfma_f32_32x32x16_bf16 v[60:75], v[128:131], v[124:127], v[60:75]
    ds_read_b128 v[124:127], v11 offset:12288
    ds_read_b128 v[128:131], v8 offset:12288
    s_waitcnt lgkmcnt(8)
    v_mfma_f32_32x32x16_bf16 v[60:75], v[136:139], v[132:135], v[60:75]
    s_barrier
    ds_read_b128 v[132:135], v11 offset:16384
    ds_read_b128 v[136:139], v8 offset:16384
    s_waitcnt lgkmcnt(8)
    v_mfma_f32_32x32x16_bf16 v[60:75], v[144:147], v[140:143], v[60:75]
    ds_read_b128 v[140:143], v11 offset:20480
    ds_read_b128 v[144:147], v8 offset:20480
    s_waitcnt lgkmcnt(8)
    v_mfma_f32_32x32x16_bf16 v[60:75], v[152:155], v[148:151], v[60:75]
    ds_read_b128 v[148:151], v11 offset:24576
    ds_read_b128 v[152:155], v8 offset:24576
    s_waitcnt lgkmcnt(8)
    v_mfma_f32_32x32x16_bf16 v[60:75], v[160:163], v[156:159], v[60:75]
    ds_read_b128 v[156:159], v11 offset:28672
    ds_read_b128 v[160:163], v8 offset:28672
    s_waitcnt lgkmcnt(8)
    v_mfma_f32_32x32x16_bf16 v[60:75], v[128:131], v[124:127], v[60:75]
    s_barrier
    ds_read_b128 v[124:127], v11 offset:32768
    ds_read_b128 v[128:131], v8 offset:32768
    s_waitcnt lgkmcnt(8)
    v_mfma_f32_32x32x16_bf16 v[60:75], v[136:139], v[132:135], v[60:75]
    ds_read_b128 v[132:135], v11 offset:36864
    ds_read_b128 v[136:139], v8 offset:36864
    s_waitcnt lgkmcnt(8)
    v_mfma_f32_32x32x16_bf16 v[60:75], v[144:147], v[140:143], v[60:75]
    ds_read_b128 v[140:143], v11 offset:40960
    ds_read_b128 v[144:147], v8 offset:40960
    s_waitcnt lgkmcnt(8)
    v_mfma_f32_32x32x16_bf16 v[60:75], v[152:155], v[148:151], v[60:75]
    ds_read_b128 v[148:151], v11 offset:45056
    ds_read_b128 v[152:155], v8 offset:45056
    s_waitcnt lgkmcnt(8)
    v_mfma_f32_32x32x16_bf16 v[60:75], v[160:163], v[156:159], v[60:75]
    s_barrier
    ds_read_b128 v[156:159], v11 offset:49152
    ds_read_b128 v[160:163], v8 offset:49152
    s_waitcnt lgkmcnt(8)
    v_mfma_f32_32x32x16_bf16 v[60:75], v[128:131], v[124:127], v[60:75]
    ds_read_b128 v[124:127], v11 offset:53248
    ds_read_b128 v[128:131], v8 offset:53248
    s_waitcnt lgkmcnt(8)
    v_mfma_f32_32x32x16_bf16 v[60:75], v[136:139], v[132:135], v[60:75]
    ds_read_b128 v[132:135], v11 offset:57344
    ds_read_b128 v[136:139], v8 offset:57344
    s_waitcnt lgkmcnt(8)
    v_mfma_f32_32x32x16_bf16 v[60:75], v[144:147], v[140:143], v[60:75]
    ds_read_b128 v[140:143], v11 offset:61440
    ds_read_b128 v[144:147], v8 offset:61440
    s_waitcnt lgkmcnt(8)
    v_mfma_f32_32x32x16_bf16 v[60:75], v[152:155], v[148:151], v[60:75]
    s_barrier
    ds_read_b128 v[148:151], v12 offset:0
    ds_read_b128 v[152:155], v9 offset:0
    s_waitcnt lgkmcnt(8)
    v_mfma_f32_32x32x16_bf16 v[60:75], v[160:163], v[156:159], v[60:75]
    ds_read_b128 v[156:159], v12 offset:4096
    ds_read_b128 v[160:163], v9 offset:4096
    s_waitcnt lgkmcnt(8)
    v_mfma_f32_32x32x16_bf16 v[60:75], v[128:131], v[124:127], v[60:75]
    ds_read_b128 v[124:127], v12 offset:8192
    ds_read_b128 v[128:131], v9 offset:8192
    s_waitcnt lgkmcnt(8)
    v_mfma_f32_32x32x16_bf16 v[60:75], v[136:139], v[132:135], v[60:75]
    ds_read_b128 v[132:135], v12 offset:12288
    ds_read_b128 v[136:139], v9 offset:12288
    s_waitcnt lgkmcnt(8)
    v_mfma_f32_32x32x16_bf16 v[60:75], v[144:147], v[140:143], v[60:75]
    s_barrier
    ds_read_b128 v[140:143], v12 offset:16384
    ds_read_b128 v[144:147], v9 offset:16384
    s_waitcnt lgkmcnt(8)
    v_mfma_f32_32x32x16_bf16 v[60:75], v[152:155], v[148:151], v[60:75]
    ds_read_b128 v[148:151], v12 offset:20480
    ds_read_b128 v[152:155], v9 offset:20480
    s_waitcnt lgkmcnt(8)
    v_mfma_f32_32x32x16_bf16 v[60:75], v[160:163], v[156:159], v[60:75]
    ds_read_b128 v[156:159], v12 offset:24576
    ds_read_b128 v[160:163], v9 offset:24576
    s_waitcnt lgkmcnt(8)
    v_mfma_f32_32x32x16_bf16 v[60:75], v[128:131], v[124:127], v[60:75]
    ds_read_b128 v[124:127], v12 offset:28672
    ds_read_b128 v[128:131], v9 offset:28672
    s_waitcnt lgkmcnt(8)
    v_mfma_f32_32x32x16_bf16 v[60:75], v[136:139], v[132:135], v[60:75]
    s_barrier
    ds_read_b128 v[132:135], v12 offset:32768
    ds_read_b128 v[136:139], v9 offset:32768
    s_waitcnt lgkmcnt(8)
    v_mfma_f32_32x32x16_bf16 v[60:75], v[144:147], v[140:143], v[60:75]
    ds_read_b128 v[140:143], v12 offset:36864
    ds_read_b128 v[144:147], v9 offset:36864
    s_waitcnt lgkmcnt(8)
    v_mfma_f32_32x32x16_bf16 v[60:75], v[152:155], v[148:151], v[60:75]
    ds_read_b128 v[148:151], v12 offset:40960
    ds_read_b128 v[152:155], v9 offset:40960
    s_waitcnt lgkmcnt(8)
    v_mfma_f32_32x32x16_bf16 v[60:75], v[160:163], v[156:159], v[60:75]
    ds_read_b128 v[156:159], v12 offset:45056
    ds_read_b128 v[160:163], v9 offset:45056
    s_waitcnt lgkmcnt(8)
    v_mfma_f32_32x32x16_bf16 v[60:75], v[128:131], v[124:127], v[60:75]
    s_barrier
    ds_read_b128 v[124:127], v12 offset:49152
    ds_read_b128 v[128:131], v9 offset:49152
    s_waitcnt lgkmcnt(8)
    v_mfma_f32_32x32x16_bf16 v[60:75], v[136:139], v[132:135], v[60:75]
    ds_read_b128 v[132:135], v12 offset:53248
    ds_read_b128 v[136:139], v9 offset:53248
    s_waitcnt lgkmcnt(8)
    v_mfma_f32_32x32x16_bf16 v[60:75], v[144:147], v[140:143], v[60:75]
    ds_read_b128 v[140:143], v12 offset:57344
    ds_read_b128 v[144:147], v9 offset:57344
    s_waitcnt lgkmcnt(8)
    v_mfma_f32_32x32x16_bf16 v[60:75], v[152:155], v[148:151], v[60:75]
    ds_read_b128 v[148:151], v12 offset:61440
    ds_read_b128 v[152:155], v9 offset:61440
    s_waitcnt lgkmcnt(8)
    v_mfma_f32_32x32x16_bf16 v[60:75], v[160:163], v[156:159], v[60:75]
    s_barrier
    ds_read_b128 v[156:159], v11 offset:0
    ds_read_b128 v[160:163], v8 offset:0
    s_waitcnt lgkmcnt(8)
    v_mfma_f32_32x32x16_bf16 v[60:75], v[128:131], v[124:127], v[60:75]
    ds_read_b128 v[124:127], v11 offset:4096
    ds_read_b128 v[128:131], v8 offset:4096
    s_waitcnt lgkmcnt(8)
    v_mfma_f32_32x32x16_bf16 v[60:75], v[136:139], v[132:135], v[60:75]
    ds_read_b128 v[132:135], v11 offset:8192
    ds_read_b128 v[136:139], v8 offset:8192
    s_waitcnt lgkmcnt(8)
    v_mfma_f32_32x32x16_bf16 v[60:75], v[144:147], v[140:143], v[60:75]
    ds_read_b128 v[140:143], v11 offset:12288
    ds_read_b128 v[144:147], v8 offset:12288
    s_waitcnt lgkmcnt(8)
    v_mfma_f32_32x32x16_bf16 v[60:75], v[152:155], v[148:151], v[60:75]
    s_barrier
    ds_read_b128 v[148:151], v11 offset:16384
    ds_read_b128 v[152:155], v8 offset:16384
    s_waitcnt lgkmcnt(8)
    v_mfma_f32_32x32x16_bf16 v[60:75], v[160:163], v[156:159], v[60:75]
    ds_read_b128 v[156:159], v11 offset:20480
    ds_read_b128 v[160:163], v8 offset:20480
    s_waitcnt lgkmcnt(8)
    v_mfma_f32_32x32x16_bf16 v[60:75], v[128:131], v[124:127], v[60:75]
    ds_read_b128 v[124:127], v11 offset:24576
    ds_read_b128 v[128:131], v8 offset:24576
    s_waitcnt lgkmcnt(8)
    v_mfma_f32_32x32x16_bf16 v[60:75], v[136:139], v[132:135], v[60:75]
    ds_read_b128 v[132:135], v11 offset:28672
    ds_read_b128 v[136:139], v8 offset:28672
    s_waitcnt lgkmcnt(8)
    v_mfma_f32_32x32x16_bf16 v[60:75], v[144:147], v[140:143], v[60:75]
    s_barrier
    ds_read_b128 v[140:143], v11 offset:32768
    ds_read_b128 v[144:147], v8 offset:32768
    s_waitcnt lgkmcnt(8)
    v_mfma_f32_32x32x16_bf16 v[60:75], v[152:155], v[148:151], v[60:75]
    ds_read_b128 v[148:151], v11 offset:36864
    ds_read_b128 v[152:155], v8 offset:36864
    s_waitcnt lgkmcnt(8)
    v_mfma_f32_32x32x16_bf16 v[60:75], v[160:163], v[156:159], v[60:75]
    ds_read_b128 v[156:159], v11 offset:40960
    ds_read_b128 v[160:163], v8 offset:40960
    s_waitcnt lgkmcnt(8)
    v_mfma_f32_32x32x16_bf16 v[60:75], v[128:131], v[124:127], v[60:75]
    ds_read_b128 v[124:127], v11 offset:45056
    ds_read_b128 v[128:131], v8 offset:45056
    s_waitcnt lgkmcnt(8)
    v_mfma_f32_32x32x16_bf16 v[60:75], v[136:139], v[132:135], v[60:75]
    s_barrier
    ds_read_b128 v[132:135], v11 offset:49152
    ds_read_b128 v[136:139], v8 offset:49152
    s_waitcnt lgkmcnt(8)
    v_mfma_f32_32x32x16_bf16 v[60:75], v[144:147], v[140:143], v[60:75]
    ds_read_b128 v[140:143], v11 offset:53248
    ds_read_b128 v[144:147], v8 offset:53248
    s_waitcnt lgkmcnt(8)
    v_mfma_f32_32x32x16_bf16 v[60:75], v[152:155], v[148:151], v[60:75]
    ds_read_b128 v[148:151], v11 offset:57344
    ds_read_b128 v[152:155], v8 offset:57344
    s_waitcnt lgkmcnt(8)
    v_mfma_f32_32x32x16_bf16 v[60:75], v[160:163], v[156:159], v[60:75]
    ds_read_b128 v[156:159], v11 offset:61440
    ds_read_b128 v[160:163], v8 offset:61440
    s_waitcnt lgkmcnt(8)
    v_mfma_f32_32x32x16_bf16 v[60:75], v[128:131], v[124:127], v[60:75]
    s_barrier
    ds_read_b128 v[124:127], v12 offset:0
    ds_read_b128 v[128:131], v9 offset:0
    s_waitcnt lgkmcnt(8)
    v_mfma_f32_32x32x16_bf16 v[60:75], v[136:139], v[132:135], v[60:75]
    ds_read_b128 v[132:135], v12 offset:4096
    ds_read_b128 v[136:139], v9 offset:4096
    s_waitcnt lgkmcnt(8)
    v_mfma_f32_32x32x16_bf16 v[60:75], v[144:147], v[140:143], v[60:75]
    ds_read_b128 v[140:143], v12 offset:8192
    ds_read_b128 v[144:147], v9 offset:8192
    s_waitcnt lgkmcnt(8)
    v_mfma_f32_32x32x16_bf16 v[60:75], v[152:155], v[148:151], v[60:75]
    ds_read_b128 v[148:151], v12 offset:12288
    ds_read_b128 v[152:155], v9 offset:12288
    s_waitcnt lgkmcnt(8)
    v_mfma_f32_32x32x16_bf16 v[60:75], v[160:163], v[156:159], v[60:75]
    s_barrier
    ds_read_b128 v[156:159], v12 offset:16384
    ds_read_b128 v[160:163], v9 offset:16384
    s_waitcnt lgkmcnt(8)
    v_mfma_f32_32x32x16_bf16 v[60:75], v[128:131], v[124:127], v[60:75]
    ds_read_b128 v[124:127], v12 offset:20480
    ds_read_b128 v[128:131], v9 offset:20480
    s_waitcnt lgkmcnt(8)
    v_mfma_f32_32x32x16_bf16 v[60:75], v[136:139], v[132:135], v[60:75]
    ds_read_b128 v[132:135], v12 offset:24576
    ds_read_b128 v[136:139], v9 offset:24576
    s_waitcnt lgkmcnt(8)
    v_mfma_f32_32x32x16_bf16 v[60:75], v[144:147], v[140:143], v[60:75]
    ds_read_b128 v[140:143], v12 offset:28672
    ds_read_b128 v[144:147], v9 offset:28672
    s_waitcnt lgkmcnt(8)
    v_mfma_f32_32x32x16_bf16 v[60:75], v[152:155], v[148:151], v[60:75]
    s_barrier
    ds_read_b128 v[148:151], v12 offset:32768
    ds_read_b128 v[152:155], v9 offset:32768
    s_waitcnt lgkmcnt(8)
    v_mfma_f32_32x32x16_bf16 v[60:75], v[160:163], v[156:159], v[60:75]
    ds_read_b128 v[156:159], v12 offset:36864
    ds_read_b128 v[160:163], v9 offset:36864
    s_waitcnt lgkmcnt(8)
    v_mfma_f32_32x32x16_bf16 v[60:75], v[128:131], v[124:127], v[60:75]
    ds_read_b128 v[124:127], v12 offset:40960
    ds_read_b128 v[128:131], v9 offset:40960
    s_waitcnt lgkmcnt(8)
    v_mfma_f32_32x32x16_bf16 v[60:75], v[136:139], v[132:135], v[60:75]
    ds_read_b128 v[132:135], v12 offset:45056
    ds_read_b128 v[136:139], v9 offset:45056
    s_waitcnt lgkmcnt(8)
    v_mfma_f32_32x32x16_bf16 v[60:75], v[144:147], v[140:143], v[60:75]
    s_barrier
    ds_read_b128 v[140:143], v12 offset:49152
    ds_read_b128 v[144:147], v9 offset:49152
    s_waitcnt lgkmcnt(8)
    v_mfma_f32_32x32x16_bf16 v[60:75], v[152:155], v[148:151], v[60:75]
    ds_read_b128 v[148:151], v12 offset:53248
    ds_read_b128 v[152:155], v9 offset:53248
    s_waitcnt lgkmcnt(8)
    v_mfma_f32_32x32x16_bf16 v[60:75], v[160:163], v[156:159], v[60:75]
    ds_read_b128 v[156:159], v12 offset:57344
    ds_read_b128 v[160:163], v9 offset:57344
    s_waitcnt lgkmcnt(8)
    v_mfma_f32_32x32x16_bf16 v[60:75], v[128:131], v[124:127], v[60:75]
    ds_read_b128 v[124:127], v12 offset:61440
    ds_read_b128 v[128:131], v9 offset:61440
    s_waitcnt lgkmcnt(8)
    v_mfma_f32_32x32x16_bf16 v[60:75], v[136:139], v[132:135], v[60:75]
    s_barrier
    ds_read_b128 v[132:135], v11 offset:0
    ds_read_b128 v[136:139], v8 offset:0
    s_waitcnt lgkmcnt(8)
    v_mfma_f32_32x32x16_bf16 v[60:75], v[144:147], v[140:143], v[60:75]
    ds_read_b128 v[140:143], v11 offset:4096
    ds_read_b128 v[144:147], v8 offset:4096
    s_waitcnt lgkmcnt(8)
    v_mfma_f32_32x32x16_bf16 v[60:75], v[152:155], v[148:151], v[60:75]
    ds_read_b128 v[148:151], v11 offset:8192
    ds_read_b128 v[152:155], v8 offset:8192
    s_waitcnt lgkmcnt(8)
    v_mfma_f32_32x32x16_bf16 v[60:75], v[160:163], v[156:159], v[60:75]
    ds_read_b128 v[156:159], v11 offset:12288
    ds_read_b128 v[160:163], v8 offset:12288
    s_waitcnt lgkmcnt(8)
    v_mfma_f32_32x32x16_bf16 v[60:75], v[128:131], v[124:127], v[60:75]
    s_barrier
    ds_read_b128 v[124:127], v11 offset:16384
    ds_read_b128 v[128:131], v8 offset:16384
    s_waitcnt lgkmcnt(8)
    v_mfma_f32_32x32x16_bf16 v[60:75], v[136:139], v[132:135], v[60:75]
    ds_read_b128 v[132:135], v11 offset:20480
    ds_read_b128 v[136:139], v8 offset:20480
    s_waitcnt lgkmcnt(8)
    v_mfma_f32_32x32x16_bf16 v[60:75], v[144:147], v[140:143], v[60:75]
    ds_read_b128 v[140:143], v11 offset:24576
    ds_read_b128 v[144:147], v8 offset:24576
    s_waitcnt lgkmcnt(8)
    v_mfma_f32_32x32x16_bf16 v[60:75], v[152:155], v[148:151], v[60:75]
    ds_read_b128 v[148:151], v11 offset:28672
    ds_read_b128 v[152:155], v8 offset:28672
    s_waitcnt lgkmcnt(8)
    v_mfma_f32_32x32x16_bf16 v[60:75], v[160:163], v[156:159], v[60:75]
    s_barrier
    ds_read_b128 v[156:159], v11 offset:32768
    ds_read_b128 v[160:163], v8 offset:32768
    s_waitcnt lgkmcnt(8)
    v_mfma_f32_32x32x16_bf16 v[60:75], v[128:131], v[124:127], v[60:75]
    ds_read_b128 v[124:127], v11 offset:36864
    ds_read_b128 v[128:131], v8 offset:36864
    s_waitcnt lgkmcnt(8)
    v_mfma_f32_32x32x16_bf16 v[60:75], v[136:139], v[132:135], v[60:75]
    ds_read_b128 v[132:135], v11 offset:40960
    ds_read_b128 v[136:139], v8 offset:40960
    s_waitcnt lgkmcnt(8)
    v_mfma_f32_32x32x16_bf16 v[60:75], v[144:147], v[140:143], v[60:75]
    ds_read_b128 v[140:143], v11 offset:45056
    ds_read_b128 v[144:147], v8 offset:45056
    s_waitcnt lgkmcnt(8)
    v_mfma_f32_32x32x16_bf16 v[60:75], v[152:155], v[148:151], v[60:75]
    s_barrier
    ds_read_b128 v[148:151], v11 offset:49152
    ds_read_b128 v[152:155], v8 offset:49152
    s_waitcnt lgkmcnt(8)
    v_mfma_f32_32x32x16_bf16 v[60:75], v[160:163], v[156:159], v[60:75]
    ds_read_b128 v[156:159], v11 offset:53248
    ds_read_b128 v[160:163], v8 offset:53248
    s_waitcnt lgkmcnt(8)
    v_mfma_f32_32x32x16_bf16 v[60:75], v[128:131], v[124:127], v[60:75]
    ds_read_b128 v[124:127], v11 offset:57344
    ds_read_b128 v[128:131], v8 offset:57344
    s_waitcnt lgkmcnt(8)
    v_mfma_f32_32x32x16_bf16 v[60:75], v[136:139], v[132:135], v[60:75]
    ds_read_b128 v[132:135], v11 offset:61440
    ds_read_b128 v[136:139], v8 offset:61440
    s_waitcnt lgkmcnt(8)
    v_mfma_f32_32x32x16_bf16 v[60:75], v[144:147], v[140:143], v[60:75]
    s_waitcnt lgkmcnt(6)
    v_mfma_f32_32x32x16_bf16 v[60:75], v[152:155], v[148:151], v[60:75]
    s_waitcnt lgkmcnt(4)
    v_mfma_f32_32x32x16_bf16 v[60:75], v[160:163], v[156:159], v[60:75]
    s_waitcnt lgkmcnt(2)
    v_mfma_f32_32x32x16_bf16 v[60:75], v[128:131], v[124:127], v[60:75]
    s_waitcnt lgkmcnt(0)
    v_mfma_f32_32x32x16_bf16 v[60:75], v[136:139], v[132:135], v[60:75]
    s_nop 15
    v_pk_add_f32 v[44:45], v[44:45], v[60:61]
    v_pk_add_f32 v[46:47], v[46:47], v[62:63]
    v_pk_add_f32 v[48:49], v[48:49], v[64:65]
    v_pk_add_f32 v[50:51], v[50:51], v[66:67]
    v_pk_add_f32 v[52:53], v[52:53], v[68:69]
    v_pk_add_f32 v[54:55], v[54:55], v[70:71]
    v_pk_add_f32 v[56:57], v[56:57], v[72:73]
    v_pk_add_f32 v[58:59], v[58:59], v[74:75]
    v_pk_add_f32 v[28:29], v[28:29], v[44:45]
    v_pk_add_f32 v[30:31], v[30:31], v[46:47]
    v_pk_add_f32 v[32:33], v[32:33], v[48:49]
    v_pk_add_f32 v[34:35], v[34:35], v[50:51]
    v_pk_add_f32 v[36:37], v[36:37], v[52:53]
    v_pk_add_f32 v[38:39], v[38:39], v[54:55]
    v_pk_add_f32 v[40:41], v[40:41], v[56:57]
    v_pk_add_f32 v[42:43], v[42:43], v[58:59]
    s_lshl_b32 s30, s28, 15
    s_lshl_b32 s31, s44, 6
    s_add_u32 s30, s30, s31
    v_and_b32 v2, 31, v0
    v_lshlrev_b32 v2, 10, v2
    v_lshrrev_b32 v3, 5, v0
    v_lshl_add_u32 v2, v3, 4, v2
    v_cvt_pk_bf16_f32 v236, v28, v29
    v_cvt_pk_bf16_f32 v237, v30, v31
    v_cvt_pk_bf16_f32 v238, v32, v33
    v_cvt_pk_bf16_f32 v239, v34, v35
    v_cvt_pk_bf16_f32 v240, v36, v37
    v_cvt_pk_bf16_f32 v241, v38, v39
    v_cvt_pk_bf16_f32 v242, v40, v41
    v_cvt_pk_bf16_f32 v243, v42, v43
    s_nop 1
    v_permlane32_swap_b32 v236, v238
    v_permlane32_swap_b32 v237, v239
    v_permlane32_swap_b32 v240, v242
    v_permlane32_swap_b32 v241, v243
    s_nop 1
    buffer_store_dwordx4 v[236:239], v2, s[16:19], s30 offen offset:0
    buffer_store_dwordx4 v[240:243], v2, s[16:19], s30 offen offset:32
    s_endpgm
L_chain1_kernel_ld:
    s_and_b32 s52, s20, 7
    s_sub_u32 s30, s20, 28
    s_cmp_ge_u32 s20, 28
    s_cselect_b32 s53, s30, s20
    s_mul_i32 s30, s21, 65536
    s_lshl_b32 s31, s25, 10
    s_add_u32 s30, s30, s31
    s_add_u32 s30, s30, 26738688
    v_lshlrev_b32 v2, 4, v0
    v_add_u32 v2, s30, v2
    s_mul_i32 s27, s25, 4096
    s_lshl_b32 s30, s20, 1
    s_mul_i32 s30, s30, 32768
    s_lshl_b32 s31, s25, 10
    s_add_u32 s30, s30, s31
    s_add_u32 s30, s30, 4194304
    v_lshlrev_b32 v4, 4, v0
    v_add_u32 v4, s30, v4
    v_add_u32 v5, 32768, v4
    s_mov_b32 s54, 0
    s_add_u32 m0, s27, 0
    s_nop 0
    buffer_load_dwordx4 v4, s[12:15], s54 offen lds
    s_add_u32 m0, s27, 1024
    s_nop 0
    buffer_load_dwordx4 v5, s[12:15], s54 offen lds
    s_mov_b32 s54, 0
    s_add_u32 m0, s27, 2048
    s_add_u32 s26, s54, 0
    buffer_load_dwordx4 v2, s[12:15], s26 offen lds
    s_add_u32 m0, s27, 3072
    s_add_u32 s26, s54, 32768
    buffer_load_dwordx4 v2, s[12:15], s26 offen lds
    s_mov_b32 s54, 4096
    s_add_u32 m0, s27, 16384
    s_nop 0
    buffer_load_dwordx4 v4, s[12:15], s54 offen lds
    s_add_u32 m0, s27, 17408
    s_nop 0
    buffer_load_dwordx4 v5, s[12:15], s54 offen lds
    s_mov_b32 s54, 4096
    s_add_u32 m0, s27, 18432
    s_add_u32 s26, s54, 0
    buffer_load_dwordx4 v2, s[12:15], s26 offen lds
    s_add_u32 m0, s27, 19456
    s_add_u32 s26, s54, 32768
    buffer_load_dwordx4 v2, s[12:15], s26 offen lds
    s_mov_b32 s54, 8192
    s_add_u32 m0, s27, 32768
    s_nop 0
    buffer_load_dwordx4 v4, s[12:15], s54 offen lds
    s_add_u32 m0, s27, 33792
    s_nop 0
    buffer_load_dwordx4 v5, s[12:15], s54 offen lds
    s_mov_b32 s54, 8192
    s_add_u32 m0, s27, 34816
    s_add_u32 s26, s54, 0
    buffer_load_dwordx4 v2, s[12:15], s26 offen lds
    s_add_u32 m0, s27, 35840
    s_add_u32 s26, s54, 32768
    buffer_load_dwordx4 v2, s[12:15], s26 offen lds
    s_mov_b32 s54, 12288
    s_add_u32 m0, s27, 49152
    s_nop 0
    buffer_load_dwordx4 v4, s[12:15], s54 offen lds
    s_add_u32 m0, s27, 50176
    s_nop 0
    buffer_load_dwordx4 v5, s[12:15], s54 offen lds
    s_mov_b32 s54, 12288
    s_add_u32 m0, s27, 51200
    s_add_u32 s26, s54, 0
    buffer_load_dwordx4 v2, s[12:15], s26 offen lds
    s_add_u32 m0, s27, 52224
    s_add_u32 s26, s54, 32768
    buffer_load_dwordx4 v2, s[12:15], s26 offen lds
    s_mov_b32 s54, 16384
    s_add_u32 m0, s27, 65536
    s_nop 0
    buffer_load_dwordx4 v4, s[12:15], s54 offen lds
    s_add_u32 m0, s27, 66560
    s_nop 0
    buffer_load_dwordx4 v5, s[12:15], s54 offen lds
    s_mov_b32 s54, 16384
    s_add_u32 m0, s27, 67584
    s_add_u32 s26, s54, 0
    buffer_load_dwordx4 v2, s[12:15], s26 offen lds
    s_add_u32 m0, s27, 68608
    s_add_u32 s26, s54, 32768
    buffer_load_dwordx4 v2, s[12:15], s26 offen lds
    s_mov_b32 s54, 20480
    s_add_u32 m0, s27, 81920
    s_nop 0
    buffer_load_dwordx4 v4, s[12:15], s54 offen lds
    s_add_u32 m0, s27, 82944
    s_nop 0
    buffer_load_dwordx4 v5, s[12:15], s54 offen lds
    s_mov_b32 s54, 20480
    s_add_u32 m0, s27, 83968
    s_add_u32 s26, s54, 0
    buffer_load_dwordx4 v2, s[12:15], s26 offen lds
    s_add_u32 m0, s27, 84992
    s_add_u32 s26, s54, 32768
    buffer_load_dwordx4 v2, s[12:15], s26 offen lds
    s_mov_b32 s54, 24576
    s_add_u32 m0, s27, 98304
    s_nop 0
    buffer_load_dwordx4 v4, s[12:15], s54 offen lds
    s_add_u32 m0, s27, 99328
    s_nop 0
    buffer_load_dwordx4 v5, s[12:15], s54 offen lds
    s_mov_b32 s54, 24576
    s_add_u32 m0, s27, 100352
    s_add_u32 s26, s54, 0
    buffer_load_dwordx4 v2, s[12:15], s26 offen lds
    s_add_u32 m0, s27, 101376
    s_add_u32 s26, s54, 32768
    buffer_load_dwordx4 v2, s[12:15], s26 offen lds
    s_mov_b32 s54, 28672
    s_add_u32 m0, s27, 114688
    s_nop 0
    buffer_load_dwordx4 v4, s[12:15], s54 offen lds
    s_add_u32 m0, s27, 115712
    s_nop 0
    buffer_load_dwordx4 v5, s[12:15], s54 offen lds
    s_mov_b32 s54, 28672
    s_add_u32 m0, s27, 116736
    s_add_u32 s26, s54, 0
    buffer_load_dwordx4 v2, s[12:15], s26 offen lds
    s_add_u32 m0, s27, 117760
    s_add_u32 s26, s54, 32768
    buffer_load_dwordx4 v2, s[12:15], s26 offen lds
    s_waitcnt vmcnt(28)
    s_barrier
    s_waitcnt vmcnt(24)
    s_barrier
    s_waitcnt vmcnt(20)
    s_barrier
    s_waitcnt vmcnt(16)
    s_barrier
    s_waitcnt vmcnt(12)
    s_barrier
    s_mul_i32 s30, s21, 65536
    s_lshl_b32 s31, s25, 10
    s_add_u32 s30, s30, s31
    s_add_u32 s30, s30, 27262976
    v_lshlrev_b32 v2, 4, v0
    v_add_u32 v2, s30, v2
    s_mul_i32 s27, s25, 4096
    s_mul_i32 s26, s21, 256
    s_add_u32 s26, s26, 40960
    v_lshlrev_b32 v12, 4, v0
    s_mov_b32 m0, 148480
    s_nop 0
    buffer_load_dwordx4 v12, s[12:15], s26 offen lds
    s_mov_b32 s54, 0
    s_add_u32 m0, s27, 2048
    s_add_u32 s26, s54, 0
    buffer_load_dwordx4 v2, s[12:15], s26 offen lds
    s_add_u32 m0, s27, 3072
    s_add_u32 s26, s54, 32768
    buffer_load_dwordx4 v2, s[12:15], s26 offen lds
    s_mov_b32 s54, 4096
    s_add_u32 m0, s27, 18432
    s_add_u32 s26, s54, 0
    buffer_load_dwordx4 v2, s[12:15], s26 offen lds
    s_add_u32 m0, s27, 19456
    s_add_u32 s26, s54, 32768
    buffer_load_dwordx4 v2, s[12:15], s26 offen lds
    s_mov_b32 s54, 8192
    s_add_u32 m0, s27, 34816
    s_add_u32 s26, s54, 0
    buffer_load_dwordx4 v2, s[12:15], s26 offen lds
    s_add_u32 m0, s27, 35840
    s_add_u32 s26, s54, 32768
    buffer_load_dwordx4 v2, s[12:15], s26 offen lds
    s_waitcnt vmcnt(15)
    s_barrier
    s_mov_b32 s54, 12288
    s_add_u32 m0, s27, 51200
    s_add_u32 s26, s54, 0
    buffer_load_dwordx4 v2, s[12:15], s26 offen lds
    s_add_u32 m0, s27, 52224
    s_add_u32 s26, s54, 32768
    buffer_load_dwordx4 v2, s[12:15], s26 offen lds
    s_waitcnt vmcnt(13)
    s_barrier
    s_mov_b32 s54, 16384
    s_add_u32 m0, s27, 67584
    s_add_u32 s26, s54, 0
    buffer_load_dwordx4 v2, s[12:15], s26 offen lds
    s_add_u32 m0, s27, 68608
    s_add_u32 s26, s54, 32768
    buffer_load_dwordx4 v2, s[12:15], s26 offen lds
    s_waitcnt vmcnt(11)
    s_barrier
    s_mov_b32 s54, 20480
    s_add_u32 m0, s27, 83968
    s_add_u32 s26, s54, 0
    buffer_load_dwordx4 v2, s[12:15], s26 offen lds
    s_add_u32 m0, s27, 84992
    s_add_u32 s26, s54, 32768
    buffer_load_dwordx4 v2, s[12:15], s26 offen lds
    s_barrier
    s_mov_b32 s54, 24576
    s_add_u32 m0, s27, 100352
    s_add_u32 s26, s54, 0
    buffer_load_dwordx4 v2, s[12:15], s26 offen lds
    s_add_u32 m0, s27, 101376
    s_add_u32 s26, s54, 32768
    buffer_load_dwordx4 v2, s[12:15], s26 offen lds
    s_mov_b32 s54, 28672
    s_add_u32 m0, s27, 116736
    s_add_u32 s26, s54, 0
    buffer_load_dwordx4 v2, s[12:15], s26 offen lds
    s_add_u32 m0, s27, 117760
    s_add_u32 s26, s54, 32768
    buffer_load_dwordx4 v2, s[12:15], s26 offen lds
    s_lshl_b32 s30, s20, 1
    s_mul_i32 s30, s30, 32768
    s_lshl_b32 s31, s25, 10
    s_add_u32 s30, s30, s31
    s_add_u32 s30, s30, 2097152
    v_lshlrev_b32 v4, 4, v0
    v_add_u32 v4, s30, v4
    v_add_u32 v5, 32768, v4
    s_barrier
    s_barrier
    s_lshl_b32 s26, s20, 13
    s_lshl_b32 s30, s25, 11
    s_add_u32 s26, s26, s30
    s_add_u32 s26, s26, 20185088
    s_add_u32 m0, s30, 149504
    v_lshlrev_b32 v12, 4, v0
    buffer_load_dwordx4 v12, s[12:15], s26 offen sc1 lds
    buffer_load_dwordx4 v12, s[12:15], s26 offen offset:1024 sc1 lds
    s_mov_b32 s54, 0
    s_add_u32 m0, s27, 0
    s_nop 0
    buffer_load_dwordx4 v4, s[12:15], s54 offen sc1 lds
    s_add_u32 m0, s27, 1024
    s_nop 0
    buffer_load_dwordx4 v5, s[12:15], s54 offen sc1 lds
    s_mov_b32 s54, 4096
    s_add_u32 m0, s27, 16384
    s_nop 0
    buffer_load_dwordx4 v4, s[12:15], s54 offen sc1 lds
    s_add_u32 m0, s27, 17408
    s_nop 0
    buffer_load_dwordx4 v5, s[12:15], s54 offen sc1 lds
    s_mov_b32 s54, 8192
    s_add_u32 m0, s27, 32768
    s_nop 0
    buffer_load_dwordx4 v4, s[12:15], s54 offen sc1 lds
    s_add_u32 m0, s27, 33792
    s_nop 0
    buffer_load_dwordx4 v5, s[12:15], s54 offen sc1 lds
    s_mov_b32 s54, 12288
    s_add_u32 m0, s27, 49152
    s_nop 0
    buffer_load_dwordx4 v4, s[12:15], s54 offen sc1 lds
    s_add_u32 m0, s27, 50176
    s_nop 0
    buffer_load_dwordx4 v5, s[12:15], s54 offen sc1 lds
    s_waitcnt vmcnt(6)
    s_barrier
    s_mov_b32 s54, 16384
    s_add_u32 m0, s27, 65536
    s_nop 0
    buffer_load_dwordx4 v4, s[12:15], s54 offen sc1 lds
    s_add_u32 m0, s27, 66560
    s_nop 0
    buffer_load_dwordx4 v5, s[12:15], s54 offen sc1 lds
    s_mov_b32 s54, 20480
    s_add_u32 m0, s27, 81920
    s_nop 0
    buffer_load_dwordx4 v4, s[12:15], s54 offen sc1 lds
    s_add_u32 m0, s27, 82944
    s_nop 0
    buffer_load_dwordx4 v5, s[12:15], s54 offen sc1 lds
    s_waitcnt vmcnt(8)
    s_barrier
    s_mov_b32 s54, 24576
    s_add_u32 m0, s27, 98304
    s_nop 0
    buffer_load_dwordx4 v4, s[12:15], s54 offen sc1 lds
    s_add_u32 m0, s27, 99328
    s_nop 0
    buffer_load_dwordx4 v5, s[12:15], s54 offen sc1 lds
    s_mov_b32 s54, 28672
    s_add_u32 m0, s27, 114688
    s_nop 0
    buffer_load_dwordx4 v4, s[12:15], s54 offen sc1 lds
    s_add_u32 m0, s27, 115712
    s_nop 0
    buffer_load_dwordx4 v5, s[12:15], s54 offen sc1 lds
    s_waitcnt vmcnt(10)
    s_barrier
    s_mul_i32 s30, s21, 65536
    s_lshl_b32 s31, s25, 10
    s_add_u32 s30, s30, s31
    s_add_u32 s30, s30, 27787264
    v_lshlrev_b32 v2, 4, v0
    v_add_u32 v2, s30, v2
    s_mul_i32 s27, s25, 4096
    s_mov_b32 s54, 0
    s_add_u32 m0, s27, 2048
    s_add_u32 s26, s54, 0
    buffer_load_dwordx4 v2, s[12:15], s26 offen lds
    s_add_u32 m0, s27, 3072
    s_add_u32 s26, s54, 32768
    buffer_load_dwordx4 v2, s[12:15], s26 offen lds
    s_waitcnt vmcnt(10)
    s_barrier
    s_mov_b32 s54, 4096
    s_add_u32 m0, s27, 18432
    s_add_u32 s26, s54, 0
    buffer_load_dwordx4 v2, s[12:15], s26 offen lds
    s_add_u32 m0, s27, 19456
    s_add_u32 s26, s54, 32768
    buffer_load_dwordx4 v2, s[12:15], s26 offen lds
    s_waitcnt vmcnt(10)
    s_barrier
    s_mov_b32 s54, 8192
    s_add_u32 m0, s27, 34816
    s_add_u32 s26, s54, 0
    buffer_load_dwordx4 v2, s[12:15], s26 offen lds
    s_add_u32 m0, s27, 35840
    s_add_u32 s26, s54, 32768
    buffer_load_dwordx4 v2, s[12:15], s26 offen lds
    s_waitcnt vmcnt(10)
    s_barrier
    s_mov_b32 s54, 12288
    s_add_u32 m0, s27, 51200
    s_add_u32 s26, s54, 0
    buffer_load_dwordx4 v2, s[12:15], s26 offen lds
    s_add_u32 m0, s27, 52224
    s_add_u32 s26, s54, 32768
    buffer_load_dwordx4 v2, s[12:15], s26 offen lds
    s_waitcnt vmcnt(10)
    s_barrier
    s_mov_b32 s54, 16384
    s_add_u32 m0, s27, 67584
    s_add_u32 s26, s54, 0
    buffer_load_dwordx4 v2, s[12:15], s26 offen lds
    s_add_u32 m0, s27, 68608
    s_add_u32 s26, s54, 32768
    buffer_load_dwordx4 v2, s[12:15], s26 offen lds
    s_waitcnt vmcnt(10)
    s_barrier
    s_mov_b32 s54, 20480
    s_add_u32 m0, s27, 83968
    s_add_u32 s26, s54, 0
    buffer_load_dwordx4 v2, s[12:15], s26 offen lds
    s_add_u32 m0, s27, 84992
    s_add_u32 s26, s54, 32768
    buffer_load_dwordx4 v2, s[12:15], s26 offen lds
    s_barrier
    s_mov_b32 s54, 24576
    s_add_u32 m0, s27, 100352
    s_add_u32 s26, s54, 0
    buffer_load_dwordx4 v2, s[12:15], s26 offen lds
    s_add_u32 m0, s27, 101376
    s_add_u32 s26, s54, 32768
    buffer_load_dwordx4 v2, s[12:15], s26 offen lds
    s_mov_b32 s54, 28672
    s_add_u32 m0, s27, 116736
    s_add_u32 s26, s54, 0
    buffer_load_dwordx4 v2, s[12:15], s26 offen lds
    s_add_u32 m0, s27, 117760
    s_add_u32 s26, s54, 32768
    buffer_load_dwordx4 v2, s[12:15], s26 offen lds
    v_lshrrev_b32 v13, 5, v0
    v_lshlrev_b32 v13, 9, v13
    s_lshl_b32 s30, s25, 10
    v_add_u32 v13, s30, v13
    s_lshl_b32 s30, s20, 16
    s_add_u32 s30, s30, 4194304
    v_add_u32 v13, s30, v13
    v_and_b32 v12, 31, v0
    v_add_u32 v4, -1, v12
    v_bfe_u32 v14, v4, 5, 1
    v_lshlrev_b32 v14, 15, v14
    v_and_b32 v15, 31, v4
    v_lshl_add_u32 v14, v15, 4, v14
    v_add_u32 v4, v14, v13
    v_add_u32 v5, 31, v12
    v_bfe_u32 v14, v5, 5, 1
    v_lshlrev_b32 v14, 15, v14
    v_and_b32 v15, 31, v5
    v_lshl_add_u32 v14, v15, 4, v14
    v_add_u32 v5, v14, v13
    v_add_u32 v6, 1, v12
    v_bfe_u32 v14, v6, 5, 1
    v_lshlrev_b32 v14, 15, v14
    v_and_b32 v15, 31, v6
    v_lshl_add_u32 v14, v15, 4, v14
    v_add_u32 v6, v14, v13
    v_add_u32 v7, 33, v12
    v_bfe_u32 v14, v7, 5, 1
    v_lshlrev_b32 v14, 15, v14
    v_and_b32 v15, 31, v7
    v_lshl_add_u32 v14, v15, 4, v14
    v_add_u32 v7, v14, v13
    v_add_u32 v8, -2, v12
    v_bfe_u32 v14, v8, 5, 1
    v_lshlrev_b32 v14, 15, v14
    v_and_b32 v15, 31, v8
    v_lshl_add_u32 v14, v15, 4, v14
    v_add_u32 v8, v14, v13
    v_add_u32 v9, 30, v12
    v_bfe_u32 v14, v9, 5, 1
    v_lshlrev_b32 v14, 15, v14
    v_and_b32 v15, 31, v9
    v_lshl_add_u32 v14, v15, 4, v14
    v_add_u32 v9, v14, v13
    v_add_u32 v10, 2, v12
    v_bfe_u32 v14, v10, 5, 1
    v_lshlrev_b32 v14, 15, v14
    v_and_b32 v15, 31, v10
    v_lshl_add_u32 v14, v15, 4, v14
    v_add_u32 v10, v14, v13
    v_add_u32 v11, 34, v12
    v_bfe_u32 v14, v11, 5, 1
    v_lshlrev_b32 v14, 15, v14
    v_and_b32 v15, 31, v11
    v_lshl_add_u32 v14, v15, 4, v14
    v_add_u32 v11, v14, v13
    s_barrier
    s_barrier
    s_mov_b32 s54, 0
    s_add_u32 m0, s27, 0
    s_nop 0
    s_mov_b32 exec_lo, 0xfffffffe
    s_mov_b32 exec_hi, 0xfffffffe
    buffer_load_dwordx4 v4, s[12:15], s54 offen sc1 lds
    s_mov_b64 exec, -1
    s_add_u32 m0, s27, 1024
    s_nop 0
    buffer_load_dwordx4 v5, s[12:15], s54 offen sc1 lds
    s_mov_b32 s54, 4096
    s_add_u32 m0, s27, 16384
    s_nop 0
    s_mov_b32 exec_lo, 0xfffffffe
    s_mov_b32 exec_hi, 0xfffffffe
    buffer_load_dwordx4 v4, s[12:15], s54 offen sc1 lds
    s_mov_b64 exec, -1
    s_add_u32 m0, s27, 17408
    s_nop 0
    buffer_load_dwordx4 v5, s[12:15], s54 offen sc1 lds
    s_mov_b32 s54, 8192
    s_add_u32 m0, s27, 32768
    s_nop 0
    buffer_load_dwordx4 v6, s[12:15], s54 offen sc1 lds
    s_add_u32 m0, s27, 33792
    s_nop 0
    s_mov_b32 exec_lo, 0x7fffffff
    s_mov_b32 exec_hi, 0x7fffffff
    buffer_load_dwordx4 v7, s[12:15], s54 offen sc1 lds
    s_mov_b64 exec, -1
    s_mov_b32 s54, 12288
    s_add_u32 m0, s27, 49152
    s_nop 0
    buffer_load_dwordx4 v6, s[12:15], s54 offen sc1 lds
    s_add_u32 m0, s27, 50176
    s_nop 0
    s_mov_b32 exec_lo, 0x7fffffff
    s_mov_b32 exec_hi, 0x7fffffff
    buffer_load_dwordx4 v7, s[12:15], s54 offen sc1 lds
    s_mov_b64 exec, -1
    s_waitcnt vmcnt(6)
    s_barrier
    s_mov_b32 s54, 16384
    s_add_u32 m0, s27, 65536
    s_nop 0
    s_mov_b32 exec_lo, 0xfffffffc
    s_mov_b32 exec_hi, 0xfffffffc
    buffer_load_dwordx4 v8, s[12:15], s54 offen sc1 lds
    s_mov_b64 exec, -1
    s_add_u32 m0, s27, 66560
    s_nop 0
    buffer_load_dwordx4 v9, s[12:15], s54 offen sc1 lds
    s_mov_b32 s54, 20480
    s_add_u32 m0, s27, 81920
    s_nop 0
    s_mov_b32 exec_lo, 0xfffffffc
    s_mov_b32 exec_hi, 0xfffffffc
    buffer_load_dwordx4 v8, s[12:15], s54 offen sc1 lds
    s_mov_b64 exec, -1
    s_add_u32 m0, s27, 82944
    s_nop 0
    buffer_load_dwordx4 v9, s[12:15], s54 offen sc1 lds
    s_waitcnt vmcnt(8)
    s_barrier
    s_mov_b32 s54, 24576
    s_add_u32 m0, s27, 98304
    s_nop 0
    buffer_load_dwordx4 v10, s[12:15], s54 offen sc1 lds
    s_add_u32 m0, s27, 99328
    s_nop 0
    s_mov_b32 exec_lo, 0x3fffffff
    s_mov_b32 exec_hi, 0x3fffffff
    buffer_load_dwordx4 v11, s[12:15], s54 offen sc1 lds
    s_mov_b64 exec, -1
    s_mov_b32 s54, 28672
    s_add_u32 m0, s27, 114688
    s_nop 0
    buffer_load_dwordx4 v10, s[12:15], s54 offen sc1 lds
    s_add_u32 m0, s27, 115712
    s_nop 0
    s_mov_b32 exec_lo, 0x3fffffff
    s_mov_b32 exec_hi, 0x3fffffff
    buffer_load_dwordx4 v11, s[12:15], s54 offen sc1 lds
    s_mov_b64 exec, -1
    s_waitcnt vmcnt(10)
    s_barrier
    s_waitcnt vmcnt(8)
    s_barrier
    s_waitcnt vmcnt(6)
    s_barrier
    s_waitcnt vmcnt(4)
    s_barrier
    s_waitcnt vmcnt(2)
    s_barrier
    s_waitcnt vmcnt(0)
    s_barrier
    s_barrier
    s_mul_i32 s26, s21, 896
    s_add_u32 s26, s26, 45056
    v_lshlrev_b32 v12, 4, v0
    s_mov_b32 m0, 148480
    s_nop 0
    buffer_load_dwordx4 v12, s[12:15], s26 offen lds
    s_barrier
    s_branch L_chain1_kernel_com
L_chain1_kernel_ldtail:
    s_mul_i32 s30, s21, 229376
    s_lshl_b32 s31, s25, 10
    s_add_u32 s30, s30, s31
    s_add_u32 s30, s30, 30146560
    v_lshlrev_b32 v2, 4, v0
    v_add_u32 v2, s30, v2
    s_mul_i32 s27, s25, 4096
    s_mov_b32 s54, 0
    s_add_u32 m0, s27, 2048
    s_add_u32 s26, s54, 0
    buffer_load_dwordx4 v2, s[12:15], s26 offen lds
    s_add_u32 m0, s27, 3072
    s_add_u32 s26, s54, 114688
    buffer_load_dwordx4 v2, s[12:15], s26 offen lds
    s_mov_b32 s54, 4096
    s_add_u32 m0, s27, 18432
    s_add_u32 s26, s54, 0
    buffer_load_dwordx4 v2, s[12:15], s26 offen lds
    s_add_u32 m0, s27, 19456
    s_add_u32 s26, s54, 114688
    buffer_load_dwordx4 v2, s[12:15], s26 offen lds
    s_mov_b32 s54, 8192
    s_add_u32 m0, s27, 34816
    s_add_u32 s26, s54, 0
    buffer_load_dwordx4 v2, s[12:15], s26 offen lds
    s_add_u32 m0, s27, 35840
    s_add_u32 s26, s54, 114688
    buffer_load_dwordx4 v2, s[12:15], s26 offen lds
    s_mov_b32 s54, 12288
    s_add_u32 m0, s27, 51200
    s_add_u32 s26, s54, 0
    buffer_load_dwordx4 v2, s[12:15], s26 offen lds
    s_add_u32 m0, s27, 52224
    s_add_u32 s26, s54, 114688
    buffer_load_dwordx4 v2, s[12:15], s26 offen lds
    s_mov_b32 s54, 16384
    s_add_u32 m0, s27, 67584
    s_add_u32 s26, s54, 0
    buffer_load_dwordx4 v2, s[12:15], s26 offen lds
    s_add_u32 m0, s27, 68608
    s_add_u32 s26, s54, 114688
    buffer_load_dwordx4 v2, s[12:15], s26 offen lds
    s_mov_b32 s54, 20480
    s_add_u32 m0, s27, 83968
    s_add_u32 s26, s54, 0
    buffer_load_dwordx4 v2, s[12:15], s26 offen lds
    s_add_u32 m0, s27, 84992
    s_add_u32 s26, s54, 114688
    buffer_load_dwordx4 v2, s[12:15], s26 offen lds
    s_mov_b32 s54, 24576
    s_add_u32 m0, s27, 100352
    s_add_u32 s26, s54, 0
    buffer_load_dwordx4 v2, s[12:15], s26 offen lds
    s_add_u32 m0, s27, 101376
    s_add_u32 s26, s54, 114688
    buffer_load_dwordx4 v2, s[12:15], s26 offen lds
    s_mov_b32 s54, 28672
    s_add_u32 m0, s27, 116736
    s_add_u32 s26, s54, 0
    buffer_load_dwordx4 v2, s[12:15], s26 offen lds
    s_add_u32 m0, s27, 117760
    s_add_u32 s26, s54, 114688
    buffer_load_dwordx4 v2, s[12:15], s26 offen lds
    s_lshl_b32 s30, s20, 1
    s_mul_i32 s30, s30, 114688
    s_lshl_b32 s31, s25, 10
    s_add_u32 s30, s30, s31
    s_add_u32 s30, s30, 12582912
    v_lshlrev_b32 v4, 4, v0
    v_add_u32 v4, s30, v4
    v_add_u32 v5, 114688, v4
    s_barrier
    s_mov_b32 s54, 0
    s_add_u32 m0, s27, 0
    s_nop 0
    buffer_load_dwordx4 v4, s[12:15], s54 offen sc1 lds
    s_add_u32 m0, s27, 1024
    s_nop 0
    buffer_load_dwordx4 v5, s[12:15], s54 offen sc1 lds
    s_mov_b32 s54, 4096
    s_add_u32 m0, s27, 16384
    s_nop 0
    buffer_load_dwordx4 v4, s[12:15], s54 offen sc1 lds
    s_add_u32 m0, s27, 17408
    s_nop 0
    buffer_load_dwordx4 v5, s[12:15], s54 offen sc1 lds
    s_mov_b32 s54, 8192
    s_add_u32 m0, s27, 32768
    s_nop 0
    buffer_load_dwordx4 v4, s[12:15], s54 offen sc1 lds
    s_add_u32 m0, s27, 33792
    s_nop 0
    buffer_load_dwordx4 v5, s[12:15], s54 offen sc1 lds
    s_mov_b32 s54, 12288
    s_add_u32 m0, s27, 49152
    s_nop 0
    buffer_load_dwordx4 v4, s[12:15], s54 offen sc1 lds
    s_add_u32 m0, s27, 50176
    s_nop 0
    buffer_load_dwordx4 v5, s[12:15], s54 offen sc1 lds
    s_waitcnt vmcnt(6)
    s_barrier
    s_mov_b32 s54, 16384
    s_add_u32 m0, s27, 65536
    s_nop 0
    buffer_load_dwordx4 v4, s[12:15], s54 offen sc1 lds
    s_add_u32 m0, s27, 66560
    s_nop 0
    buffer_load_dwordx4 v5, s[12:15], s54 offen sc1 lds
    s_mov_b32 s54, 20480
    s_add_u32 m0, s27, 81920
    s_nop 0
    buffer_load_dwordx4 v4, s[12:15], s54 offen sc1 lds
    s_add_u32 m0, s27, 82944
    s_nop 0
    buffer_load_dwordx4 v5, s[12:15], s54 offen sc1 lds
    s_waitcnt vmcnt(8)
    s_barrier
    s_mov_b32 s54, 24576
    s_add_u32 m0, s27, 98304
    s_nop 0
    buffer_load_dwordx4 v4, s[12:15], s54 offen sc1 lds
    s_add_u32 m0, s27, 99328
    s_nop 0
    buffer_load_dwordx4 v5, s[12:15], s54 offen sc1 lds
    s_mov_b32 s54, 28672
    s_add_u32 m0, s27, 114688
    s_nop 0
    buffer_load_dwordx4 v4, s[12:15], s54 offen sc1 lds
    s_add_u32 m0, s27, 115712
    s_nop 0
    buffer_load_dwordx4 v5, s[12:15], s54 offen sc1 lds
    s_waitcnt vmcnt(10)
    s_barrier
    s_mov_b32 s54, 32768
    s_add_u32 m0, s27, 0
    s_nop 0
    buffer_load_dwordx4 v4, s[12:15], s54 offen sc1 lds
    s_add_u32 m0, s27, 1024
    s_nop 0
    buffer_load_dwordx4 v5, s[12:15], s54 offen sc1 lds
    s_mov_b32 s54, 32768
    s_add_u32 m0, s27, 2048
    s_add_u32 s26, s54, 0
    buffer_load_dwordx4 v2, s[12:15], s26 offen lds
    s_add_u32 m0, s27, 3072
    s_add_u32 s26, s54, 114688
    buffer_load_dwordx4 v2, s[12:15], s26 offen lds
    s_waitcnt vmcnt(12)
    s_barrier
    s_mov_b32 s54, 36864
    s_add_u32 m0, s27, 16384
    s_nop 0
    buffer_load_dwordx4 v4, s[12:15], s54 offen sc1 lds
    s_add_u32 m0, s27, 17408
    s_nop 0
    buffer_load_dwordx4 v5, s[12:15], s54 offen sc1 lds
    s_mov_b32 s54, 36864
    s_add_u32 m0, s27, 18432
    s_add_u32 s26, s54, 0
    buffer_load_dwordx4 v2, s[12:15], s26 offen lds
    s_add_u32 m0, s27, 19456
    s_add_u32 s26, s54, 114688
    buffer_load_dwordx4 v2, s[12:15], s26 offen lds
    s_waitcnt vmcnt(14)
    s_barrier
    s_mov_b32 s54, 40960
    s_add_u32 m0, s27, 32768
    s_nop 0
    buffer_load_dwordx4 v4, s[12:15], s54 offen sc1 lds
    s_add_u32 m0, s27, 33792
    s_nop 0
    buffer_load_dwordx4 v5, s[12:15], s54 offen sc1 lds
    s_mov_b32 s54, 40960
    s_add_u32 m0, s27, 34816
    s_add_u32 s26, s54, 0
    buffer_load_dwordx4 v2, s[12:15], s26 offen lds
    s_add_u32 m0, s27, 35840
    s_add_u32 s26, s54, 114688
    buffer_load_dwordx4 v2, s[12:15], s26 offen lds
    s_waitcnt vmcnt(16)
    s_barrier
    s_mov_b32 s54, 45056
    s_add_u32 m0, s27, 49152
    s_nop 0
    buffer_load_dwordx4 v4, s[12:15], s54 offen sc1 lds
    s_add_u32 m0, s27, 50176
    s_nop 0
    buffer_load_dwordx4 v5, s[12:15], s54 offen sc1 lds
    s_mov_b32 s54, 45056
    s_add_u32 m0, s27, 51200
    s_add_u32 s26, s54, 0
    buffer_load_dwordx4 v2, s[12:15], s26 offen lds
    s_add_u32 m0, s27, 52224
    s_add_u32 s26, s54, 114688
    buffer_load_dwordx4 v2, s[12:15], s26 offen lds
    s_waitcnt vmcnt(18)
    s_barrier
    s_mov_b32 s54, 49152
    s_add_u32 m0, s27, 65536
    s_nop 0
    buffer_load_dwordx4 v4, s[12:15], s54 offen sc1 lds
    s_add_u32 m0, s27, 66560
    s_nop 0
    buffer_load_dwordx4 v5, s[12:15], s54 offen sc1 lds
    s_mov_b32 s54, 49152
    s_add_u32 m0, s27, 67584
    s_add_u32 s26, s54, 0
    buffer_load_dwordx4 v2, s[12:15], s26 offen lds
    s_add_u32 m0, s27, 68608
    s_add_u32 s26, s54, 114688
    buffer_load_dwordx4 v2, s[12:15], s26 offen lds
    s_waitcnt vmcnt(20)
    s_barrier
    s_mov_b32 s54, 53248
    s_add_u32 m0, s27, 81920
    s_nop 0
    buffer_load_dwordx4 v4, s[12:15], s54 offen sc1 lds
    s_add_u32 m0, s27, 82944
    s_nop 0
    buffer_load_dwordx4 v5, s[12:15], s54 offen sc1 lds
    s_mov_b32 s54, 53248
    s_add_u32 m0, s27, 83968
    s_add_u32 s26, s54, 0
    buffer_load_dwordx4 v2, s[12:15], s26 offen lds
    s_add_u32 m0, s27, 84992
    s_add_u32 s26, s54, 114688
    buffer_load_dwordx4 v2, s[12:15], s26 offen lds
    s_waitcnt vmcnt(20)
    s_barrier
    s_mov_b32 s54, 57344
    s_add_u32 m0, s27, 98304
    s_nop 0
    buffer_load_dwordx4 v4, s[12:15], s54 offen sc1 lds
    s_add_u32 m0, s27, 99328
    s_nop 0
    buffer_load_dwordx4 v5, s[12:15], s54 offen sc1 lds
    s_mov_b32 s54, 57344
    s_add_u32 m0, s27, 100352
    s_add_u32 s26, s54, 0
    buffer_load_dwordx4 v2, s[12:15], s26 offen lds
    s_add_u32 m0, s27, 101376
    s_add_u32 s26, s54, 114688
    buffer_load_dwordx4 v2, s[12:15], s26 offen lds
    s_waitcnt vmcnt(20)
    s_barrier
    s_mov_b32 s54, 61440
    s_add_u32 m0, s27, 114688
    s_nop 0
    buffer_load_dwordx4 v4, s[12:15], s54 offen sc1 lds
    s_add_u32 m0, s27, 115712
    s_nop 0
    buffer_load_dwordx4 v5, s[12:15], s54 offen sc1 lds
    s_mov_b32 s54, 61440
    s_add_u32 m0, s27, 116736
    s_add_u32 s26, s54, 0
    buffer_load_dwordx4 v2, s[12:15], s26 offen lds
    s_add_u32 m0, s27, 117760
    s_add_u32 s26, s54, 114688
    buffer_load_dwordx4 v2, s[12:15], s26 offen lds
    s_waitcnt vmcnt(20)
    s_barrier
    s_mov_b32 s54, 65536
    s_add_u32 m0, s27, 0
    s_nop 0
    buffer_load_dwordx4 v4, s[12:15], s54 offen sc1 lds
    s_add_u32 m0, s27, 1024
    s_nop 0
    buffer_load_dwordx4 v5, s[12:15], s54 offen sc1 lds
    s_mov_b32 s54, 65536
    s_add_u32 m0, s27, 2048
    s_add_u32 s26, s54, 0
    buffer_load_dwordx4 v2, s[12:15], s26 offen lds
    s_add_u32 m0, s27, 3072
    s_add_u32 s26, s54, 114688
    buffer_load_dwordx4 v2, s[12:15], s26 offen lds
    s_waitcnt vmcnt(20)
    s_barrier
    s_mov_b32 s54, 69632
    s_add_u32 m0, s27, 16384
    s_nop 0
    buffer_load_dwordx4 v4, s[12:15], s54 offen sc1 lds
    s_add_u32 m0, s27, 17408
    s_nop 0
    buffer_load_dwordx4 v5, s[12:15], s54 offen sc1 lds
    s_mov_b32 s54, 69632
    s_add_u32 m0, s27, 18432
    s_add_u32 s26, s54, 0
    buffer_load_dwordx4 v2, s[12:15], s26 offen lds
    s_add_u32 m0, s27, 19456
    s_add_u32 s26, s54, 114688
    buffer_load_dwordx4 v2, s[12:15], s26 offen lds
    s_waitcnt vmcnt(20)
    s_barrier
    s_mov_b32 s54, 73728
    s_add_u32 m0, s27, 32768
    s_nop 0
    buffer_load_dwordx4 v4, s[12:15], s54 offen sc1 lds
    s_add_u32 m0, s27, 33792
    s_nop 0
    buffer_load_dwordx4 v5, s[12:15], s54 offen sc1 lds
    s_mov_b32 s54, 73728
    s_add_u32 m0, s27, 34816
    s_add_u32 s26, s54, 0
    buffer_load_dwordx4 v2, s[12:15], s26 offen lds
    s_add_u32 m0, s27, 35840
    s_add_u32 s26, s54, 114688
    buffer_load_dwordx4 v2, s[12:15], s26 offen lds
    s_waitcnt vmcnt(20)
    s_barrier
    s_mov_b32 s54, 77824
    s_add_u32 m0, s27, 49152
    s_nop 0
    buffer_load_dwordx4 v4, s[12:15], s54 offen sc1 lds
    s_add_u32 m0, s27, 50176
    s_nop 0
    buffer_load_dwordx4 v5, s[12:15], s54 offen sc1 lds
    s_mov_b32 s54, 77824
    s_add_u32 m0, s27, 51200
    s_add_u32 s26, s54, 0
    buffer_load_dwordx4 v2, s[12:15], s26 offen lds
    s_add_u32 m0, s27, 52224
    s_add_u32 s26, s54, 114688
    buffer_load_dwordx4 v2, s[12:15], s26 offen lds
    s_waitcnt vmcnt(20)
    s_barrier
    s_mov_b32 s54, 81920
    s_add_u32 m0, s27, 65536
    s_nop 0
    buffer_load_dwordx4 v4, s[12:15], s54 offen sc1 lds
    s_add_u32 m0, s27, 66560
    s_nop 0
    buffer_load_dwordx4 v5, s[12:15], s54 offen sc1 lds
    s_mov_b32 s54, 81920
    s_add_u32 m0, s27, 67584
    s_add_u32 s26, s54, 0
    buffer_load_dwordx4 v2, s[12:15], s26 offen lds
    s_add_u32 m0, s27, 68608
    s_add_u32 s26, s54, 114688
    buffer_load_dwordx4 v2, s[12:15], s26 offen lds
    s_waitcnt vmcnt(20)
    s_barrier
    s_mov_b32 s54, 86016
    s_add_u32 m0, s27, 81920
    s_nop 0
    buffer_load_dwordx4 v4, s[12:15], s54 offen sc1 lds
    s_add_u32 m0, s27, 82944
    s_nop 0
    buffer_load_dwordx4 v5, s[12:15], s54 offen sc1 lds
    s_mov_b32 s54, 86016
    s_add_u32 m0, s27, 83968
    s_add_u32 s26, s54, 0
    buffer_load_dwordx4 v2, s[12:15], s26 offen lds
    s_add_u32 m0, s27, 84992
    s_add_u32 s26, s54, 114688
    buffer_load_dwordx4 v2, s[12:15], s26 offen lds
    s_waitcnt vmcnt(20)
    s_barrier
    s_mov_b32 s54, 90112
    s_add_u32 m0, s27, 98304
    s_nop 0
    buffer_load_dwordx4 v4, s[12:15], s54 offen sc1 lds
    s_add_u32 m0, s27, 99328
    s_nop 0
    buffer_load_dwordx4 v5, s[12:15], s54 offen sc1 lds
    s_mov_b32 s54, 90112
    s_add_u32 m0, s27, 100352
    s_add_u32 s26, s54, 0
    buffer_load_dwordx4 v2, s[12:15], s26 offen lds
    s_add_u32 m0, s27, 101376
    s_add_u32 s26, s54, 114688
    buffer_load_dwordx4 v2, s[12:15], s26 offen lds
    s_waitcnt vmcnt(20)
    s_barrier
    s_mov_b32 s54, 94208
    s_add_u32 m0, s27, 114688
    s_nop 0
    buffer_load_dwordx4 v4, s[12:15], s54 offen sc1 lds
    s_add_u32 m0, s27, 115712
    s_nop 0
    buffer_load_dwordx4 v5, s[12:15], s54 offen sc1 lds
    s_mov_b32 s54, 94208
    s_add_u32 m0, s27, 116736
    s_add_u32 s26, s54, 0
    buffer_load_dwordx4 v2, s[12:15], s26 offen lds
    s_add_u32 m0, s27, 117760
    s_add_u32 s26, s54, 114688
    buffer_load_dwordx4 v2, s[12:15], s26 offen lds
    s_waitcnt vmcnt(20)
    s_barrier
    s_mov_b32 s54, 98304
    s_add_u32 m0, s27, 0
    s_nop 0
    buffer_load_dwordx4 v4, s[12:15], s54 offen sc1 lds
    s_add_u32 m0, s27, 1024
    s_nop 0
    buffer_load_dwordx4 v5, s[12:15], s54 offen sc1 lds
    s_mov_b32 s54, 98304
    s_add_u32 m0, s27, 2048
    s_add_u32 s26, s54, 0
    buffer_load_dwordx4 v2, s[12:15], s26 offen lds
    s_add_u32 m0, s27, 3072
    s_add_u32 s26, s54, 114688
    buffer_load_dwordx4 v2, s[12:15], s26 offen lds
    s_waitcnt vmcnt(20)
    s_barrier
    s_mov_b32 s54, 102400
    s_add_u32 m0, s27, 16384
    s_nop 0
    buffer_load_dwordx4 v4, s[12:15], s54 offen sc1 lds
    s_add_u32 m0, s27, 17408
    s_nop 0
    buffer_load_dwordx4 v5, s[12:15], s54 offen sc1 lds
    s_mov_b32 s54, 102400
    s_add_u32 m0, s27, 18432
    s_add_u32 s26, s54, 0
    buffer_load_dwordx4 v2, s[12:15], s26 offen lds
    s_add_u32 m0, s27, 19456
    s_add_u32 s26, s54, 114688
    buffer_load_dwordx4 v2, s[12:15], s26 offen lds
    s_waitcnt vmcnt(20)
    s_barrier
    s_mov_b32 s54, 106496
    s_add_u32 m0, s27, 32768
    s_nop 0
    buffer_load_dwordx4 v4, s[12:15], s54 offen sc1 lds
    s_add_u32 m0, s27, 33792
    s_nop 0
    buffer_load_dwordx4 v5, s[12:15], s54 offen sc1 lds
    s_mov_b32 s54, 106496
    s_add_u32 m0, s27, 34816
    s_add_u32 s26, s54, 0
    buffer_load_dwordx4 v2, s[12:15], s26 offen lds
    s_add_u32 m0, s27, 35840
    s_add_u32 s26, s54, 114688
    buffer_load_dwordx4 v2, s[12:15], s26 offen lds
    s_waitcnt vmcnt(20)
    s_barrier
    s_mov_b32 s54, 110592
    s_add_u32 m0, s27, 49152
    s_nop 0
    buffer_load_dwordx4 v4, s[12:15], s54 offen sc1 lds
    s_add_u32 m0, s27, 50176
    s_nop 0
    buffer_load_dwordx4 v5, s[12:15], s54 offen sc1 lds
    s_mov_b32 s54, 110592
    s_add_u32 m0, s27, 51200
    s_add_u32 s26, s54, 0
    buffer_load_dwordx4 v2, s[12:15], s26 offen lds
    s_add_u32 m0, s27, 52224
    s_add_u32 s26, s54, 114688
    buffer_load_dwordx4 v2, s[12:15], s26 offen lds
    s_waitcnt vmcnt(20)
    s_barrier
    s_waitcnt vmcnt(16)
    s_barrier
    s_waitcnt vmcnt(12)
    s_barrier
    s_waitcnt vmcnt(8)
    s_barrier
    s_waitcnt vmcnt(4)
    s_barrier
    s_waitcnt vmcnt(0)
    s_barrier
    s_endpgm
L_chain1_kernel_end:
    s_endpgm
.section .rodata,"a"
.p2align 6
.amdhsa_kernel chain1_kernel
  .amdhsa_next_free_vgpr 256
  .amdhsa_next_free_sgpr 64
  .amdhsa_accum_offset 256
  .amdhsa_group_segment_fixed_size 0
  .amdhsa_kernarg_size 88
  .amdhsa_user_sgpr_count 2
  .amdhsa_user_sgpr_kernarg_segment_ptr 1
  .amdhsa_system_sgpr_workgroup_id_x 1
  .amdhsa_float_denorm_mode_32 3
.end_amdhsa_kernel
.text
.text
.p2align 2
L_code_end:
    s_endpgm
```
